```python
import torch

def _softmax(x, axis=-1):
    return torch.softmax(x, dim=axis)
def _gelu(x):
    return torch.nn.functional.gelu(x, approximate="tanh")
def _silu(x):
    return torch.nn.functional.silu(x)
def _sigmoid(x):
    return torch.sigmoid(x)
def _layernorm(x, axis=-1, eps=1e-5):
    m = x.mean(dim=axis, keepdim=True)
    v = x.var(dim=axis, keepdim=True, unbiased=False)
    return (x - m) / torch.sqrt(v + eps)
def _scatter_add(tgt, idx, src, axis=0):
    return tgt.clone().index_add_(axis, idx, src)
def _segment_sum(src, seg, n):
    out = torch.zeros((n,) + src.shape[1:], dtype=src.dtype)
    return out.index_add_(0, seg, src)
def _pad(x, pw):
    flat = tuple(v for pair in reversed(pw) for v in pair)
    return torch.nn.functional.pad(x, flat)

kernel_name = 'concat_heads__mha_block__compressed_kv_cla__prompt'

def setup_inputs():

    _w = (lambda a: (lambda t: t.to(torch.bfloat16) if t.is_floating_point() else t)(torch.as_tensor(a)))
    def _A_setup():
        B, S, D, H = 1, 2048, 640, 32
        return {
            "x": _w((lambda *s: torch.randn(*s, dtype=torch.bfloat16) * 0.2)(B, S, D)),
            "wqkv": _w((lambda *s: torch.randn(*s, dtype=torch.bfloat16) * 0.2)(D, 3 * D)),
            "wo": _w((lambda *s: torch.randn(*s, dtype=torch.bfloat16) * 0.05)(D, D)),
        }
    _A_in = _A_setup()

    def _B_setup():
        B, H, Sq, Sk, D, M = 1, 32, 2048, 2048, 128, 640
        Dc = 4 * D
        return {
            "x": _w((lambda *s: torch.randn(*s, dtype=torch.bfloat16) * 0.4)(B, Sq, M)),
            "c_kv": _w((lambda *s: torch.randn(*s, dtype=torch.bfloat16) * 0.4)(B, Sk, Dc)),
            "w_q": _w((lambda *s: torch.randn(*s, dtype=torch.bfloat16) * 3.2)(M, H, D) * (M ** -0.5)),
            "w_uk": _w((lambda *s: torch.randn(*s, dtype=torch.bfloat16) * 3.2)(Dc, H, D) * (Dc ** -0.5)),
            "w_uv": _w((lambda *s: torch.randn(*s, dtype=torch.bfloat16) * 0.4)(Dc, H, D) * (Dc ** -0.5)),
            "w_o": _w((lambda *s: torch.randn(*s, dtype=torch.bfloat16) * 0.4)(H, D, M) * ((H * D) ** -0.5)),
        }
    _B_in = _B_setup()

    return {
        "A_x": _A_in["x"],
        "A_wqkv": _A_in["wqkv"],
        "A_wo": _A_in["wo"],
        "B_x": _B_in["x"],
        "B_c_kv": _B_in["c_kv"],
        "B_w_q": _B_in["w_q"],
        "B_w_uk": _B_in["w_uk"],
        "B_w_uv": _B_in["w_uv"],
        "B_w_o": _B_in["w_o"],
    }

def reference(A_x, A_wqkv, A_wo, B_x, B_c_kv, B_w_q, B_w_uk, B_w_uv, B_w_o):
    def _A_ref(x, wqkv, wo):
        B, S, D = x.shape
        H = 32
        Dh = D // H
        qkv = (lambda x, *d: x.permute(*d))((x @ wqkv).reshape(B, S, 3, H, Dh), 2, 0, 3, 1, 4)
        q, k, v = qkv[0], qkv[1], qkv[2]
        scores = torch.einsum("bhqd,bhkd->bhqk", q, k) * (Dh ** -0.5)
        p = _softmax(scores, axis=-1)
        o = torch.einsum("bhqk,bhkd->bhqd", p, v)
        return (lambda x, *d: x.permute(*d))(o, 0, 2, 1, 3).reshape(B, S, D) @ wo

    def _B_ref(x, c_kv, w_q, w_uk, w_uv, w_o):
        B, Sq, M = x.shape[0], x.shape[1], x.shape[2]
        Sk = c_kv.shape[1]
        H, D = w_q.shape[1], w_q.shape[2]
        q = torch.einsum("bqm,mhd->bhqd", x, w_q)
        k = torch.einsum("bkc,chd->bhkd", c_kv, w_uk)
        v = torch.einsum("bkc,chd->bhkd", c_kv, w_uv)
        scores = torch.einsum("bhqd,bhkd->bhqk", q, k) * (D ** -0.5)
        off = Sk - Sq
        qi = torch.arange(Sq)[:, None]
        kj = torch.arange(Sk)[None, :]
        cmask = kj <= (qi + off)
        scores = torch.where(cmask[None, None], scores, -1e9)
        p = _softmax(scores, axis=-1)
        ctx = torch.einsum("bhqk,bhkd->bhqd", p, v)
        return torch.einsum("bhqd,hdm->bqm", ctx, w_o)

    a = _A_ref(A_x, A_wqkv, A_wo)
    b = _B_ref(B_x, B_c_kv, B_w_q, B_w_uk, B_w_uv, B_w_o)
    return torch.concatenate([a, b], axis=-1)
```

```asm
; @launch kernel=proj_kernel grid=(448,1,1) block=(512,1,1) lds=131072
; @launch kernel=attn_kernel grid=(512,1,1) block=(256,1,1) lds=65536
; @launch kernel=oproj_kernel grid=(200,1,1) block=(512,1,1) lds=147456
; @launch kernel=reduce_kernel grid=(640,1,1) block=(256,1,1) lds=0
.amdgcn_target "amdgcn-amd-amdhsa--gfx950"
.text
.globl proj_kernel
.p2align 8
.type proj_kernel,@function
proj_kernel:
    s_cmp_ge_u32 s2, 448
    s_cbranch_scc1 k1_end
    s_load_dwordx2 s[42:43], s[0:1], 88
    s_mov_b32 s23, 0
    s_mov_b32 s24, 0
    s_mov_b32 s41, 0
    s_mov_b32 s40, 1.0
    s_mov_b32 s21, 8192
    s_mov_b32 s25, 524288
    s_cmp_ge_u32 s2, 192
    s_cbranch_scc1 k1_p2
    s_cmp_ge_u32 s2, 128
    s_cbranch_scc1 k1_pa
    s_load_dwordx2 s[4:5], s[0:1], 24
    s_load_dwordx2 s[6:7], s[0:1], 40
    s_sub_u32 s35, s2, 0
    s_and_b32 s36, s35, 1
    s_lshl_b32 s36, s36, 2
    s_bfe_u32 s37, s35, 0x20003
    s_add_u32 s30, s36, s37
    s_lshl_b32 s30, s30, 8
    s_bfe_u32 s36, s35, 0x20001
    s_mul_i32 s36, s36, 4
    s_lshr_b32 s37, s35, 5
    s_add_u32 s35, s36, s37
    s_lshl_b32 s31, s35, 8
    s_mov_b32 s20, 1280
    s_mov_b32 s22, 10
    s_mov_b32 s40, 0x3e0293ee
    s_mov_b32 s32, 0
    s_lshl_b32 s33, s31, 6
    s_add_u32 s33, s33, 0
    s_waitcnt lgkmcnt(0)
    s_mov_b32 s8, s4
    s_and_b32 s9, s5, 0xffff
    s_mov_b32 s10, 2621440
    s_mov_b32 s11, 0x00020000
    s_mov_b32 s12, s6
    s_and_b32 s13, s7, 0xffff
    s_mov_b32 s14, 5242880
    s_mov_b32 s15, 0x00020000
    s_mov_b32 s16, s42
    s_and_b32 s17, s43, 0xffff
    s_mov_b32 s18, 268435456
    s_mov_b32 s19, 0x00020000
    s_branch k1_T
k1_p2:
    s_load_dwordx2 s[4:5], s[0:1], 32
    s_mov_b32 s20, 1024
    s_mov_b32 s22, 8
    s_cmp_ge_u32 s2, 320
    s_cbranch_scc1 k1_p3
    s_load_dwordx2 s[6:7], s[0:1], 48
    s_sub_u32 s35, s2, 192
    s_and_b32 s36, s35, 1
    s_lshl_b32 s36, s36, 2
    s_bfe_u32 s37, s35, 0x20003
    s_add_u32 s30, s36, s37
    s_lshl_b32 s30, s30, 8
    s_bfe_u32 s36, s35, 0x20001
    s_mul_i32 s36, s36, 4
    s_lshr_b32 s37, s35, 5
    s_add_u32 s35, s36, s37
    s_lshl_b32 s31, s35, 8
    s_mov_b32 s32, 0
    s_lshl_b32 s33, s31, 6
    s_add_u32 s33, s33, 16777216
    s_waitcnt lgkmcnt(0)
    s_mov_b32 s8, s4
    s_and_b32 s9, s5, 0xffff
    s_mov_b32 s10, 2097152
    s_mov_b32 s11, 0x00020000
    s_mov_b32 s12, s6
    s_and_b32 s13, s7, 0xffff
    s_mov_b32 s14, 4194304
    s_mov_b32 s15, 0x00020000
    s_mov_b32 s16, s42
    s_and_b32 s17, s43, 0xffff
    s_mov_b32 s18, 268435456
    s_mov_b32 s19, 0x00020000
    s_branch k1_T
k1_p3:
    s_load_dwordx2 s[6:7], s[0:1], 56
    s_sub_u32 s35, s2, 320
    s_and_b32 s36, s35, 1
    s_lshl_b32 s36, s36, 2
    s_bfe_u32 s37, s35, 0x20003
    s_add_u32 s30, s36, s37
    s_lshl_b32 s30, s30, 8
    s_bfe_u32 s36, s35, 0x20001
    s_mul_i32 s36, s36, 4
    s_lshr_b32 s37, s35, 5
    s_add_u32 s35, s36, s37
    s_lshl_b32 s31, s35, 8
    s_lshl_b32 s33, s31, 12
    s_add_u32 s33, s33, 33554432
    s_mov_b32 s32, 0
    s_waitcnt lgkmcnt(0)
    s_mov_b32 s8, s4
    s_and_b32 s9, s5, 0xffff
    s_mov_b32 s10, 2097152
    s_mov_b32 s11, 0x00020000
    s_mov_b32 s12, s6
    s_and_b32 s13, s7, 0xffff
    s_mov_b32 s14, 4194304
    s_mov_b32 s15, 0x00020000
    s_mov_b32 s16, s42
    s_and_b32 s17, s43, 0xffff
    s_mov_b32 s18, 268435456
    s_mov_b32 s19, 0x00020000
    s_branch k1_N
k1_pa:
    s_load_dwordx2 s[4:5], s[0:1], 0
    s_load_dwordx2 s[6:7], s[0:1], 8
    s_sub_u32 s35, s2, 128
    s_and_b32 s36, s35, 1
    s_lshl_b32 s36, s36, 2
    s_bfe_u32 s37, s35, 0x20003
    s_add_u32 s30, s36, s37
    s_lshl_b32 s30, s30, 8
    s_bfe_u32 s36, s35, 0x20001
    s_mul_i32 s36, s36, 2
    s_lshr_b32 s37, s35, 5
    s_add_u32 s35, s36, s37
    s_lshl_b32 s31, s35, 8
    s_mov_b32 s20, 1280
    s_mov_b32 s21, 3840
    s_mov_b32 s25, 245760
    s_mov_b32 s22, 10
    s_mov_b32 s32, 1
    s_waitcnt lgkmcnt(0)
    s_mov_b32 s8, s4
    s_and_b32 s9, s5, 0xffff
    s_mov_b32 s10, 2621440
    s_mov_b32 s11, 0x00020000
    s_mov_b32 s12, s6
    s_and_b32 s13, s7, 0xffff
    s_mov_b32 s14, 2457600
    s_mov_b32 s15, 0x00020000
    s_mov_b32 s16, s42
    s_and_b32 s17, s43, 0xffff
    s_mov_b32 s18, 268435456
    s_mov_b32 s19, 0x00020000
    s_cmp_lt_u32 s35, 5
    s_cbranch_scc1 k1_T
    s_sub_u32 s33, s31, 1280
    s_lshl_b32 s33, s33, 12
    s_add_u32 s33, s33, 73400320
k1_N:
    v_and_b32 v1, 63, v0
    v_lshrrev_b32 v2, 6, v0
    s_nop 0
    v_readfirstlane_b32 s27, v2
    s_lshl_b32 s26, s27, 12
    s_lshr_b32 s28, s27, 2
    s_and_b32 s29, s27, 3
    v_lshrrev_b32 v2, 3, v1
    v_and_b32 v3, 7, v1
    v_lshrrev_b32 v4, 4, v1
    v_and_b32 v5, 15, v1
    s_lshl_b32 s36, s27, 5
    s_add_u32 s36, s36, 0
    s_add_u32 s36, s36, s30
    v_add_u32 v6, s36, v2
    v_add_u32 v7, 0, v4
    v_xor_b32 v7, v7, v3
    v_mul_lo_u32 v6, v6, s20
    v_lshlrev_b32 v7, 4, v7
    v_add3_u32 v10, v6, v7, s41
    s_lshl_b32 s36, s27, 5
    s_add_u32 s36, s36, 8
    s_add_u32 s36, s36, s30
    v_add_u32 v6, s36, v2
    v_add_u32 v7, 4, v4
    v_xor_b32 v7, v7, v3
    v_mul_lo_u32 v6, v6, s20
    v_lshlrev_b32 v7, 4, v7
    v_add3_u32 v11, v6, v7, s41
    s_lshl_b32 s36, s27, 5
    s_add_u32 s36, s36, 16
    s_add_u32 s36, s36, s30
    v_add_u32 v6, s36, v2
    v_add_u32 v7, 0, v4
    v_xor_b32 v7, v7, v3
    v_mul_lo_u32 v6, v6, s20
    v_lshlrev_b32 v7, 4, v7
    v_add3_u32 v12, v6, v7, s41
    s_lshl_b32 s36, s27, 5
    s_add_u32 s36, s36, 24
    s_add_u32 s36, s36, s30
    v_add_u32 v6, s36, v2
    v_add_u32 v7, 4, v4
    v_xor_b32 v7, v7, v3
    v_mul_lo_u32 v6, v6, s20
    v_lshlrev_b32 v7, 4, v7
    v_add3_u32 v13, v6, v7, s41
    v_lshlrev_b32 v7, 2, v4
    v_xor_b32 v7, v7, v5
    v_lshlrev_b32 v7, 4, v7
    s_lshl_b32 s37, s28, 7
    s_add_u32 s37, s37, s31
    s_lshl_b32 s37, s37, 1
    s_lshl_b32 s36, s29, 4
    s_add_u32 s36, s36, 0
    v_add_u32 v6, s36, v4
    v_mul_lo_u32 v6, v6, s21
    v_add3_u32 v14, v6, v7, s37
    s_lshl_b32 s36, s29, 4
    s_add_u32 s36, s36, 4
    v_add_u32 v6, s36, v4
    v_mul_lo_u32 v6, v6, s21
    v_add3_u32 v15, v6, v7, s37
    s_lshl_b32 s36, s29, 4
    s_add_u32 s36, s36, 8
    v_add_u32 v6, s36, v4
    v_mul_lo_u32 v6, v6, s21
    v_add3_u32 v16, v6, v7, s37
    s_lshl_b32 s36, s29, 4
    s_add_u32 s36, s36, 12
    v_add_u32 v6, s36, v4
    v_mul_lo_u32 v6, v6, s21
    v_add3_u32 v17, v6, v7, s37
    s_add_u32 m0, s26, 0
    s_nop 0
    buffer_load_dwordx4 v10, s[8:11], s23 offen lds
    s_add_u32 m0, s26, 1024
    s_nop 0
    buffer_load_dwordx4 v11, s[8:11], s23 offen lds
    s_add_u32 m0, s26, 2048
    s_nop 0
    buffer_load_dwordx4 v12, s[8:11], s23 offen lds
    s_add_u32 m0, s26, 3072
    s_nop 0
    buffer_load_dwordx4 v13, s[8:11], s23 offen lds
    s_add_u32 m0, s26, 32768
    s_nop 0
    buffer_load_dwordx4 v14, s[12:15], s24 offen lds
    s_add_u32 m0, s26, 33792
    s_nop 0
    buffer_load_dwordx4 v15, s[12:15], s24 offen lds
    s_add_u32 m0, s26, 34816
    s_nop 0
    buffer_load_dwordx4 v16, s[12:15], s24 offen lds
    s_add_u32 m0, s26, 35840
    s_nop 0
    buffer_load_dwordx4 v17, s[12:15], s24 offen lds
    s_add_u32 s23, s23, 128
    s_add_u32 s24, s24, s25
    s_add_u32 m0, s26, 65536
    s_nop 0
    buffer_load_dwordx4 v10, s[8:11], s23 offen lds
    s_add_u32 m0, s26, 66560
    s_nop 0
    buffer_load_dwordx4 v11, s[8:11], s23 offen lds
    s_add_u32 m0, s26, 67584
    s_nop 0
    buffer_load_dwordx4 v12, s[8:11], s23 offen lds
    s_add_u32 m0, s26, 68608
    s_nop 0
    buffer_load_dwordx4 v13, s[8:11], s23 offen lds
    s_add_u32 m0, s26, 98304
    s_nop 0
    buffer_load_dwordx4 v14, s[12:15], s24 offen lds
    s_add_u32 m0, s26, 99328
    s_nop 0
    buffer_load_dwordx4 v15, s[12:15], s24 offen lds
    s_add_u32 m0, s26, 100352
    s_nop 0
    buffer_load_dwordx4 v16, s[12:15], s24 offen lds
    s_add_u32 m0, s26, 101376
    s_nop 0
    buffer_load_dwordx4 v17, s[12:15], s24 offen lds
    s_add_u32 s23, s23, 128
    s_add_u32 s24, s24, s25
    v_and_b32 v6, 31, v1
    v_lshrrev_b32 v8, 5, v1
    v_bfe_u32 v7, v6, 1, 3
    v_xor_b32 v7, v7, v8
    v_lshlrev_b32 v6, 7, v6
    s_lshl_b32 s36, s28, 14
    v_add_u32 v6, s36, v6
    v_xor_b32 v9, 0, v7
    v_lshl_add_u32 v18, v9, 4, v6
    v_add_u32 v22, 65536, v18
    v_xor_b32 v9, 2, v7
    v_lshl_add_u32 v19, v9, 4, v6
    v_add_u32 v23, 65536, v19
    v_xor_b32 v9, 4, v7
    v_lshl_add_u32 v20, v9, 4, v6
    v_add_u32 v24, 65536, v20
    v_xor_b32 v9, 6, v7
    v_lshl_add_u32 v21, v9, 4, v6
    v_add_u32 v25, 65536, v21
    v_bfe_u32 v6, v1, 2, 2
    v_and_b32 v7, 3, v1
    v_bfe_u32 v9, v1, 4, 1
    v_lshlrev_b32 v40, 3, v8
    v_add_u32 v40, v40, v6
    v_lshlrev_b32 v40, 8, v40
    v_lshrrev_b32 v41, 1, v7
    v_lshl_add_u32 v41, v9, 1, v41
    s_and_b32 s36, s29, 1
    s_lshl_b32 s36, s36, 3
    v_add_u32 v41, s36, v41
    v_lshlrev_b32 v42, 2, v6
    v_xor_b32 v41, v41, v42
    v_and_b32 v7, 1, v7
    v_lshl_add_u32 v40, v7, 3, v40
    s_lshr_b32 s36, s29, 1
    s_lshl_b32 s36, s36, 14
    s_add_u32 s36, s36, 32768
    v_add_u32 v40, s36, v40
    v_xor_b32 v42, 0, v41
    v_lshl_add_u32 v30, v42, 4, v40
    v_add_u32 v32, 65536, v30
    v_xor_b32 v42, 4, v41
    v_lshl_add_u32 v31, v42, 4, v40
    v_add_u32 v33, 65536, v31
    v_mov_b32 v128, 0
    v_mov_b32 v129, 0
    v_mov_b32 v130, 0
    v_mov_b32 v131, 0
    v_mov_b32 v132, 0
    v_mov_b32 v133, 0
    v_mov_b32 v134, 0
    v_mov_b32 v135, 0
    v_mov_b32 v136, 0
    v_mov_b32 v137, 0
    v_mov_b32 v138, 0
    v_mov_b32 v139, 0
    v_mov_b32 v140, 0
    v_mov_b32 v141, 0
    v_mov_b32 v142, 0
    v_mov_b32 v143, 0
    v_mov_b32 v144, 0
    v_mov_b32 v145, 0
    v_mov_b32 v146, 0
    v_mov_b32 v147, 0
    v_mov_b32 v148, 0
    v_mov_b32 v149, 0
    v_mov_b32 v150, 0
    v_mov_b32 v151, 0
    v_mov_b32 v152, 0
    v_mov_b32 v153, 0
    v_mov_b32 v154, 0
    v_mov_b32 v155, 0
    v_mov_b32 v156, 0
    v_mov_b32 v157, 0
    v_mov_b32 v158, 0
    v_mov_b32 v159, 0
    v_mov_b32 v160, 0
    v_mov_b32 v161, 0
    v_mov_b32 v162, 0
    v_mov_b32 v163, 0
    v_mov_b32 v164, 0
    v_mov_b32 v165, 0
    v_mov_b32 v166, 0
    v_mov_b32 v167, 0
    v_mov_b32 v168, 0
    v_mov_b32 v169, 0
    v_mov_b32 v170, 0
    v_mov_b32 v171, 0
    v_mov_b32 v172, 0
    v_mov_b32 v173, 0
    v_mov_b32 v174, 0
    v_mov_b32 v175, 0
    v_mov_b32 v176, 0
    v_mov_b32 v177, 0
    v_mov_b32 v178, 0
    v_mov_b32 v179, 0
    v_mov_b32 v180, 0
    v_mov_b32 v181, 0
    v_mov_b32 v182, 0
    v_mov_b32 v183, 0
    v_mov_b32 v184, 0
    v_mov_b32 v185, 0
    v_mov_b32 v186, 0
    v_mov_b32 v187, 0
    v_mov_b32 v188, 0
    v_mov_b32 v189, 0
    v_mov_b32 v190, 0
    v_mov_b32 v191, 0
    v_mov_b32 v192, 0
    v_mov_b32 v193, 0
    v_mov_b32 v194, 0
    v_mov_b32 v195, 0
    v_mov_b32 v196, 0
    v_mov_b32 v197, 0
    v_mov_b32 v198, 0
    v_mov_b32 v199, 0
    v_mov_b32 v200, 0
    v_mov_b32 v201, 0
    v_mov_b32 v202, 0
    v_mov_b32 v203, 0
    v_mov_b32 v204, 0
    v_mov_b32 v205, 0
    v_mov_b32 v206, 0
    v_mov_b32 v207, 0
    v_mov_b32 v208, 0
    v_mov_b32 v209, 0
    v_mov_b32 v210, 0
    v_mov_b32 v211, 0
    v_mov_b32 v212, 0
    v_mov_b32 v213, 0
    v_mov_b32 v214, 0
    v_mov_b32 v215, 0
    v_mov_b32 v216, 0
    v_mov_b32 v217, 0
    v_mov_b32 v218, 0
    v_mov_b32 v219, 0
    v_mov_b32 v220, 0
    v_mov_b32 v221, 0
    v_mov_b32 v222, 0
    v_mov_b32 v223, 0
    v_mov_b32 v224, 0
    v_mov_b32 v225, 0
    v_mov_b32 v226, 0
    v_mov_b32 v227, 0
    v_mov_b32 v228, 0
    v_mov_b32 v229, 0
    v_mov_b32 v230, 0
    v_mov_b32 v231, 0
    v_mov_b32 v232, 0
    v_mov_b32 v233, 0
    v_mov_b32 v234, 0
    v_mov_b32 v235, 0
    v_mov_b32 v236, 0
    v_mov_b32 v237, 0
    v_mov_b32 v238, 0
    v_mov_b32 v239, 0
    v_mov_b32 v240, 0
    v_mov_b32 v241, 0
    v_mov_b32 v242, 0
    v_mov_b32 v243, 0
    v_mov_b32 v244, 0
    v_mov_b32 v245, 0
    v_mov_b32 v246, 0
    v_mov_b32 v247, 0
    v_mov_b32 v248, 0
    v_mov_b32 v249, 0
    v_mov_b32 v250, 0
    v_mov_b32 v251, 0
    v_mov_b32 v252, 0
    v_mov_b32 v253, 0
    v_mov_b32 v254, 0
    v_mov_b32 v255, 0
    s_mov_b64 vcc, 0
    s_waitcnt vmcnt(8)
    s_barrier
    ds_read_b64_tr_b16 v[80:81], v30 offset:0
    ds_read_b64_tr_b16 v[82:83], v30 offset:1024
    ds_read_b64_tr_b16 v[84:85], v31 offset:0
    ds_read_b64_tr_b16 v[86:87], v31 offset:1024
    ds_read_b128 v[64:67], v18 offset:0
    ds_read_b128 v[68:71], v18 offset:4096
    ds_read_b128 v[72:75], v18 offset:8192
    ds_read_b128 v[76:79], v18 offset:12288
gl_1:
    ds_read_b64_tr_b16 v[104:105], v30 offset:4096
    ds_read_b64_tr_b16 v[106:107], v30 offset:5120
    ds_read_b64_tr_b16 v[108:109], v31 offset:4096
    ds_read_b64_tr_b16 v[110:111], v31 offset:5120
    ds_read_b128 v[88:91], v19 offset:0
    ds_read_b128 v[92:95], v19 offset:4096
    ds_read_b128 v[96:99], v19 offset:8192
    ds_read_b128 v[100:103], v19 offset:12288
    s_waitcnt lgkmcnt(11)
    v_mfma_f32_32x32x16_bf16 v[128:143], v[64:67], v[80:83], v[128:143]
    v_mfma_f32_32x32x16_bf16 v[192:207], v[64:67], v[84:87], v[192:207]
    s_cbranch_vccz gn_3
    s_add_u32 m0, s26, 67584
    s_nop 0
    buffer_load_dwordx4 v12, s[8:11], s23 offen lds
gn_3:
    s_waitcnt lgkmcnt(10)
    v_mfma_f32_32x32x16_bf16 v[144:159], v[68:71], v[80:83], v[144:159]
    v_mfma_f32_32x32x16_bf16 v[208:223], v[68:71], v[84:87], v[208:223]
    s_cbranch_vccz gn_4
    s_add_u32 m0, s26, 68608
    s_nop 0
    buffer_load_dwordx4 v13, s[8:11], s23 offen lds
gn_4:
    s_waitcnt lgkmcnt(9)
    v_mfma_f32_32x32x16_bf16 v[160:175], v[72:75], v[80:83], v[160:175]
    v_mfma_f32_32x32x16_bf16 v[224:239], v[72:75], v[84:87], v[224:239]
    s_cbranch_vccz gn_5
    s_add_u32 m0, s26, 98304
    s_nop 0
    buffer_load_dwordx4 v14, s[12:15], s24 offen lds
gn_5:
    s_waitcnt lgkmcnt(8)
    v_mfma_f32_32x32x16_bf16 v[176:191], v[76:79], v[80:83], v[176:191]
    v_mfma_f32_32x32x16_bf16 v[240:255], v[76:79], v[84:87], v[240:255]
    s_cbranch_vccz gn_6
    s_add_u32 m0, s26, 99328
    s_nop 0
    buffer_load_dwordx4 v15, s[12:15], s24 offen lds
gn_6:
    ds_read_b64_tr_b16 v[80:81], v30 offset:8192
    ds_read_b64_tr_b16 v[82:83], v30 offset:9216
    ds_read_b64_tr_b16 v[84:85], v31 offset:8192
    ds_read_b64_tr_b16 v[86:87], v31 offset:9216
    ds_read_b128 v[64:67], v20 offset:0
    ds_read_b128 v[68:71], v20 offset:4096
    ds_read_b128 v[72:75], v20 offset:8192
    ds_read_b128 v[76:79], v20 offset:12288
    s_waitcnt lgkmcnt(11)
    v_mfma_f32_32x32x16_bf16 v[128:143], v[88:91], v[104:107], v[128:143]
    v_mfma_f32_32x32x16_bf16 v[192:207], v[88:91], v[108:111], v[192:207]
    s_cbranch_vccz gn_7
    s_add_u32 m0, s26, 100352
    s_nop 0
    buffer_load_dwordx4 v16, s[12:15], s24 offen lds
gn_7:
    s_waitcnt lgkmcnt(10)
    v_mfma_f32_32x32x16_bf16 v[144:159], v[92:95], v[104:107], v[144:159]
    v_mfma_f32_32x32x16_bf16 v[208:223], v[92:95], v[108:111], v[208:223]
    s_cbranch_vccz gn_8
    s_add_u32 m0, s26, 101376
    s_nop 0
    buffer_load_dwordx4 v17, s[12:15], s24 offen lds
    s_add_u32 s23, s23, 128
    s_add_u32 s24, s24, s25
gn_8:
    s_waitcnt lgkmcnt(9)
    v_mfma_f32_32x32x16_bf16 v[160:175], v[96:99], v[104:107], v[160:175]
    v_mfma_f32_32x32x16_bf16 v[224:239], v[96:99], v[108:111], v[224:239]
    s_waitcnt lgkmcnt(8)
    v_mfma_f32_32x32x16_bf16 v[176:191], v[100:103], v[104:107], v[176:191]
    v_mfma_f32_32x32x16_bf16 v[240:255], v[100:103], v[108:111], v[240:255]
    ds_read_b64_tr_b16 v[104:105], v30 offset:12288
    ds_read_b64_tr_b16 v[106:107], v30 offset:13312
    ds_read_b64_tr_b16 v[108:109], v31 offset:12288
    ds_read_b64_tr_b16 v[110:111], v31 offset:13312
    ds_read_b128 v[88:91], v21 offset:0
    ds_read_b128 v[92:95], v21 offset:4096
    ds_read_b128 v[96:99], v21 offset:8192
    ds_read_b128 v[100:103], v21 offset:12288
    s_waitcnt lgkmcnt(11)
    v_mfma_f32_32x32x16_bf16 v[128:143], v[64:67], v[80:83], v[128:143]
    v_mfma_f32_32x32x16_bf16 v[192:207], v[64:67], v[84:87], v[192:207]
    s_waitcnt lgkmcnt(10)
    v_mfma_f32_32x32x16_bf16 v[144:159], v[68:71], v[80:83], v[144:159]
    v_mfma_f32_32x32x16_bf16 v[208:223], v[68:71], v[84:87], v[208:223]
    s_waitcnt lgkmcnt(9)
    v_mfma_f32_32x32x16_bf16 v[160:175], v[72:75], v[80:83], v[160:175]
    v_mfma_f32_32x32x16_bf16 v[224:239], v[72:75], v[84:87], v[224:239]
    s_waitcnt lgkmcnt(8)
    v_mfma_f32_32x32x16_bf16 v[176:191], v[76:79], v[80:83], v[176:191]
    v_mfma_f32_32x32x16_bf16 v[240:255], v[76:79], v[84:87], v[240:255]
    s_waitcnt lgkmcnt(3)
    v_mfma_f32_32x32x16_bf16 v[128:143], v[88:91], v[104:107], v[128:143]
    v_mfma_f32_32x32x16_bf16 v[192:207], v[88:91], v[108:111], v[192:207]
    s_waitcnt lgkmcnt(2)
    v_mfma_f32_32x32x16_bf16 v[144:159], v[92:95], v[104:107], v[144:159]
    v_mfma_f32_32x32x16_bf16 v[208:223], v[92:95], v[108:111], v[208:223]
    s_cmp_le_u32 s22, 1
    s_waitcnt lgkmcnt(0)
    s_cbranch_scc1 ge_2
    s_waitcnt vmcnt(0)
    s_cmp_gt_u32 s22, 2
    s_cselect_b64 vcc, -1, 0
    s_barrier
    ds_read_b64_tr_b16 v[80:81], v32 offset:0
    ds_read_b64_tr_b16 v[82:83], v32 offset:1024
    ds_read_b64_tr_b16 v[84:85], v33 offset:0
    ds_read_b64_tr_b16 v[86:87], v33 offset:1024
    ds_read_b128 v[64:67], v22 offset:0
    ds_read_b128 v[68:71], v22 offset:4096
    ds_read_b128 v[72:75], v22 offset:8192
    ds_read_b128 v[76:79], v22 offset:12288
    v_mfma_f32_32x32x16_bf16 v[160:175], v[96:99], v[104:107], v[160:175]
    v_mfma_f32_32x32x16_bf16 v[224:239], v[96:99], v[108:111], v[224:239]
    s_cbranch_vccz gn_9
    s_add_u32 m0, s26, 0
    s_nop 0
    buffer_load_dwordx4 v10, s[8:11], s23 offen lds
gn_9:
    v_mfma_f32_32x32x16_bf16 v[176:191], v[100:103], v[104:107], v[176:191]
    v_mfma_f32_32x32x16_bf16 v[240:255], v[100:103], v[108:111], v[240:255]
    s_cbranch_vccz gn_10
    s_add_u32 m0, s26, 1024
    s_nop 0
    buffer_load_dwordx4 v11, s[8:11], s23 offen lds
gn_10:
    s_sub_u32 s22, s22, 1
    ds_read_b64_tr_b16 v[104:105], v32 offset:4096
    ds_read_b64_tr_b16 v[106:107], v32 offset:5120
    ds_read_b64_tr_b16 v[108:109], v33 offset:4096
    ds_read_b64_tr_b16 v[110:111], v33 offset:5120
    ds_read_b128 v[88:91], v23 offset:0
    ds_read_b128 v[92:95], v23 offset:4096
    ds_read_b128 v[96:99], v23 offset:8192
    ds_read_b128 v[100:103], v23 offset:12288
    s_waitcnt lgkmcnt(11)
    v_mfma_f32_32x32x16_bf16 v[128:143], v[64:67], v[80:83], v[128:143]
    v_mfma_f32_32x32x16_bf16 v[192:207], v[64:67], v[84:87], v[192:207]
    s_cbranch_vccz gn_11
    s_add_u32 m0, s26, 2048
    s_nop 0
    buffer_load_dwordx4 v12, s[8:11], s23 offen lds
gn_11:
    s_waitcnt lgkmcnt(10)
    v_mfma_f32_32x32x16_bf16 v[144:159], v[68:71], v[80:83], v[144:159]
    v_mfma_f32_32x32x16_bf16 v[208:223], v[68:71], v[84:87], v[208:223]
    s_cbranch_vccz gn_12
    s_add_u32 m0, s26, 3072
    s_nop 0
    buffer_load_dwordx4 v13, s[8:11], s23 offen lds
gn_12:
    s_waitcnt lgkmcnt(9)
    v_mfma_f32_32x32x16_bf16 v[160:175], v[72:75], v[80:83], v[160:175]
    v_mfma_f32_32x32x16_bf16 v[224:239], v[72:75], v[84:87], v[224:239]
    s_cbranch_vccz gn_13
    s_add_u32 m0, s26, 32768
    s_nop 0
    buffer_load_dwordx4 v14, s[12:15], s24 offen lds
gn_13:
    s_waitcnt lgkmcnt(8)
    v_mfma_f32_32x32x16_bf16 v[176:191], v[76:79], v[80:83], v[176:191]
    v_mfma_f32_32x32x16_bf16 v[240:255], v[76:79], v[84:87], v[240:255]
    s_cbranch_vccz gn_14
    s_add_u32 m0, s26, 33792
    s_nop 0
    buffer_load_dwordx4 v15, s[12:15], s24 offen lds
gn_14:
    ds_read_b64_tr_b16 v[80:81], v32 offset:8192
    ds_read_b64_tr_b16 v[82:83], v32 offset:9216
    ds_read_b64_tr_b16 v[84:85], v33 offset:8192
    ds_read_b64_tr_b16 v[86:87], v33 offset:9216
    ds_read_b128 v[64:67], v24 offset:0
    ds_read_b128 v[68:71], v24 offset:4096
    ds_read_b128 v[72:75], v24 offset:8192
    ds_read_b128 v[76:79], v24 offset:12288
    s_waitcnt lgkmcnt(11)
    v_mfma_f32_32x32x16_bf16 v[128:143], v[88:91], v[104:107], v[128:143]
    v_mfma_f32_32x32x16_bf16 v[192:207], v[88:91], v[108:111], v[192:207]
    s_cbranch_vccz gn_15
    s_add_u32 m0, s26, 34816
    s_nop 0
    buffer_load_dwordx4 v16, s[12:15], s24 offen lds
gn_15:
    s_waitcnt lgkmcnt(10)
    v_mfma_f32_32x32x16_bf16 v[144:159], v[92:95], v[104:107], v[144:159]
    v_mfma_f32_32x32x16_bf16 v[208:223], v[92:95], v[108:111], v[208:223]
    s_cbranch_vccz gn_16
    s_add_u32 m0, s26, 35840
    s_nop 0
    buffer_load_dwordx4 v17, s[12:15], s24 offen lds
    s_add_u32 s23, s23, 128
    s_add_u32 s24, s24, s25
gn_16:
    s_waitcnt lgkmcnt(9)
    v_mfma_f32_32x32x16_bf16 v[160:175], v[96:99], v[104:107], v[160:175]
    v_mfma_f32_32x32x16_bf16 v[224:239], v[96:99], v[108:111], v[224:239]
    s_waitcnt lgkmcnt(8)
    v_mfma_f32_32x32x16_bf16 v[176:191], v[100:103], v[104:107], v[176:191]
    v_mfma_f32_32x32x16_bf16 v[240:255], v[100:103], v[108:111], v[240:255]
    ds_read_b64_tr_b16 v[104:105], v32 offset:12288
    ds_read_b64_tr_b16 v[106:107], v32 offset:13312
    ds_read_b64_tr_b16 v[108:109], v33 offset:12288
    ds_read_b64_tr_b16 v[110:111], v33 offset:13312
    ds_read_b128 v[88:91], v25 offset:0
    ds_read_b128 v[92:95], v25 offset:4096
    ds_read_b128 v[96:99], v25 offset:8192
    ds_read_b128 v[100:103], v25 offset:12288
    s_waitcnt lgkmcnt(11)
    v_mfma_f32_32x32x16_bf16 v[128:143], v[64:67], v[80:83], v[128:143]
    v_mfma_f32_32x32x16_bf16 v[192:207], v[64:67], v[84:87], v[192:207]
    s_waitcnt lgkmcnt(10)
    v_mfma_f32_32x32x16_bf16 v[144:159], v[68:71], v[80:83], v[144:159]
    v_mfma_f32_32x32x16_bf16 v[208:223], v[68:71], v[84:87], v[208:223]
    s_waitcnt lgkmcnt(9)
    v_mfma_f32_32x32x16_bf16 v[160:175], v[72:75], v[80:83], v[160:175]
    v_mfma_f32_32x32x16_bf16 v[224:239], v[72:75], v[84:87], v[224:239]
    s_waitcnt lgkmcnt(8)
    v_mfma_f32_32x32x16_bf16 v[176:191], v[76:79], v[80:83], v[176:191]
    v_mfma_f32_32x32x16_bf16 v[240:255], v[76:79], v[84:87], v[240:255]
    s_waitcnt lgkmcnt(3)
    v_mfma_f32_32x32x16_bf16 v[128:143], v[88:91], v[104:107], v[128:143]
    v_mfma_f32_32x32x16_bf16 v[192:207], v[88:91], v[108:111], v[192:207]
    s_waitcnt lgkmcnt(2)
    v_mfma_f32_32x32x16_bf16 v[144:159], v[92:95], v[104:107], v[144:159]
    v_mfma_f32_32x32x16_bf16 v[208:223], v[92:95], v[108:111], v[208:223]
    s_cmp_le_u32 s22, 1
    s_waitcnt lgkmcnt(0)
    s_cbranch_scc1 ge_2
    s_waitcnt vmcnt(0)
    s_cmp_gt_u32 s22, 2
    s_cselect_b64 vcc, -1, 0
    s_barrier
    ds_read_b64_tr_b16 v[80:81], v30 offset:0
    ds_read_b64_tr_b16 v[82:83], v30 offset:1024
    ds_read_b64_tr_b16 v[84:85], v31 offset:0
    ds_read_b64_tr_b16 v[86:87], v31 offset:1024
    ds_read_b128 v[64:67], v18 offset:0
    ds_read_b128 v[68:71], v18 offset:4096
    ds_read_b128 v[72:75], v18 offset:8192
    ds_read_b128 v[76:79], v18 offset:12288
    v_mfma_f32_32x32x16_bf16 v[160:175], v[96:99], v[104:107], v[160:175]
    v_mfma_f32_32x32x16_bf16 v[224:239], v[96:99], v[108:111], v[224:239]
    s_cbranch_vccz gn_17
    s_add_u32 m0, s26, 65536
    s_nop 0
    buffer_load_dwordx4 v10, s[8:11], s23 offen lds
gn_17:
    v_mfma_f32_32x32x16_bf16 v[176:191], v[100:103], v[104:107], v[176:191]
    v_mfma_f32_32x32x16_bf16 v[240:255], v[100:103], v[108:111], v[240:255]
    s_cbranch_vccz gn_18
    s_add_u32 m0, s26, 66560
    s_nop 0
    buffer_load_dwordx4 v11, s[8:11], s23 offen lds
gn_18:
    s_sub_u32 s22, s22, 1
    s_branch gl_1
ge_2:
    v_mfma_f32_32x32x16_bf16 v[160:175], v[96:99], v[104:107], v[160:175]
    v_mfma_f32_32x32x16_bf16 v[224:239], v[96:99], v[108:111], v[224:239]
    v_mfma_f32_32x32x16_bf16 v[176:191], v[100:103], v[104:107], v[176:191]
    v_mfma_f32_32x32x16_bf16 v[240:255], v[100:103], v[108:111], v[240:255]
    s_nop 15
    s_cmp_eq_u32 s32, 0
    s_cbranch_scc1 k1_Nst
    s_lshl_b32 s36, s29, 6
    s_add_u32 s36, s36, s31
    s_cmp_ge_u32 s36, 1920
    s_cbranch_scc1 k1_end
    v_and_b32 v2, 31, v1
    s_lshl_b32 s36, s29, 6
    v_add_u32 v2, s36, v2
    v_lshlrev_b32 v2, 12, v2
    s_lshl_b32 s36, s28, 7
    s_add_u32 s36, s36, s30
    s_lshl_b32 s36, s36, 1
    s_add_u32 s36, s36, s33
    v_lshlrev_b32 v3, 4, v8
    v_add3_u32 v2, v2, v3, s36
    v_add_u32 v3, 131072, v2
    v_cvt_pk_bf16_f32 v32, v128, v129
    v_cvt_pk_bf16_f32 v33, v130, v131
    v_cvt_pk_bf16_f32 v34, v132, v133
    v_cvt_pk_bf16_f32 v35, v134, v135
    buffer_store_dwordx4 v[32:35], v2, s[16:19], 0 offen offset:0
    v_cvt_pk_bf16_f32 v36, v136, v137
    v_cvt_pk_bf16_f32 v37, v138, v139
    v_cvt_pk_bf16_f32 v38, v140, v141
    v_cvt_pk_bf16_f32 v39, v142, v143
    buffer_store_dwordx4 v[36:39], v2, s[16:19], 0 offen offset:32
    v_cvt_pk_bf16_f32 v40, v144, v145
    v_cvt_pk_bf16_f32 v41, v146, v147
    v_cvt_pk_bf16_f32 v42, v148, v149
    v_cvt_pk_bf16_f32 v43, v150, v151
    buffer_store_dwordx4 v[40:43], v2, s[16:19], 0 offen offset:64
    v_cvt_pk_bf16_f32 v44, v152, v153
    v_cvt_pk_bf16_f32 v45, v154, v155
    v_cvt_pk_bf16_f32 v46, v156, v157
    v_cvt_pk_bf16_f32 v47, v158, v159
    buffer_store_dwordx4 v[44:47], v2, s[16:19], 0 offen offset:96
    v_cvt_pk_bf16_f32 v48, v160, v161
    v_cvt_pk_bf16_f32 v49, v162, v163
    v_cvt_pk_bf16_f32 v50, v164, v165
    v_cvt_pk_bf16_f32 v51, v166, v167
    buffer_store_dwordx4 v[48:51], v2, s[16:19], 0 offen offset:128
    v_cvt_pk_bf16_f32 v52, v168, v169
    v_cvt_pk_bf16_f32 v53, v170, v171
    v_cvt_pk_bf16_f32 v54, v172, v173
    v_cvt_pk_bf16_f32 v55, v174, v175
    buffer_store_dwordx4 v[52:55], v2, s[16:19], 0 offen offset:160
    v_cvt_pk_bf16_f32 v56, v176, v177
    v_cvt_pk_bf16_f32 v57, v178, v179
    v_cvt_pk_bf16_f32 v58, v180, v181
    v_cvt_pk_bf16_f32 v59, v182, v183
    buffer_store_dwordx4 v[56:59], v2, s[16:19], 0 offen offset:192
    v_cvt_pk_bf16_f32 v60, v184, v185
    v_cvt_pk_bf16_f32 v61, v186, v187
    v_cvt_pk_bf16_f32 v62, v188, v189
    v_cvt_pk_bf16_f32 v63, v190, v191
    buffer_store_dwordx4 v[60:63], v2, s[16:19], 0 offen offset:224
    v_cvt_pk_bf16_f32 v32, v192, v193
    v_cvt_pk_bf16_f32 v33, v194, v195
    v_cvt_pk_bf16_f32 v34, v196, v197
    v_cvt_pk_bf16_f32 v35, v198, v199
    buffer_store_dwordx4 v[32:35], v3, s[16:19], 0 offen offset:0
    v_cvt_pk_bf16_f32 v36, v200, v201
    v_cvt_pk_bf16_f32 v37, v202, v203
    v_cvt_pk_bf16_f32 v38, v204, v205
    v_cvt_pk_bf16_f32 v39, v206, v207
    buffer_store_dwordx4 v[36:39], v3, s[16:19], 0 offen offset:32
    v_cvt_pk_bf16_f32 v40, v208, v209
    v_cvt_pk_bf16_f32 v41, v210, v211
    v_cvt_pk_bf16_f32 v42, v212, v213
    v_cvt_pk_bf16_f32 v43, v214, v215
    buffer_store_dwordx4 v[40:43], v3, s[16:19], 0 offen offset:64
    v_cvt_pk_bf16_f32 v44, v216, v217
    v_cvt_pk_bf16_f32 v45, v218, v219
    v_cvt_pk_bf16_f32 v46, v220, v221
    v_cvt_pk_bf16_f32 v47, v222, v223
    buffer_store_dwordx4 v[44:47], v3, s[16:19], 0 offen offset:96
    v_cvt_pk_bf16_f32 v48, v224, v225
    v_cvt_pk_bf16_f32 v49, v226, v227
    v_cvt_pk_bf16_f32 v50, v228, v229
    v_cvt_pk_bf16_f32 v51, v230, v231
    buffer_store_dwordx4 v[48:51], v3, s[16:19], 0 offen offset:128
    v_cvt_pk_bf16_f32 v52, v232, v233
    v_cvt_pk_bf16_f32 v53, v234, v235
    v_cvt_pk_bf16_f32 v54, v236, v237
    v_cvt_pk_bf16_f32 v55, v238, v239
    buffer_store_dwordx4 v[52:55], v3, s[16:19], 0 offen offset:160
    v_cvt_pk_bf16_f32 v56, v240, v241
    v_cvt_pk_bf16_f32 v57, v242, v243
    v_cvt_pk_bf16_f32 v58, v244, v245
    v_cvt_pk_bf16_f32 v59, v246, v247
    buffer_store_dwordx4 v[56:59], v3, s[16:19], 0 offen offset:192
    v_cvt_pk_bf16_f32 v60, v248, v249
    v_cvt_pk_bf16_f32 v61, v250, v251
    v_cvt_pk_bf16_f32 v62, v252, v253
    v_cvt_pk_bf16_f32 v63, v254, v255
    buffer_store_dwordx4 v[60:63], v3, s[16:19], 0 offen offset:224
    s_endpgm
k1_Nst:
    v_and_b32 v2, 31, v1
    v_lshlrev_b32 v2, 5, v2
    v_lshl_add_u32 v2, v8, 4, v2
    s_lshl_b32 s36, s29, 18
    s_add_u32 s36, s36, s33
    s_lshl_b32 s37, s28, 7
    s_add_u32 s37, s37, s30
    s_lshl_b32 s37, s37, 6
    s_add_u32 s36, s36, s37
    v_add_u32 v2, s36, v2
    v_add_u32 v3, 4096, v2
    v_add_u32 v4, 131072, v2
    v_add_u32 v5, 135168, v2
    v_cvt_pk_bf16_f32 v32, v128, v129
    v_cvt_pk_bf16_f32 v33, v130, v131
    v_cvt_pk_bf16_f32 v34, v132, v133
    v_cvt_pk_bf16_f32 v35, v134, v135
    buffer_store_dwordx4 v[32:35], v2, s[16:19], 0 offen offset:0
    v_cvt_pk_bf16_f32 v36, v136, v137
    v_cvt_pk_bf16_f32 v37, v138, v139
    v_cvt_pk_bf16_f32 v38, v140, v141
    v_cvt_pk_bf16_f32 v39, v142, v143
    buffer_store_dwordx4 v[36:39], v2, s[16:19], 0 offen offset:1024
    v_cvt_pk_bf16_f32 v40, v144, v145
    v_cvt_pk_bf16_f32 v41, v146, v147
    v_cvt_pk_bf16_f32 v42, v148, v149
    v_cvt_pk_bf16_f32 v43, v150, v151
    buffer_store_dwordx4 v[40:43], v2, s[16:19], 0 offen offset:2048
    v_cvt_pk_bf16_f32 v44, v152, v153
    v_cvt_pk_bf16_f32 v45, v154, v155
    v_cvt_pk_bf16_f32 v46, v156, v157
    v_cvt_pk_bf16_f32 v47, v158, v159
    buffer_store_dwordx4 v[44:47], v2, s[16:19], 0 offen offset:3072
    v_cvt_pk_bf16_f32 v48, v160, v161
    v_cvt_pk_bf16_f32 v49, v162, v163
    v_cvt_pk_bf16_f32 v50, v164, v165
    v_cvt_pk_bf16_f32 v51, v166, v167
    buffer_store_dwordx4 v[48:51], v3, s[16:19], 0 offen offset:0
    v_cvt_pk_bf16_f32 v52, v168, v169
    v_cvt_pk_bf16_f32 v53, v170, v171
    v_cvt_pk_bf16_f32 v54, v172, v173
    v_cvt_pk_bf16_f32 v55, v174, v175
    buffer_store_dwordx4 v[52:55], v3, s[16:19], 0 offen offset:1024
    v_cvt_pk_bf16_f32 v56, v176, v177
    v_cvt_pk_bf16_f32 v57, v178, v179
    v_cvt_pk_bf16_f32 v58, v180, v181
    v_cvt_pk_bf16_f32 v59, v182, v183
    buffer_store_dwordx4 v[56:59], v3, s[16:19], 0 offen offset:2048
    v_cvt_pk_bf16_f32 v60, v184, v185
    v_cvt_pk_bf16_f32 v61, v186, v187
    v_cvt_pk_bf16_f32 v62, v188, v189
    v_cvt_pk_bf16_f32 v63, v190, v191
    buffer_store_dwordx4 v[60:63], v3, s[16:19], 0 offen offset:3072
    v_cvt_pk_bf16_f32 v32, v192, v193
    v_cvt_pk_bf16_f32 v33, v194, v195
    v_cvt_pk_bf16_f32 v34, v196, v197
    v_cvt_pk_bf16_f32 v35, v198, v199
    buffer_store_dwordx4 v[32:35], v4, s[16:19], 0 offen offset:0
    v_cvt_pk_bf16_f32 v36, v200, v201
    v_cvt_pk_bf16_f32 v37, v202, v203
    v_cvt_pk_bf16_f32 v38, v204, v205
    v_cvt_pk_bf16_f32 v39, v206, v207
    buffer_store_dwordx4 v[36:39], v4, s[16:19], 0 offen offset:1024
    v_cvt_pk_bf16_f32 v40, v208, v209
    v_cvt_pk_bf16_f32 v41, v210, v211
    v_cvt_pk_bf16_f32 v42, v212, v213
    v_cvt_pk_bf16_f32 v43, v214, v215
    buffer_store_dwordx4 v[40:43], v4, s[16:19], 0 offen offset:2048
    v_cvt_pk_bf16_f32 v44, v216, v217
    v_cvt_pk_bf16_f32 v45, v218, v219
    v_cvt_pk_bf16_f32 v46, v220, v221
    v_cvt_pk_bf16_f32 v47, v222, v223
    buffer_store_dwordx4 v[44:47], v4, s[16:19], 0 offen offset:3072
    v_cvt_pk_bf16_f32 v48, v224, v225
    v_cvt_pk_bf16_f32 v49, v226, v227
    v_cvt_pk_bf16_f32 v50, v228, v229
    v_cvt_pk_bf16_f32 v51, v230, v231
    buffer_store_dwordx4 v[48:51], v5, s[16:19], 0 offen offset:0
    v_cvt_pk_bf16_f32 v52, v232, v233
    v_cvt_pk_bf16_f32 v53, v234, v235
    v_cvt_pk_bf16_f32 v54, v236, v237
    v_cvt_pk_bf16_f32 v55, v238, v239
    buffer_store_dwordx4 v[52:55], v5, s[16:19], 0 offen offset:1024
    v_cvt_pk_bf16_f32 v56, v240, v241
    v_cvt_pk_bf16_f32 v57, v242, v243
    v_cvt_pk_bf16_f32 v58, v244, v245
    v_cvt_pk_bf16_f32 v59, v246, v247
    buffer_store_dwordx4 v[56:59], v5, s[16:19], 0 offen offset:2048
    v_cvt_pk_bf16_f32 v60, v248, v249
    v_cvt_pk_bf16_f32 v61, v250, v251
    v_cvt_pk_bf16_f32 v62, v252, v253
    v_cvt_pk_bf16_f32 v63, v254, v255
    buffer_store_dwordx4 v[60:63], v5, s[16:19], 0 offen offset:3072
    s_endpgm
k1_T:
    v_and_b32 v1, 63, v0
    v_lshrrev_b32 v2, 6, v0
    s_nop 0
    v_readfirstlane_b32 s27, v2
    s_lshl_b32 s26, s27, 12
    s_lshr_b32 s28, s27, 2
    s_and_b32 s29, s27, 3
    v_lshrrev_b32 v2, 3, v1
    v_and_b32 v3, 7, v1
    v_lshrrev_b32 v4, 4, v1
    v_and_b32 v5, 15, v1
    s_lshl_b32 s36, s27, 5
    s_add_u32 s36, s36, 0
    s_add_u32 s36, s36, s30
    v_add_u32 v6, s36, v2
    v_add_u32 v7, 0, v4
    v_xor_b32 v7, v7, v3
    v_mul_lo_u32 v6, v6, s20
    v_lshlrev_b32 v7, 4, v7
    v_add3_u32 v10, v6, v7, s41
    s_lshl_b32 s36, s27, 5
    s_add_u32 s36, s36, 8
    s_add_u32 s36, s36, s30
    v_add_u32 v6, s36, v2
    v_add_u32 v7, 4, v4
    v_xor_b32 v7, v7, v3
    v_mul_lo_u32 v6, v6, s20
    v_lshlrev_b32 v7, 4, v7
    v_add3_u32 v11, v6, v7, s41
    s_lshl_b32 s36, s27, 5
    s_add_u32 s36, s36, 16
    s_add_u32 s36, s36, s30
    v_add_u32 v6, s36, v2
    v_add_u32 v7, 0, v4
    v_xor_b32 v7, v7, v3
    v_mul_lo_u32 v6, v6, s20
    v_lshlrev_b32 v7, 4, v7
    v_add3_u32 v12, v6, v7, s41
    s_lshl_b32 s36, s27, 5
    s_add_u32 s36, s36, 24
    s_add_u32 s36, s36, s30
    v_add_u32 v6, s36, v2
    v_add_u32 v7, 4, v4
    v_xor_b32 v7, v7, v3
    v_mul_lo_u32 v6, v6, s20
    v_lshlrev_b32 v7, 4, v7
    v_add3_u32 v13, v6, v7, s41
    v_lshlrev_b32 v7, 2, v4
    v_xor_b32 v7, v7, v5
    v_lshlrev_b32 v7, 4, v7
    s_lshl_b32 s37, s28, 7
    s_add_u32 s37, s37, s31
    s_lshl_b32 s37, s37, 1
    s_lshl_b32 s36, s29, 4
    s_add_u32 s36, s36, 0
    v_add_u32 v6, s36, v4
    v_mul_lo_u32 v6, v6, s21
    v_add3_u32 v14, v6, v7, s37
    s_lshl_b32 s36, s29, 4
    s_add_u32 s36, s36, 4
    v_add_u32 v6, s36, v4
    v_mul_lo_u32 v6, v6, s21
    v_add3_u32 v15, v6, v7, s37
    s_lshl_b32 s36, s29, 4
    s_add_u32 s36, s36, 8
    v_add_u32 v6, s36, v4
    v_mul_lo_u32 v6, v6, s21
    v_add3_u32 v16, v6, v7, s37
    s_lshl_b32 s36, s29, 4
    s_add_u32 s36, s36, 12
    v_add_u32 v6, s36, v4
    v_mul_lo_u32 v6, v6, s21
    v_add3_u32 v17, v6, v7, s37
    s_add_u32 m0, s26, 0
    s_nop 0
    buffer_load_dwordx4 v10, s[8:11], s23 offen lds
    s_add_u32 m0, s26, 1024
    s_nop 0
    buffer_load_dwordx4 v11, s[8:11], s23 offen lds
    s_add_u32 m0, s26, 2048
    s_nop 0
    buffer_load_dwordx4 v12, s[8:11], s23 offen lds
    s_add_u32 m0, s26, 3072
    s_nop 0
    buffer_load_dwordx4 v13, s[8:11], s23 offen lds
    s_add_u32 m0, s26, 32768
    s_nop 0
    buffer_load_dwordx4 v14, s[12:15], s24 offen lds
    s_add_u32 m0, s26, 33792
    s_nop 0
    buffer_load_dwordx4 v15, s[12:15], s24 offen lds
    s_add_u32 m0, s26, 34816
    s_nop 0
    buffer_load_dwordx4 v16, s[12:15], s24 offen lds
    s_add_u32 m0, s26, 35840
    s_nop 0
    buffer_load_dwordx4 v17, s[12:15], s24 offen lds
    s_add_u32 s23, s23, 128
    s_add_u32 s24, s24, s25
    s_add_u32 m0, s26, 65536
    s_nop 0
    buffer_load_dwordx4 v10, s[8:11], s23 offen lds
    s_add_u32 m0, s26, 66560
    s_nop 0
    buffer_load_dwordx4 v11, s[8:11], s23 offen lds
    s_add_u32 m0, s26, 67584
    s_nop 0
    buffer_load_dwordx4 v12, s[8:11], s23 offen lds
    s_add_u32 m0, s26, 68608
    s_nop 0
    buffer_load_dwordx4 v13, s[8:11], s23 offen lds
    s_add_u32 m0, s26, 98304
    s_nop 0
    buffer_load_dwordx4 v14, s[12:15], s24 offen lds
    s_add_u32 m0, s26, 99328
    s_nop 0
    buffer_load_dwordx4 v15, s[12:15], s24 offen lds
    s_add_u32 m0, s26, 100352
    s_nop 0
    buffer_load_dwordx4 v16, s[12:15], s24 offen lds
    s_add_u32 m0, s26, 101376
    s_nop 0
    buffer_load_dwordx4 v17, s[12:15], s24 offen lds
    s_add_u32 s23, s23, 128
    s_add_u32 s24, s24, s25
    v_and_b32 v6, 31, v1
    v_lshrrev_b32 v8, 5, v1
    v_bfe_u32 v7, v6, 1, 3
    v_xor_b32 v7, v7, v8
    v_lshlrev_b32 v6, 7, v6
    s_lshl_b32 s36, s28, 14
    v_add_u32 v6, s36, v6
    v_xor_b32 v9, 0, v7
    v_lshl_add_u32 v18, v9, 4, v6
    v_add_u32 v22, 65536, v18
    v_xor_b32 v9, 2, v7
    v_lshl_add_u32 v19, v9, 4, v6
    v_add_u32 v23, 65536, v19
    v_xor_b32 v9, 4, v7
    v_lshl_add_u32 v20, v9, 4, v6
    v_add_u32 v24, 65536, v20
    v_xor_b32 v9, 6, v7
    v_lshl_add_u32 v21, v9, 4, v6
    v_add_u32 v25, 65536, v21
    v_bfe_u32 v6, v1, 2, 2
    v_and_b32 v7, 3, v1
    v_bfe_u32 v9, v1, 4, 1
    v_lshlrev_b32 v40, 3, v8
    v_add_u32 v40, v40, v6
    v_lshlrev_b32 v40, 8, v40
    v_lshrrev_b32 v41, 1, v7
    v_lshl_add_u32 v41, v9, 1, v41
    s_and_b32 s36, s29, 1
    s_lshl_b32 s36, s36, 3
    v_add_u32 v41, s36, v41
    v_lshlrev_b32 v42, 2, v6
    v_xor_b32 v41, v41, v42
    v_and_b32 v7, 1, v7
    v_lshl_add_u32 v40, v7, 3, v40
    s_lshr_b32 s36, s29, 1
    s_lshl_b32 s36, s36, 14
    s_add_u32 s36, s36, 32768
    v_add_u32 v40, s36, v40
    v_xor_b32 v42, 0, v41
    v_lshl_add_u32 v30, v42, 4, v40
    v_add_u32 v32, 65536, v30
    v_xor_b32 v42, 4, v41
    v_lshl_add_u32 v31, v42, 4, v40
    v_add_u32 v33, 65536, v31
    v_mov_b32 v128, 0
    v_mov_b32 v129, 0
    v_mov_b32 v130, 0
    v_mov_b32 v131, 0
    v_mov_b32 v132, 0
    v_mov_b32 v133, 0
    v_mov_b32 v134, 0
    v_mov_b32 v135, 0
    v_mov_b32 v136, 0
    v_mov_b32 v137, 0
    v_mov_b32 v138, 0
    v_mov_b32 v139, 0
    v_mov_b32 v140, 0
    v_mov_b32 v141, 0
    v_mov_b32 v142, 0
    v_mov_b32 v143, 0
    v_mov_b32 v144, 0
    v_mov_b32 v145, 0
    v_mov_b32 v146, 0
    v_mov_b32 v147, 0
    v_mov_b32 v148, 0
    v_mov_b32 v149, 0
    v_mov_b32 v150, 0
    v_mov_b32 v151, 0
    v_mov_b32 v152, 0
    v_mov_b32 v153, 0
    v_mov_b32 v154, 0
    v_mov_b32 v155, 0
    v_mov_b32 v156, 0
    v_mov_b32 v157, 0
    v_mov_b32 v158, 0
    v_mov_b32 v159, 0
    v_mov_b32 v160, 0
    v_mov_b32 v161, 0
    v_mov_b32 v162, 0
    v_mov_b32 v163, 0
    v_mov_b32 v164, 0
    v_mov_b32 v165, 0
    v_mov_b32 v166, 0
    v_mov_b32 v167, 0
    v_mov_b32 v168, 0
    v_mov_b32 v169, 0
    v_mov_b32 v170, 0
    v_mov_b32 v171, 0
    v_mov_b32 v172, 0
    v_mov_b32 v173, 0
    v_mov_b32 v174, 0
    v_mov_b32 v175, 0
    v_mov_b32 v176, 0
    v_mov_b32 v177, 0
    v_mov_b32 v178, 0
    v_mov_b32 v179, 0
    v_mov_b32 v180, 0
    v_mov_b32 v181, 0
    v_mov_b32 v182, 0
    v_mov_b32 v183, 0
    v_mov_b32 v184, 0
    v_mov_b32 v185, 0
    v_mov_b32 v186, 0
    v_mov_b32 v187, 0
    v_mov_b32 v188, 0
    v_mov_b32 v189, 0
    v_mov_b32 v190, 0
    v_mov_b32 v191, 0
    v_mov_b32 v192, 0
    v_mov_b32 v193, 0
    v_mov_b32 v194, 0
    v_mov_b32 v195, 0
    v_mov_b32 v196, 0
    v_mov_b32 v197, 0
    v_mov_b32 v198, 0
    v_mov_b32 v199, 0
    v_mov_b32 v200, 0
    v_mov_b32 v201, 0
    v_mov_b32 v202, 0
    v_mov_b32 v203, 0
    v_mov_b32 v204, 0
    v_mov_b32 v205, 0
    v_mov_b32 v206, 0
    v_mov_b32 v207, 0
    v_mov_b32 v208, 0
    v_mov_b32 v209, 0
    v_mov_b32 v210, 0
    v_mov_b32 v211, 0
    v_mov_b32 v212, 0
    v_mov_b32 v213, 0
    v_mov_b32 v214, 0
    v_mov_b32 v215, 0
    v_mov_b32 v216, 0
    v_mov_b32 v217, 0
    v_mov_b32 v218, 0
    v_mov_b32 v219, 0
    v_mov_b32 v220, 0
    v_mov_b32 v221, 0
    v_mov_b32 v222, 0
    v_mov_b32 v223, 0
    v_mov_b32 v224, 0
    v_mov_b32 v225, 0
    v_mov_b32 v226, 0
    v_mov_b32 v227, 0
    v_mov_b32 v228, 0
    v_mov_b32 v229, 0
    v_mov_b32 v230, 0
    v_mov_b32 v231, 0
    v_mov_b32 v232, 0
    v_mov_b32 v233, 0
    v_mov_b32 v234, 0
    v_mov_b32 v235, 0
    v_mov_b32 v236, 0
    v_mov_b32 v237, 0
    v_mov_b32 v238, 0
    v_mov_b32 v239, 0
    v_mov_b32 v240, 0
    v_mov_b32 v241, 0
    v_mov_b32 v242, 0
    v_mov_b32 v243, 0
    v_mov_b32 v244, 0
    v_mov_b32 v245, 0
    v_mov_b32 v246, 0
    v_mov_b32 v247, 0
    v_mov_b32 v248, 0
    v_mov_b32 v249, 0
    v_mov_b32 v250, 0
    v_mov_b32 v251, 0
    v_mov_b32 v252, 0
    v_mov_b32 v253, 0
    v_mov_b32 v254, 0
    v_mov_b32 v255, 0
    s_mov_b64 vcc, 0
    s_waitcnt vmcnt(8)
    s_barrier
    ds_read_b64_tr_b16 v[80:81], v30 offset:0
    ds_read_b64_tr_b16 v[82:83], v30 offset:1024
    ds_read_b64_tr_b16 v[84:85], v31 offset:0
    ds_read_b64_tr_b16 v[86:87], v31 offset:1024
    ds_read_b128 v[64:67], v18 offset:0
    ds_read_b128 v[68:71], v18 offset:4096
    ds_read_b128 v[72:75], v18 offset:8192
    ds_read_b128 v[76:79], v18 offset:12288
gl_19:
    ds_read_b64_tr_b16 v[104:105], v30 offset:4096
    ds_read_b64_tr_b16 v[106:107], v30 offset:5120
    ds_read_b64_tr_b16 v[108:109], v31 offset:4096
    ds_read_b64_tr_b16 v[110:111], v31 offset:5120
    ds_read_b128 v[88:91], v19 offset:0
    ds_read_b128 v[92:95], v19 offset:4096
    ds_read_b128 v[96:99], v19 offset:8192
    ds_read_b128 v[100:103], v19 offset:12288
    s_waitcnt lgkmcnt(11)
    v_mfma_f32_32x32x16_bf16 v[128:143], v[80:83], v[64:67], v[128:143]
    v_mfma_f32_32x32x16_bf16 v[192:207], v[84:87], v[64:67], v[192:207]
    s_cbranch_vccz gn_21
    s_add_u32 m0, s26, 67584
    s_nop 0
    buffer_load_dwordx4 v12, s[8:11], s23 offen lds
gn_21:
    s_waitcnt lgkmcnt(10)
    v_mfma_f32_32x32x16_bf16 v[144:159], v[80:83], v[68:71], v[144:159]
    v_mfma_f32_32x32x16_bf16 v[208:223], v[84:87], v[68:71], v[208:223]
    s_cbranch_vccz gn_22
    s_add_u32 m0, s26, 68608
    s_nop 0
    buffer_load_dwordx4 v13, s[8:11], s23 offen lds
gn_22:
    s_waitcnt lgkmcnt(9)
    v_mfma_f32_32x32x16_bf16 v[160:175], v[80:83], v[72:75], v[160:175]
    v_mfma_f32_32x32x16_bf16 v[224:239], v[84:87], v[72:75], v[224:239]
    s_cbranch_vccz gn_23
    s_add_u32 m0, s26, 98304
    s_nop 0
    buffer_load_dwordx4 v14, s[12:15], s24 offen lds
gn_23:
    s_waitcnt lgkmcnt(8)
    v_mfma_f32_32x32x16_bf16 v[176:191], v[80:83], v[76:79], v[176:191]
    v_mfma_f32_32x32x16_bf16 v[240:255], v[84:87], v[76:79], v[240:255]
    s_cbranch_vccz gn_24
    s_add_u32 m0, s26, 99328
    s_nop 0
    buffer_load_dwordx4 v15, s[12:15], s24 offen lds
gn_24:
    ds_read_b64_tr_b16 v[80:81], v30 offset:8192
    ds_read_b64_tr_b16 v[82:83], v30 offset:9216
    ds_read_b64_tr_b16 v[84:85], v31 offset:8192
    ds_read_b64_tr_b16 v[86:87], v31 offset:9216
    ds_read_b128 v[64:67], v20 offset:0
    ds_read_b128 v[68:71], v20 offset:4096
    ds_read_b128 v[72:75], v20 offset:8192
    ds_read_b128 v[76:79], v20 offset:12288
    s_waitcnt lgkmcnt(11)
    v_mfma_f32_32x32x16_bf16 v[128:143], v[104:107], v[88:91], v[128:143]
    v_mfma_f32_32x32x16_bf16 v[192:207], v[108:111], v[88:91], v[192:207]
    s_cbranch_vccz gn_25
    s_add_u32 m0, s26, 100352
    s_nop 0
    buffer_load_dwordx4 v16, s[12:15], s24 offen lds
gn_25:
    s_waitcnt lgkmcnt(10)
    v_mfma_f32_32x32x16_bf16 v[144:159], v[104:107], v[92:95], v[144:159]
    v_mfma_f32_32x32x16_bf16 v[208:223], v[108:111], v[92:95], v[208:223]
    s_cbranch_vccz gn_26
    s_add_u32 m0, s26, 101376
    s_nop 0
    buffer_load_dwordx4 v17, s[12:15], s24 offen lds
    s_add_u32 s23, s23, 128
    s_add_u32 s24, s24, s25
gn_26:
    s_waitcnt lgkmcnt(9)
    v_mfma_f32_32x32x16_bf16 v[160:175], v[104:107], v[96:99], v[160:175]
    v_mfma_f32_32x32x16_bf16 v[224:239], v[108:111], v[96:99], v[224:239]
    s_waitcnt lgkmcnt(8)
    v_mfma_f32_32x32x16_bf16 v[176:191], v[104:107], v[100:103], v[176:191]
    v_mfma_f32_32x32x16_bf16 v[240:255], v[108:111], v[100:103], v[240:255]
    ds_read_b64_tr_b16 v[104:105], v30 offset:12288
    ds_read_b64_tr_b16 v[106:107], v30 offset:13312
    ds_read_b64_tr_b16 v[108:109], v31 offset:12288
    ds_read_b64_tr_b16 v[110:111], v31 offset:13312
    ds_read_b128 v[88:91], v21 offset:0
    ds_read_b128 v[92:95], v21 offset:4096
    ds_read_b128 v[96:99], v21 offset:8192
    ds_read_b128 v[100:103], v21 offset:12288
    s_waitcnt lgkmcnt(11)
    v_mfma_f32_32x32x16_bf16 v[128:143], v[80:83], v[64:67], v[128:143]
    v_mfma_f32_32x32x16_bf16 v[192:207], v[84:87], v[64:67], v[192:207]
    s_waitcnt lgkmcnt(10)
    v_mfma_f32_32x32x16_bf16 v[144:159], v[80:83], v[68:71], v[144:159]
    v_mfma_f32_32x32x16_bf16 v[208:223], v[84:87], v[68:71], v[208:223]
    s_waitcnt lgkmcnt(9)
    v_mfma_f32_32x32x16_bf16 v[160:175], v[80:83], v[72:75], v[160:175]
    v_mfma_f32_32x32x16_bf16 v[224:239], v[84:87], v[72:75], v[224:239]
    s_waitcnt lgkmcnt(8)
    v_mfma_f32_32x32x16_bf16 v[176:191], v[80:83], v[76:79], v[176:191]
    v_mfma_f32_32x32x16_bf16 v[240:255], v[84:87], v[76:79], v[240:255]
    s_waitcnt lgkmcnt(3)
    v_mfma_f32_32x32x16_bf16 v[128:143], v[104:107], v[88:91], v[128:143]
    v_mfma_f32_32x32x16_bf16 v[192:207], v[108:111], v[88:91], v[192:207]
    s_waitcnt lgkmcnt(2)
    v_mfma_f32_32x32x16_bf16 v[144:159], v[104:107], v[92:95], v[144:159]
    v_mfma_f32_32x32x16_bf16 v[208:223], v[108:111], v[92:95], v[208:223]
    s_cmp_le_u32 s22, 1
    s_waitcnt lgkmcnt(0)
    s_cbranch_scc1 ge_20
    s_waitcnt vmcnt(0)
    s_cmp_gt_u32 s22, 2
    s_cselect_b64 vcc, -1, 0
    s_barrier
    ds_read_b64_tr_b16 v[80:81], v32 offset:0
    ds_read_b64_tr_b16 v[82:83], v32 offset:1024
    ds_read_b64_tr_b16 v[84:85], v33 offset:0
    ds_read_b64_tr_b16 v[86:87], v33 offset:1024
    ds_read_b128 v[64:67], v22 offset:0
    ds_read_b128 v[68:71], v22 offset:4096
    ds_read_b128 v[72:75], v22 offset:8192
    ds_read_b128 v[76:79], v22 offset:12288
    v_mfma_f32_32x32x16_bf16 v[160:175], v[104:107], v[96:99], v[160:175]
    v_mfma_f32_32x32x16_bf16 v[224:239], v[108:111], v[96:99], v[224:239]
    s_cbranch_vccz gn_27
    s_add_u32 m0, s26, 0
    s_nop 0
    buffer_load_dwordx4 v10, s[8:11], s23 offen lds
gn_27:
    v_mfma_f32_32x32x16_bf16 v[176:191], v[104:107], v[100:103], v[176:191]
    v_mfma_f32_32x32x16_bf16 v[240:255], v[108:111], v[100:103], v[240:255]
    s_cbranch_vccz gn_28
    s_add_u32 m0, s26, 1024
    s_nop 0
    buffer_load_dwordx4 v11, s[8:11], s23 offen lds
gn_28:
    s_sub_u32 s22, s22, 1
    ds_read_b64_tr_b16 v[104:105], v32 offset:4096
    ds_read_b64_tr_b16 v[106:107], v32 offset:5120
    ds_read_b64_tr_b16 v[108:109], v33 offset:4096
    ds_read_b64_tr_b16 v[110:111], v33 offset:5120
    ds_read_b128 v[88:91], v23 offset:0
    ds_read_b128 v[92:95], v23 offset:4096
    ds_read_b128 v[96:99], v23 offset:8192
    ds_read_b128 v[100:103], v23 offset:12288
    s_waitcnt lgkmcnt(11)
    v_mfma_f32_32x32x16_bf16 v[128:143], v[80:83], v[64:67], v[128:143]
    v_mfma_f32_32x32x16_bf16 v[192:207], v[84:87], v[64:67], v[192:207]
    s_cbranch_vccz gn_29
    s_add_u32 m0, s26, 2048
    s_nop 0
    buffer_load_dwordx4 v12, s[8:11], s23 offen lds
gn_29:
    s_waitcnt lgkmcnt(10)
    v_mfma_f32_32x32x16_bf16 v[144:159], v[80:83], v[68:71], v[144:159]
    v_mfma_f32_32x32x16_bf16 v[208:223], v[84:87], v[68:71], v[208:223]
    s_cbranch_vccz gn_30
    s_add_u32 m0, s26, 3072
    s_nop 0
    buffer_load_dwordx4 v13, s[8:11], s23 offen lds
gn_30:
    s_waitcnt lgkmcnt(9)
    v_mfma_f32_32x32x16_bf16 v[160:175], v[80:83], v[72:75], v[160:175]
    v_mfma_f32_32x32x16_bf16 v[224:239], v[84:87], v[72:75], v[224:239]
    s_cbranch_vccz gn_31
    s_add_u32 m0, s26, 32768
    s_nop 0
    buffer_load_dwordx4 v14, s[12:15], s24 offen lds
gn_31:
    s_waitcnt lgkmcnt(8)
    v_mfma_f32_32x32x16_bf16 v[176:191], v[80:83], v[76:79], v[176:191]
    v_mfma_f32_32x32x16_bf16 v[240:255], v[84:87], v[76:79], v[240:255]
    s_cbranch_vccz gn_32
    s_add_u32 m0, s26, 33792
    s_nop 0
    buffer_load_dwordx4 v15, s[12:15], s24 offen lds
gn_32:
    ds_read_b64_tr_b16 v[80:81], v32 offset:8192
    ds_read_b64_tr_b16 v[82:83], v32 offset:9216
    ds_read_b64_tr_b16 v[84:85], v33 offset:8192
    ds_read_b64_tr_b16 v[86:87], v33 offset:9216
    ds_read_b128 v[64:67], v24 offset:0
    ds_read_b128 v[68:71], v24 offset:4096
    ds_read_b128 v[72:75], v24 offset:8192
    ds_read_b128 v[76:79], v24 offset:12288
    s_waitcnt lgkmcnt(11)
    v_mfma_f32_32x32x16_bf16 v[128:143], v[104:107], v[88:91], v[128:143]
    v_mfma_f32_32x32x16_bf16 v[192:207], v[108:111], v[88:91], v[192:207]
    s_cbranch_vccz gn_33
    s_add_u32 m0, s26, 34816
    s_nop 0
    buffer_load_dwordx4 v16, s[12:15], s24 offen lds
gn_33:
    s_waitcnt lgkmcnt(10)
    v_mfma_f32_32x32x16_bf16 v[144:159], v[104:107], v[92:95], v[144:159]
    v_mfma_f32_32x32x16_bf16 v[208:223], v[108:111], v[92:95], v[208:223]
    s_cbranch_vccz gn_34
    s_add_u32 m0, s26, 35840
    s_nop 0
    buffer_load_dwordx4 v17, s[12:15], s24 offen lds
    s_add_u32 s23, s23, 128
    s_add_u32 s24, s24, s25
gn_34:
    s_waitcnt lgkmcnt(9)
    v_mfma_f32_32x32x16_bf16 v[160:175], v[104:107], v[96:99], v[160:175]
    v_mfma_f32_32x32x16_bf16 v[224:239], v[108:111], v[96:99], v[224:239]
    s_waitcnt lgkmcnt(8)
    v_mfma_f32_32x32x16_bf16 v[176:191], v[104:107], v[100:103], v[176:191]
    v_mfma_f32_32x32x16_bf16 v[240:255], v[108:111], v[100:103], v[240:255]
    ds_read_b64_tr_b16 v[104:105], v32 offset:12288
    ds_read_b64_tr_b16 v[106:107], v32 offset:13312
    ds_read_b64_tr_b16 v[108:109], v33 offset:12288
    ds_read_b64_tr_b16 v[110:111], v33 offset:13312
    ds_read_b128 v[88:91], v25 offset:0
    ds_read_b128 v[92:95], v25 offset:4096
    ds_read_b128 v[96:99], v25 offset:8192
    ds_read_b128 v[100:103], v25 offset:12288
    s_waitcnt lgkmcnt(11)
    v_mfma_f32_32x32x16_bf16 v[128:143], v[80:83], v[64:67], v[128:143]
    v_mfma_f32_32x32x16_bf16 v[192:207], v[84:87], v[64:67], v[192:207]
    s_waitcnt lgkmcnt(10)
    v_mfma_f32_32x32x16_bf16 v[144:159], v[80:83], v[68:71], v[144:159]
    v_mfma_f32_32x32x16_bf16 v[208:223], v[84:87], v[68:71], v[208:223]
    s_waitcnt lgkmcnt(9)
    v_mfma_f32_32x32x16_bf16 v[160:175], v[80:83], v[72:75], v[160:175]
    v_mfma_f32_32x32x16_bf16 v[224:239], v[84:87], v[72:75], v[224:239]
    s_waitcnt lgkmcnt(8)
    v_mfma_f32_32x32x16_bf16 v[176:191], v[80:83], v[76:79], v[176:191]
    v_mfma_f32_32x32x16_bf16 v[240:255], v[84:87], v[76:79], v[240:255]
    s_waitcnt lgkmcnt(3)
    v_mfma_f32_32x32x16_bf16 v[128:143], v[104:107], v[88:91], v[128:143]
    v_mfma_f32_32x32x16_bf16 v[192:207], v[108:111], v[88:91], v[192:207]
    s_waitcnt lgkmcnt(2)
    v_mfma_f32_32x32x16_bf16 v[144:159], v[104:107], v[92:95], v[144:159]
    v_mfma_f32_32x32x16_bf16 v[208:223], v[108:111], v[92:95], v[208:223]
    s_cmp_le_u32 s22, 1
    s_waitcnt lgkmcnt(0)
    s_cbranch_scc1 ge_20
    s_waitcnt vmcnt(0)
    s_cmp_gt_u32 s22, 2
    s_cselect_b64 vcc, -1, 0
    s_barrier
    ds_read_b64_tr_b16 v[80:81], v30 offset:0
    ds_read_b64_tr_b16 v[82:83], v30 offset:1024
    ds_read_b64_tr_b16 v[84:85], v31 offset:0
    ds_read_b64_tr_b16 v[86:87], v31 offset:1024
    ds_read_b128 v[64:67], v18 offset:0
    ds_read_b128 v[68:71], v18 offset:4096
    ds_read_b128 v[72:75], v18 offset:8192
    ds_read_b128 v[76:79], v18 offset:12288
    v_mfma_f32_32x32x16_bf16 v[160:175], v[104:107], v[96:99], v[160:175]
    v_mfma_f32_32x32x16_bf16 v[224:239], v[108:111], v[96:99], v[224:239]
    s_cbranch_vccz gn_35
    s_add_u32 m0, s26, 65536
    s_nop 0
    buffer_load_dwordx4 v10, s[8:11], s23 offen lds
gn_35:
    v_mfma_f32_32x32x16_bf16 v[176:191], v[104:107], v[100:103], v[176:191]
    v_mfma_f32_32x32x16_bf16 v[240:255], v[108:111], v[100:103], v[240:255]
    s_cbranch_vccz gn_36
    s_add_u32 m0, s26, 66560
    s_nop 0
    buffer_load_dwordx4 v11, s[8:11], s23 offen lds
gn_36:
    s_sub_u32 s22, s22, 1
    s_branch gl_19
ge_20:
    v_mfma_f32_32x32x16_bf16 v[160:175], v[104:107], v[96:99], v[160:175]
    v_mfma_f32_32x32x16_bf16 v[224:239], v[108:111], v[96:99], v[224:239]
    v_mfma_f32_32x32x16_bf16 v[176:191], v[104:107], v[100:103], v[176:191]
    v_mfma_f32_32x32x16_bf16 v[240:255], v[108:111], v[100:103], v[240:255]
    s_nop 15
    s_cmp_eq_u32 s32, 1
    s_cbranch_scc1 k1_compact
    v_and_b32 v2, 31, v1
    v_lshlrev_b32 v2, 5, v2
    v_lshl_add_u32 v2, v8, 4, v2
    s_lshl_b32 s36, s28, 7
    s_add_u32 s36, s36, s30
    s_mul_i32 s36, s36, 8192
    s_add_u32 s36, s36, s33
    s_lshl_b32 s37, s29, 12
    s_add_u32 s36, s36, s37
    v_add_u32 v2, s36, v2
    v_add_u32 v3, 262144, v2
    v_add_u32 v4, 524288, v2
    v_add_u32 v5, 786432, v2
    v_mul_f32 v128, s40, v128
    v_mul_f32 v129, s40, v129
    v_mul_f32 v130, s40, v130
    v_mul_f32 v131, s40, v131
    v_mul_f32 v132, s40, v132
    v_mul_f32 v133, s40, v133
    v_mul_f32 v134, s40, v134
    v_mul_f32 v135, s40, v135
    v_cvt_pk_bf16_f32 v32, v128, v129
    v_cvt_pk_bf16_f32 v33, v130, v131
    v_cvt_pk_bf16_f32 v34, v132, v133
    v_cvt_pk_bf16_f32 v35, v134, v135
    buffer_store_dwordx4 v[32:35], v2, s[16:19], 0 offen offset:0
    v_mul_f32 v136, s40, v136
    v_mul_f32 v137, s40, v137
    v_mul_f32 v138, s40, v138
    v_mul_f32 v139, s40, v139
    v_mul_f32 v140, s40, v140
    v_mul_f32 v141, s40, v141
    v_mul_f32 v142, s40, v142
    v_mul_f32 v143, s40, v143
    v_cvt_pk_bf16_f32 v36, v136, v137
    v_cvt_pk_bf16_f32 v37, v138, v139
    v_cvt_pk_bf16_f32 v38, v140, v141
    v_cvt_pk_bf16_f32 v39, v142, v143
    buffer_store_dwordx4 v[36:39], v2, s[16:19], 0 offen offset:1024
    v_mul_f32 v192, s40, v192
    v_mul_f32 v193, s40, v193
    v_mul_f32 v194, s40, v194
    v_mul_f32 v195, s40, v195
    v_mul_f32 v196, s40, v196
    v_mul_f32 v197, s40, v197
    v_mul_f32 v198, s40, v198
    v_mul_f32 v199, s40, v199
    v_cvt_pk_bf16_f32 v40, v192, v193
    v_cvt_pk_bf16_f32 v41, v194, v195
    v_cvt_pk_bf16_f32 v42, v196, v197
    v_cvt_pk_bf16_f32 v43, v198, v199
    buffer_store_dwordx4 v[40:43], v2, s[16:19], 0 offen offset:2048
    v_mul_f32 v200, s40, v200
    v_mul_f32 v201, s40, v201
    v_mul_f32 v202, s40, v202
    v_mul_f32 v203, s40, v203
    v_mul_f32 v204, s40, v204
    v_mul_f32 v205, s40, v205
    v_mul_f32 v206, s40, v206
    v_mul_f32 v207, s40, v207
    v_cvt_pk_bf16_f32 v44, v200, v201
    v_cvt_pk_bf16_f32 v45, v202, v203
    v_cvt_pk_bf16_f32 v46, v204, v205
    v_cvt_pk_bf16_f32 v47, v206, v207
    buffer_store_dwordx4 v[44:47], v2, s[16:19], 0 offen offset:3072
    v_mul_f32 v144, s40, v144
    v_mul_f32 v145, s40, v145
    v_mul_f32 v146, s40, v146
    v_mul_f32 v147, s40, v147
    v_mul_f32 v148, s40, v148
    v_mul_f32 v149, s40, v149
    v_mul_f32 v150, s40, v150
    v_mul_f32 v151, s40, v151
    v_cvt_pk_bf16_f32 v48, v144, v145
    v_cvt_pk_bf16_f32 v49, v146, v147
    v_cvt_pk_bf16_f32 v50, v148, v149
    v_cvt_pk_bf16_f32 v51, v150, v151
    buffer_store_dwordx4 v[48:51], v3, s[16:19], 0 offen offset:0
    v_mul_f32 v152, s40, v152
    v_mul_f32 v153, s40, v153
    v_mul_f32 v154, s40, v154
    v_mul_f32 v155, s40, v155
    v_mul_f32 v156, s40, v156
    v_mul_f32 v157, s40, v157
    v_mul_f32 v158, s40, v158
    v_mul_f32 v159, s40, v159
    v_cvt_pk_bf16_f32 v52, v152, v153
    v_cvt_pk_bf16_f32 v53, v154, v155
    v_cvt_pk_bf16_f32 v54, v156, v157
    v_cvt_pk_bf16_f32 v55, v158, v159
    buffer_store_dwordx4 v[52:55], v3, s[16:19], 0 offen offset:1024
    v_mul_f32 v208, s40, v208
    v_mul_f32 v209, s40, v209
    v_mul_f32 v210, s40, v210
    v_mul_f32 v211, s40, v211
    v_mul_f32 v212, s40, v212
    v_mul_f32 v213, s40, v213
    v_mul_f32 v214, s40, v214
    v_mul_f32 v215, s40, v215
    v_cvt_pk_bf16_f32 v56, v208, v209
    v_cvt_pk_bf16_f32 v57, v210, v211
    v_cvt_pk_bf16_f32 v58, v212, v213
    v_cvt_pk_bf16_f32 v59, v214, v215
    buffer_store_dwordx4 v[56:59], v3, s[16:19], 0 offen offset:2048
    v_mul_f32 v216, s40, v216
    v_mul_f32 v217, s40, v217
    v_mul_f32 v218, s40, v218
    v_mul_f32 v219, s40, v219
    v_mul_f32 v220, s40, v220
    v_mul_f32 v221, s40, v221
    v_mul_f32 v222, s40, v222
    v_mul_f32 v223, s40, v223
    v_cvt_pk_bf16_f32 v60, v216, v217
    v_cvt_pk_bf16_f32 v61, v218, v219
    v_cvt_pk_bf16_f32 v62, v220, v221
    v_cvt_pk_bf16_f32 v63, v222, v223
    buffer_store_dwordx4 v[60:63], v3, s[16:19], 0 offen offset:3072
    v_mul_f32 v160, s40, v160
    v_mul_f32 v161, s40, v161
    v_mul_f32 v162, s40, v162
    v_mul_f32 v163, s40, v163
    v_mul_f32 v164, s40, v164
    v_mul_f32 v165, s40, v165
    v_mul_f32 v166, s40, v166
    v_mul_f32 v167, s40, v167
    v_cvt_pk_bf16_f32 v32, v160, v161
    v_cvt_pk_bf16_f32 v33, v162, v163
    v_cvt_pk_bf16_f32 v34, v164, v165
    v_cvt_pk_bf16_f32 v35, v166, v167
    buffer_store_dwordx4 v[32:35], v4, s[16:19], 0 offen offset:0
    v_mul_f32 v168, s40, v168
    v_mul_f32 v169, s40, v169
    v_mul_f32 v170, s40, v170
    v_mul_f32 v171, s40, v171
    v_mul_f32 v172, s40, v172
    v_mul_f32 v173, s40, v173
    v_mul_f32 v174, s40, v174
    v_mul_f32 v175, s40, v175
    v_cvt_pk_bf16_f32 v36, v168, v169
    v_cvt_pk_bf16_f32 v37, v170, v171
    v_cvt_pk_bf16_f32 v38, v172, v173
    v_cvt_pk_bf16_f32 v39, v174, v175
    buffer_store_dwordx4 v[36:39], v4, s[16:19], 0 offen offset:1024
    v_mul_f32 v224, s40, v224
    v_mul_f32 v225, s40, v225
    v_mul_f32 v226, s40, v226
    v_mul_f32 v227, s40, v227
    v_mul_f32 v228, s40, v228
    v_mul_f32 v229, s40, v229
    v_mul_f32 v230, s40, v230
    v_mul_f32 v231, s40, v231
    v_cvt_pk_bf16_f32 v40, v224, v225
    v_cvt_pk_bf16_f32 v41, v226, v227
    v_cvt_pk_bf16_f32 v42, v228, v229
    v_cvt_pk_bf16_f32 v43, v230, v231
    buffer_store_dwordx4 v[40:43], v4, s[16:19], 0 offen offset:2048
    v_mul_f32 v232, s40, v232
    v_mul_f32 v233, s40, v233
    v_mul_f32 v234, s40, v234
    v_mul_f32 v235, s40, v235
    v_mul_f32 v236, s40, v236
    v_mul_f32 v237, s40, v237
    v_mul_f32 v238, s40, v238
    v_mul_f32 v239, s40, v239
    v_cvt_pk_bf16_f32 v44, v232, v233
    v_cvt_pk_bf16_f32 v45, v234, v235
    v_cvt_pk_bf16_f32 v46, v236, v237
    v_cvt_pk_bf16_f32 v47, v238, v239
    buffer_store_dwordx4 v[44:47], v4, s[16:19], 0 offen offset:3072
    v_mul_f32 v176, s40, v176
    v_mul_f32 v177, s40, v177
    v_mul_f32 v178, s40, v178
    v_mul_f32 v179, s40, v179
    v_mul_f32 v180, s40, v180
    v_mul_f32 v181, s40, v181
    v_mul_f32 v182, s40, v182
    v_mul_f32 v183, s40, v183
    v_cvt_pk_bf16_f32 v48, v176, v177
    v_cvt_pk_bf16_f32 v49, v178, v179
    v_cvt_pk_bf16_f32 v50, v180, v181
    v_cvt_pk_bf16_f32 v51, v182, v183
    buffer_store_dwordx4 v[48:51], v5, s[16:19], 0 offen offset:0
    v_mul_f32 v184, s40, v184
    v_mul_f32 v185, s40, v185
    v_mul_f32 v186, s40, v186
    v_mul_f32 v187, s40, v187
    v_mul_f32 v188, s40, v188
    v_mul_f32 v189, s40, v189
    v_mul_f32 v190, s40, v190
    v_mul_f32 v191, s40, v191
    v_cvt_pk_bf16_f32 v52, v184, v185
    v_cvt_pk_bf16_f32 v53, v186, v187
    v_cvt_pk_bf16_f32 v54, v188, v189
    v_cvt_pk_bf16_f32 v55, v190, v191
    buffer_store_dwordx4 v[52:55], v5, s[16:19], 0 offen offset:1024
    v_mul_f32 v240, s40, v240
    v_mul_f32 v241, s40, v241
    v_mul_f32 v242, s40, v242
    v_mul_f32 v243, s40, v243
    v_mul_f32 v244, s40, v244
    v_mul_f32 v245, s40, v245
    v_mul_f32 v246, s40, v246
    v_mul_f32 v247, s40, v247
    v_cvt_pk_bf16_f32 v56, v240, v241
    v_cvt_pk_bf16_f32 v57, v242, v243
    v_cvt_pk_bf16_f32 v58, v244, v245
    v_cvt_pk_bf16_f32 v59, v246, v247
    buffer_store_dwordx4 v[56:59], v5, s[16:19], 0 offen offset:2048
    v_mul_f32 v248, s40, v248
    v_mul_f32 v249, s40, v249
    v_mul_f32 v250, s40, v250
    v_mul_f32 v251, s40, v251
    v_mul_f32 v252, s40, v252
    v_mul_f32 v253, s40, v253
    v_mul_f32 v254, s40, v254
    v_mul_f32 v255, s40, v255
    v_cvt_pk_bf16_f32 v60, v248, v249
    v_cvt_pk_bf16_f32 v61, v250, v251
    v_cvt_pk_bf16_f32 v62, v252, v253
    v_cvt_pk_bf16_f32 v63, v254, v255
    buffer_store_dwordx4 v[60:63], v5, s[16:19], 0 offen offset:3072
    s_endpgm
k1_compact:
    s_lshl_b32 s35, s29, 6
    s_add_u32 s35, s35, s31
    s_mov_b32 s33, 67108864
    s_mov_b32 s40, 0x3ea52b5c
    s_cmp_lt_u32 s35, 640
    s_cbranch_scc1 k1_cq
    s_sub_u32 s35, s35, 640
    s_mov_b32 s33, 69730304
    s_mov_b32 s40, 1.0
k1_cq:
    s_lshr_b32 s35, s35, 2
    v_and_b32 v2, 31, v1
    s_lshl_b32 s36, s28, 7
    s_add_u32 s36, s36, s30
    v_add_u32 v2, s36, v2
    v_mul_u32_u24 v2, 40, v2
    v_add_u32 v2, s33, v2
    v_add_u32 v3, s35, v8
    v_add_u32 v4, 0, v3
    v_mul_u32_u24 v5, 0xcccd, v4
    v_lshrrev_b32 v5, 18, v5
    v_mul_u32_u24 v6, 5, v5
    v_sub_u32 v6, v4, v6
    v_mul_u32_u24 v5, 0x14000, v5
    v_lshl_add_u32 v5, v6, 3, v5
    v_add_u32 v10, v5, v2
    v_mul_f32 v128, s40, v128
    v_mul_f32 v129, s40, v129
    v_mul_f32 v130, s40, v130
    v_mul_f32 v131, s40, v131
    v_cvt_pk_bf16_f32 v32, v128, v129
    v_cvt_pk_bf16_f32 v33, v130, v131
    buffer_store_dwordx2 v[32:33], v10, s[16:19], 0 offen offset:0
    v_mul_f32 v144, s40, v144
    v_mul_f32 v145, s40, v145
    v_mul_f32 v146, s40, v146
    v_mul_f32 v147, s40, v147
    v_cvt_pk_bf16_f32 v34, v144, v145
    v_cvt_pk_bf16_f32 v35, v146, v147
    buffer_store_dwordx2 v[34:35], v10, s[16:19], 0 offen offset:1280
    v_mul_f32 v160, s40, v160
    v_mul_f32 v161, s40, v161
    v_mul_f32 v162, s40, v162
    v_mul_f32 v163, s40, v163
    v_cvt_pk_bf16_f32 v36, v160, v161
    v_cvt_pk_bf16_f32 v37, v162, v163
    buffer_store_dwordx2 v[36:37], v10, s[16:19], 0 offen offset:2560
    v_mul_f32 v176, s40, v176
    v_mul_f32 v177, s40, v177
    v_mul_f32 v178, s40, v178
    v_mul_f32 v179, s40, v179
    v_cvt_pk_bf16_f32 v38, v176, v177
    v_cvt_pk_bf16_f32 v39, v178, v179
    buffer_store_dwordx2 v[38:39], v10, s[16:19], 0 offen offset:3840
    v_add_u32 v4, 2, v3
    v_mul_u32_u24 v5, 0xcccd, v4
    v_lshrrev_b32 v5, 18, v5
    v_mul_u32_u24 v6, 5, v5
    v_sub_u32 v6, v4, v6
    v_mul_u32_u24 v5, 0x14000, v5
    v_lshl_add_u32 v5, v6, 3, v5
    v_add_u32 v11, v5, v2
    v_mul_f32 v132, s40, v132
    v_mul_f32 v133, s40, v133
    v_mul_f32 v134, s40, v134
    v_mul_f32 v135, s40, v135
    v_cvt_pk_bf16_f32 v40, v132, v133
    v_cvt_pk_bf16_f32 v41, v134, v135
    buffer_store_dwordx2 v[40:41], v11, s[16:19], 0 offen offset:0
    v_mul_f32 v148, s40, v148
    v_mul_f32 v149, s40, v149
    v_mul_f32 v150, s40, v150
    v_mul_f32 v151, s40, v151
    v_cvt_pk_bf16_f32 v42, v148, v149
    v_cvt_pk_bf16_f32 v43, v150, v151
    buffer_store_dwordx2 v[42:43], v11, s[16:19], 0 offen offset:1280
    v_mul_f32 v164, s40, v164
    v_mul_f32 v165, s40, v165
    v_mul_f32 v166, s40, v166
    v_mul_f32 v167, s40, v167
    v_cvt_pk_bf16_f32 v44, v164, v165
    v_cvt_pk_bf16_f32 v45, v166, v167
    buffer_store_dwordx2 v[44:45], v11, s[16:19], 0 offen offset:2560
    v_mul_f32 v180, s40, v180
    v_mul_f32 v181, s40, v181
    v_mul_f32 v182, s40, v182
    v_mul_f32 v183, s40, v183
    v_cvt_pk_bf16_f32 v46, v180, v181
    v_cvt_pk_bf16_f32 v47, v182, v183
    buffer_store_dwordx2 v[46:47], v11, s[16:19], 0 offen offset:3840
    v_add_u32 v4, 4, v3
    v_mul_u32_u24 v5, 0xcccd, v4
    v_lshrrev_b32 v5, 18, v5
    v_mul_u32_u24 v6, 5, v5
    v_sub_u32 v6, v4, v6
    v_mul_u32_u24 v5, 0x14000, v5
    v_lshl_add_u32 v5, v6, 3, v5
    v_add_u32 v12, v5, v2
    v_mul_f32 v136, s40, v136
    v_mul_f32 v137, s40, v137
    v_mul_f32 v138, s40, v138
    v_mul_f32 v139, s40, v139
    v_cvt_pk_bf16_f32 v48, v136, v137
    v_cvt_pk_bf16_f32 v49, v138, v139
    buffer_store_dwordx2 v[48:49], v12, s[16:19], 0 offen offset:0
    v_mul_f32 v152, s40, v152
    v_mul_f32 v153, s40, v153
    v_mul_f32 v154, s40, v154
    v_mul_f32 v155, s40, v155
    v_cvt_pk_bf16_f32 v50, v152, v153
    v_cvt_pk_bf16_f32 v51, v154, v155
    buffer_store_dwordx2 v[50:51], v12, s[16:19], 0 offen offset:1280
    v_mul_f32 v168, s40, v168
    v_mul_f32 v169, s40, v169
    v_mul_f32 v170, s40, v170
    v_mul_f32 v171, s40, v171
    v_cvt_pk_bf16_f32 v52, v168, v169
    v_cvt_pk_bf16_f32 v53, v170, v171
    buffer_store_dwordx2 v[52:53], v12, s[16:19], 0 offen offset:2560
    v_mul_f32 v184, s40, v184
    v_mul_f32 v185, s40, v185
    v_mul_f32 v186, s40, v186
    v_mul_f32 v187, s40, v187
    v_cvt_pk_bf16_f32 v54, v184, v185
    v_cvt_pk_bf16_f32 v55, v186, v187
    buffer_store_dwordx2 v[54:55], v12, s[16:19], 0 offen offset:3840
    v_add_u32 v4, 6, v3
    v_mul_u32_u24 v5, 0xcccd, v4
    v_lshrrev_b32 v5, 18, v5
    v_mul_u32_u24 v6, 5, v5
    v_sub_u32 v6, v4, v6
    v_mul_u32_u24 v5, 0x14000, v5
    v_lshl_add_u32 v5, v6, 3, v5
    v_add_u32 v13, v5, v2
    v_mul_f32 v140, s40, v140
    v_mul_f32 v141, s40, v141
    v_mul_f32 v142, s40, v142
    v_mul_f32 v143, s40, v143
    v_cvt_pk_bf16_f32 v56, v140, v141
    v_cvt_pk_bf16_f32 v57, v142, v143
    buffer_store_dwordx2 v[56:57], v13, s[16:19], 0 offen offset:0
    v_mul_f32 v156, s40, v156
    v_mul_f32 v157, s40, v157
    v_mul_f32 v158, s40, v158
    v_mul_f32 v159, s40, v159
    v_cvt_pk_bf16_f32 v58, v156, v157
    v_cvt_pk_bf16_f32 v59, v158, v159
    buffer_store_dwordx2 v[58:59], v13, s[16:19], 0 offen offset:1280
    v_mul_f32 v172, s40, v172
    v_mul_f32 v173, s40, v173
    v_mul_f32 v174, s40, v174
    v_mul_f32 v175, s40, v175
    v_cvt_pk_bf16_f32 v60, v172, v173
    v_cvt_pk_bf16_f32 v61, v174, v175
    buffer_store_dwordx2 v[60:61], v13, s[16:19], 0 offen offset:2560
    v_mul_f32 v188, s40, v188
    v_mul_f32 v189, s40, v189
    v_mul_f32 v190, s40, v190
    v_mul_f32 v191, s40, v191
    v_cvt_pk_bf16_f32 v62, v188, v189
    v_cvt_pk_bf16_f32 v63, v190, v191
    buffer_store_dwordx2 v[62:63], v13, s[16:19], 0 offen offset:3840
    v_add_u32 v4, 8, v3
    v_mul_u32_u24 v5, 0xcccd, v4
    v_lshrrev_b32 v5, 18, v5
    v_mul_u32_u24 v6, 5, v5
    v_sub_u32 v6, v4, v6
    v_mul_u32_u24 v5, 0x14000, v5
    v_lshl_add_u32 v5, v6, 3, v5
    v_add_u32 v14, v5, v2
    v_mul_f32 v192, s40, v192
    v_mul_f32 v193, s40, v193
    v_mul_f32 v194, s40, v194
    v_mul_f32 v195, s40, v195
    v_cvt_pk_bf16_f32 v32, v192, v193
    v_cvt_pk_bf16_f32 v33, v194, v195
    buffer_store_dwordx2 v[32:33], v14, s[16:19], 0 offen offset:0
    v_mul_f32 v208, s40, v208
    v_mul_f32 v209, s40, v209
    v_mul_f32 v210, s40, v210
    v_mul_f32 v211, s40, v211
    v_cvt_pk_bf16_f32 v34, v208, v209
    v_cvt_pk_bf16_f32 v35, v210, v211
    buffer_store_dwordx2 v[34:35], v14, s[16:19], 0 offen offset:1280
    v_mul_f32 v224, s40, v224
    v_mul_f32 v225, s40, v225
    v_mul_f32 v226, s40, v226
    v_mul_f32 v227, s40, v227
    v_cvt_pk_bf16_f32 v36, v224, v225
    v_cvt_pk_bf16_f32 v37, v226, v227
    buffer_store_dwordx2 v[36:37], v14, s[16:19], 0 offen offset:2560
    v_mul_f32 v240, s40, v240
    v_mul_f32 v241, s40, v241
    v_mul_f32 v242, s40, v242
    v_mul_f32 v243, s40, v243
    v_cvt_pk_bf16_f32 v38, v240, v241
    v_cvt_pk_bf16_f32 v39, v242, v243
    buffer_store_dwordx2 v[38:39], v14, s[16:19], 0 offen offset:3840
    v_add_u32 v4, 10, v3
    v_mul_u32_u24 v5, 0xcccd, v4
    v_lshrrev_b32 v5, 18, v5
    v_mul_u32_u24 v6, 5, v5
    v_sub_u32 v6, v4, v6
    v_mul_u32_u24 v5, 0x14000, v5
    v_lshl_add_u32 v5, v6, 3, v5
    v_add_u32 v15, v5, v2
    v_mul_f32 v196, s40, v196
    v_mul_f32 v197, s40, v197
    v_mul_f32 v198, s40, v198
    v_mul_f32 v199, s40, v199
    v_cvt_pk_bf16_f32 v40, v196, v197
    v_cvt_pk_bf16_f32 v41, v198, v199
    buffer_store_dwordx2 v[40:41], v15, s[16:19], 0 offen offset:0
    v_mul_f32 v212, s40, v212
    v_mul_f32 v213, s40, v213
    v_mul_f32 v214, s40, v214
    v_mul_f32 v215, s40, v215
    v_cvt_pk_bf16_f32 v42, v212, v213
    v_cvt_pk_bf16_f32 v43, v214, v215
    buffer_store_dwordx2 v[42:43], v15, s[16:19], 0 offen offset:1280
    v_mul_f32 v228, s40, v228
    v_mul_f32 v229, s40, v229
    v_mul_f32 v230, s40, v230
    v_mul_f32 v231, s40, v231
    v_cvt_pk_bf16_f32 v44, v228, v229
    v_cvt_pk_bf16_f32 v45, v230, v231
    buffer_store_dwordx2 v[44:45], v15, s[16:19], 0 offen offset:2560
    v_mul_f32 v244, s40, v244
    v_mul_f32 v245, s40, v245
    v_mul_f32 v246, s40, v246
    v_mul_f32 v247, s40, v247
    v_cvt_pk_bf16_f32 v46, v244, v245
    v_cvt_pk_bf16_f32 v47, v246, v247
    buffer_store_dwordx2 v[46:47], v15, s[16:19], 0 offen offset:3840
    v_add_u32 v4, 12, v3
    v_mul_u32_u24 v5, 0xcccd, v4
    v_lshrrev_b32 v5, 18, v5
    v_mul_u32_u24 v6, 5, v5
    v_sub_u32 v6, v4, v6
    v_mul_u32_u24 v5, 0x14000, v5
    v_lshl_add_u32 v5, v6, 3, v5
    v_add_u32 v16, v5, v2
    v_mul_f32 v200, s40, v200
    v_mul_f32 v201, s40, v201
    v_mul_f32 v202, s40, v202
    v_mul_f32 v203, s40, v203
    v_cvt_pk_bf16_f32 v48, v200, v201
    v_cvt_pk_bf16_f32 v49, v202, v203
    buffer_store_dwordx2 v[48:49], v16, s[16:19], 0 offen offset:0
    v_mul_f32 v216, s40, v216
    v_mul_f32 v217, s40, v217
    v_mul_f32 v218, s40, v218
    v_mul_f32 v219, s40, v219
    v_cvt_pk_bf16_f32 v50, v216, v217
    v_cvt_pk_bf16_f32 v51, v218, v219
    buffer_store_dwordx2 v[50:51], v16, s[16:19], 0 offen offset:1280
    v_mul_f32 v232, s40, v232
    v_mul_f32 v233, s40, v233
    v_mul_f32 v234, s40, v234
    v_mul_f32 v235, s40, v235
    v_cvt_pk_bf16_f32 v52, v232, v233
    v_cvt_pk_bf16_f32 v53, v234, v235
    buffer_store_dwordx2 v[52:53], v16, s[16:19], 0 offen offset:2560
    v_mul_f32 v248, s40, v248
    v_mul_f32 v249, s40, v249
    v_mul_f32 v250, s40, v250
    v_mul_f32 v251, s40, v251
    v_cvt_pk_bf16_f32 v54, v248, v249
    v_cvt_pk_bf16_f32 v55, v250, v251
    buffer_store_dwordx2 v[54:55], v16, s[16:19], 0 offen offset:3840
    v_add_u32 v4, 14, v3
    v_mul_u32_u24 v5, 0xcccd, v4
    v_lshrrev_b32 v5, 18, v5
    v_mul_u32_u24 v6, 5, v5
    v_sub_u32 v6, v4, v6
    v_mul_u32_u24 v5, 0x14000, v5
    v_lshl_add_u32 v5, v6, 3, v5
    v_add_u32 v17, v5, v2
    v_mul_f32 v204, s40, v204
    v_mul_f32 v205, s40, v205
    v_mul_f32 v206, s40, v206
    v_mul_f32 v207, s40, v207
    v_cvt_pk_bf16_f32 v56, v204, v205
    v_cvt_pk_bf16_f32 v57, v206, v207
    buffer_store_dwordx2 v[56:57], v17, s[16:19], 0 offen offset:0
    v_mul_f32 v220, s40, v220
    v_mul_f32 v221, s40, v221
    v_mul_f32 v222, s40, v222
    v_mul_f32 v223, s40, v223
    v_cvt_pk_bf16_f32 v58, v220, v221
    v_cvt_pk_bf16_f32 v59, v222, v223
    buffer_store_dwordx2 v[58:59], v17, s[16:19], 0 offen offset:1280
    v_mul_f32 v236, s40, v236
    v_mul_f32 v237, s40, v237
    v_mul_f32 v238, s40, v238
    v_mul_f32 v239, s40, v239
    v_cvt_pk_bf16_f32 v60, v236, v237
    v_cvt_pk_bf16_f32 v61, v238, v239
    buffer_store_dwordx2 v[60:61], v17, s[16:19], 0 offen offset:2560
    v_mul_f32 v252, s40, v252
    v_mul_f32 v253, s40, v253
    v_mul_f32 v254, s40, v254
    v_mul_f32 v255, s40, v255
    v_cvt_pk_bf16_f32 v62, v252, v253
    v_cvt_pk_bf16_f32 v63, v254, v255
    buffer_store_dwordx2 v[62:63], v17, s[16:19], 0 offen offset:3840
k1_end:
    s_endpgm
.globl attn_kernel
.p2align 8
.type attn_kernel,@function
attn_kernel:
    s_cmp_ge_u32 s2, 512
    s_cbranch_scc1 at_end
    s_load_dwordx2 s[4:5], s[0:1], 88
    v_and_b32 v1, 63, v0
    v_lshrrev_b32 v2, 6, v0
    v_lshrrev_b32 v8, 5, v1
    v_readfirstlane_b32 s27, v2
    s_and_b32 s20, s2, 31
    s_waitcnt lgkmcnt(0)
    s_mov_b32 s8, s4
    s_and_b32 s9, s5, 0xffff
    s_mov_b32 s10, 268435456
    s_mov_b32 s11, 0x00020000
    s_cmp_ge_u32 s2, 256
    s_cbranch_scc1 at_A
    v_and_b32 v4, 31, v1
    v_and_b32 v5, 15, v1
    v_xor_b32 v5, v5, v8
    v_lshlrev_b32 v4, 8, v4
    v_xor_b32 v6, 0, v5
    v_lshl_add_u32 v16, v6, 4, v4
    v_xor_b32 v6, 2, v5
    v_lshl_add_u32 v17, v6, 4, v4
    v_xor_b32 v6, 4, v5
    v_lshl_add_u32 v18, v6, 4, v4
    v_xor_b32 v6, 6, v5
    v_lshl_add_u32 v19, v6, 4, v4
    v_xor_b32 v6, 8, v5
    v_lshl_add_u32 v20, v6, 4, v4
    v_xor_b32 v6, 10, v5
    v_lshl_add_u32 v21, v6, 4, v4
    v_xor_b32 v6, 12, v5
    v_lshl_add_u32 v22, v6, 4, v4
    v_xor_b32 v6, 14, v5
    v_lshl_add_u32 v23, v6, 4, v4
    v_and_b32 v4, 31, v1
    v_bfe_u32 v5, v1, 1, 3
    v_xor_b32 v5, v5, v8
    v_lshlrev_b32 v4, 7, v4
    v_xor_b32 v6, 0, v5
    v_lshl_add_u32 v24, v6, 4, v4
    v_xor_b32 v6, 2, v5
    v_lshl_add_u32 v25, v6, 4, v4
    v_xor_b32 v6, 4, v5
    v_lshl_add_u32 v26, v6, 4, v4
    v_xor_b32 v6, 6, v5
    v_lshl_add_u32 v27, v6, 4, v4
    v_lshrrev_b32 v4, 4, v1
    v_and_b32 v5, 15, v1
    s_lshl_b32 s36, s20, 13
    s_add_u32 s36, s36, 16777216
    s_lshl_b32 s37, s27, 4
    s_add_u32 s37, s37, 0
    v_add_u32 v6, s37, v4
    v_and_b32 v7, 15, v6
    v_xor_b32 v7, v7, v5
    v_lshrrev_b32 v10, 5, v6
    v_lshlrev_b32 v10, 18, v10
    v_and_b32 v6, 31, v6
    v_lshl_add_u32 v10, v6, 5, v10
    v_lshrrev_b32 v6, 1, v7
    v_lshl_add_u32 v10, v6, 10, v10
    v_and_b32 v7, 1, v7
    v_lshl_add_u32 v10, v7, 4, v10
    v_add_u32 v28, s36, v10
    s_lshl_b32 s37, s27, 4
    s_add_u32 s37, s37, 4
    v_add_u32 v6, s37, v4
    v_and_b32 v7, 15, v6
    v_xor_b32 v7, v7, v5
    v_lshrrev_b32 v10, 5, v6
    v_lshlrev_b32 v10, 18, v10
    v_and_b32 v6, 31, v6
    v_lshl_add_u32 v10, v6, 5, v10
    v_lshrrev_b32 v6, 1, v7
    v_lshl_add_u32 v10, v6, 10, v10
    v_and_b32 v7, 1, v7
    v_lshl_add_u32 v10, v7, 4, v10
    v_add_u32 v29, s36, v10
    s_lshl_b32 s37, s27, 4
    s_add_u32 s37, s37, 8
    v_add_u32 v6, s37, v4
    v_and_b32 v7, 15, v6
    v_xor_b32 v7, v7, v5
    v_lshrrev_b32 v10, 5, v6
    v_lshlrev_b32 v10, 18, v10
    v_and_b32 v6, 31, v6
    v_lshl_add_u32 v10, v6, 5, v10
    v_lshrrev_b32 v6, 1, v7
    v_lshl_add_u32 v10, v6, 10, v10
    v_and_b32 v7, 1, v7
    v_lshl_add_u32 v10, v7, 4, v10
    v_add_u32 v30, s36, v10
    s_lshl_b32 s37, s27, 4
    s_add_u32 s37, s37, 12
    v_add_u32 v6, s37, v4
    v_and_b32 v7, 15, v6
    v_xor_b32 v7, v7, v5
    v_lshrrev_b32 v10, 5, v6
    v_lshlrev_b32 v10, 18, v10
    v_and_b32 v6, 31, v6
    v_lshl_add_u32 v10, v6, 5, v10
    v_lshrrev_b32 v6, 1, v7
    v_lshl_add_u32 v10, v6, 10, v10
    v_and_b32 v7, 1, v7
    v_lshl_add_u32 v10, v7, 4, v10
    v_add_u32 v31, s36, v10
    v_lshrrev_b32 v4, 3, v1
    v_and_b32 v5, 7, v1
    s_lshl_b32 s36, s20, 19
    s_add_u32 s36, s36, 33554432
    s_lshl_b32 s37, s27, 5
    s_add_u32 s37, s37, 0
    v_add_u32 v6, s37, v4
    v_bfe_u32 v7, v6, 1, 3
    v_xor_b32 v7, v7, v5
    v_lshrrev_b32 v10, 5, v6
    v_lshlrev_b32 v10, 17, v10
    v_and_b32 v6, 31, v6
    v_lshl_add_u32 v10, v6, 5, v10
    v_lshrrev_b32 v6, 1, v7
    v_lshl_add_u32 v10, v6, 10, v10
    v_and_b32 v7, 1, v7
    v_lshl_add_u32 v10, v7, 4, v10
    v_add_u32 v32, s36, v10
    s_lshl_b32 s37, s27, 5
    s_add_u32 s37, s37, 8
    v_add_u32 v6, s37, v4
    v_bfe_u32 v7, v6, 1, 3
    v_xor_b32 v7, v7, v5
    v_lshrrev_b32 v10, 5, v6
    v_lshlrev_b32 v10, 17, v10
    v_and_b32 v6, 31, v6
    v_lshl_add_u32 v10, v6, 5, v10
    v_lshrrev_b32 v6, 1, v7
    v_lshl_add_u32 v10, v6, 10, v10
    v_and_b32 v7, 1, v7
    v_lshl_add_u32 v10, v7, 4, v10
    v_add_u32 v33, s36, v10
    s_lshl_b32 s37, s27, 5
    s_add_u32 s37, s37, 16
    v_add_u32 v6, s37, v4
    v_bfe_u32 v7, v6, 1, 3
    v_xor_b32 v7, v7, v5
    v_lshrrev_b32 v10, 5, v6
    v_lshlrev_b32 v10, 17, v10
    v_and_b32 v6, 31, v6
    v_lshl_add_u32 v10, v6, 5, v10
    v_lshrrev_b32 v6, 1, v7
    v_lshl_add_u32 v10, v6, 10, v10
    v_and_b32 v7, 1, v7
    v_lshl_add_u32 v10, v7, 4, v10
    v_add_u32 v34, s36, v10
    s_lshl_b32 s37, s27, 5
    s_add_u32 s37, s37, 24
    v_add_u32 v6, s37, v4
    v_bfe_u32 v7, v6, 1, 3
    v_xor_b32 v7, v7, v5
    v_lshrrev_b32 v10, 5, v6
    v_lshlrev_b32 v10, 17, v10
    v_and_b32 v6, 31, v6
    v_lshl_add_u32 v10, v6, 5, v10
    v_lshrrev_b32 v6, 1, v7
    v_lshl_add_u32 v10, v6, 10, v10
    v_and_b32 v7, 1, v7
    v_lshl_add_u32 v10, v7, 4, v10
    v_add_u32 v35, s36, v10
    s_lshl_b32 s26, s27, 12
    s_lshr_b32 s21, s2, 5
    s_sub_u32 s21, 15, s21
    s_mov_b32 s50, 2
    v_mov_b32 v2, 0xf149f2ca
atB_outer:
    s_mov_b32 s23, 0
    s_mov_b32 s24, 0
    s_barrier
    s_add_u32 m0, s26, 0
    s_nop 0
    buffer_load_dwordx4 v28, s[8:11], s23 offen lds
    s_add_u32 m0, s26, 1024
    s_nop 0
    buffer_load_dwordx4 v29, s[8:11], s23 offen lds
    s_add_u32 m0, s26, 2048
    s_nop 0
    buffer_load_dwordx4 v30, s[8:11], s23 offen lds
    s_add_u32 m0, s26, 3072
    s_nop 0
    buffer_load_dwordx4 v31, s[8:11], s23 offen lds
    s_add_u32 s23, s23, 524288
    s_lshl_b32 s22, s21, 7
    s_lshl_b32 s36, s27, 5
    s_add_u32 s22, s22, s36
    v_and_b32 v4, 31, v1
    v_add_u32 v9, s22, v4
    v_lshlrev_b32 v15, 5, v4
    v_lshl_add_u32 v15, v8, 4, v15
    s_lshl_b32 s22, s22, 13
    s_lshl_b32 s36, s20, 13
    s_add_u32 s36, s36, s22
    v_add_u32 v15, s36, v15
    s_movk_i32 s37, 0x1000
    buffer_load_dwordx4 v[40:43], v15, s[8:11], 0 offen offset:0
    buffer_load_dwordx4 v[44:47], v15, s[8:11], 0 offen offset:1024
    buffer_load_dwordx4 v[48:51], v15, s[8:11], 0 offen offset:2048
    buffer_load_dwordx4 v[52:55], v15, s[8:11], 0 offen offset:3072
    buffer_load_dwordx4 v[56:59], v15, s[8:11], s37 offen offset:0
    buffer_load_dwordx4 v[60:63], v15, s[8:11], s37 offen offset:1024
    buffer_load_dwordx4 v[64:67], v15, s[8:11], s37 offen offset:2048
    buffer_load_dwordx4 v[68:71], v15, s[8:11], s37 offen offset:3072
    s_add_u32 m0, s26, 16384
    s_nop 0
    buffer_load_dwordx4 v28, s[8:11], s23 offen lds
    s_add_u32 m0, s26, 17408
    s_nop 0
    buffer_load_dwordx4 v29, s[8:11], s23 offen lds
    s_add_u32 m0, s26, 18432
    s_nop 0
    buffer_load_dwordx4 v30, s[8:11], s23 offen lds
    s_add_u32 m0, s26, 19456
    s_nop 0
    buffer_load_dwordx4 v31, s[8:11], s23 offen lds
    s_add_u32 s23, s23, 524288
    s_add_u32 m0, s26, 32768
    s_nop 0
    buffer_load_dwordx4 v32, s[8:11], s24 offen lds
    s_add_u32 m0, s26, 33792
    s_nop 0
    buffer_load_dwordx4 v33, s[8:11], s24 offen lds
    s_add_u32 m0, s26, 34816
    s_nop 0
    buffer_load_dwordx4 v34, s[8:11], s24 offen lds
    s_add_u32 m0, s26, 35840
    s_nop 0
    buffer_load_dwordx4 v35, s[8:11], s24 offen lds
    s_add_u32 s24, s24, 4096
    v_mov_b32 v136, 0
    v_mov_b32 v137, 0
    v_mov_b32 v138, 0
    v_mov_b32 v139, 0
    v_mov_b32 v140, 0
    v_mov_b32 v141, 0
    v_mov_b32 v142, 0
    v_mov_b32 v143, 0
    v_mov_b32 v144, 0
    v_mov_b32 v145, 0
    v_mov_b32 v146, 0
    v_mov_b32 v147, 0
    v_mov_b32 v148, 0
    v_mov_b32 v149, 0
    v_mov_b32 v150, 0
    v_mov_b32 v151, 0
    v_mov_b32 v168, 0
    v_mov_b32 v169, 0
    v_mov_b32 v170, 0
    v_mov_b32 v171, 0
    v_mov_b32 v172, 0
    v_mov_b32 v173, 0
    v_mov_b32 v174, 0
    v_mov_b32 v175, 0
    v_mov_b32 v176, 0
    v_mov_b32 v177, 0
    v_mov_b32 v178, 0
    v_mov_b32 v179, 0
    v_mov_b32 v180, 0
    v_mov_b32 v181, 0
    v_mov_b32 v182, 0
    v_mov_b32 v183, 0
    v_mov_b32 v184, 0
    v_mov_b32 v185, 0
    v_mov_b32 v186, 0
    v_mov_b32 v187, 0
    v_mov_b32 v188, 0
    v_mov_b32 v189, 0
    v_mov_b32 v190, 0
    v_mov_b32 v191, 0
    v_mov_b32 v192, 0
    v_mov_b32 v193, 0
    v_mov_b32 v194, 0
    v_mov_b32 v195, 0
    v_mov_b32 v196, 0
    v_mov_b32 v197, 0
    v_mov_b32 v198, 0
    v_mov_b32 v199, 0
    v_mov_b32 v200, 0
    v_mov_b32 v201, 0
    v_mov_b32 v202, 0
    v_mov_b32 v203, 0
    v_mov_b32 v204, 0
    v_mov_b32 v205, 0
    v_mov_b32 v206, 0
    v_mov_b32 v207, 0
    v_mov_b32 v208, 0
    v_mov_b32 v209, 0
    v_mov_b32 v210, 0
    v_mov_b32 v211, 0
    v_mov_b32 v212, 0
    v_mov_b32 v213, 0
    v_mov_b32 v214, 0
    v_mov_b32 v215, 0
    v_mov_b32 v216, 0
    v_mov_b32 v217, 0
    v_mov_b32 v218, 0
    v_mov_b32 v219, 0
    v_mov_b32 v220, 0
    v_mov_b32 v221, 0
    v_mov_b32 v222, 0
    v_mov_b32 v223, 0
    v_mov_b32 v224, 0
    v_mov_b32 v225, 0
    v_mov_b32 v226, 0
    v_mov_b32 v227, 0
    v_mov_b32 v228, 0
    v_mov_b32 v229, 0
    v_mov_b32 v230, 0
    v_mov_b32 v231, 0
    v_mov_b32 v36, 0
    v_mov_b32 v37, 0
    s_mov_b32 s30, 0xff7fffff
    s_mov_b32 s31, 0xff7fffff
    v_lshlrev_b32 v3, 2, v8
    v_sub_u32 v3, v9, v3
    s_waitcnt vmcnt(8)
    s_barrier
    ds_read_b128 v[232:235], v16 offset:0
    ds_read_b128 v[236:239], v17 offset:0
    ds_read_b128 v[240:243], v18 offset:0
    ds_read_b128 v[244:247], v19 offset:0
    s_waitcnt lgkmcnt(3)
    v_mfma_f32_32x32x16_bf16 v[72:87], v[232:235], v[40:43], v[136:151]
    ds_read_b128 v[248:251], v20 offset:0
    s_waitcnt lgkmcnt(3)
    v_mfma_f32_32x32x16_bf16 v[72:87], v[236:239], v[44:47], v[72:87]
    ds_read_b128 v[252:255], v21 offset:0
    s_waitcnt lgkmcnt(3)
    v_mfma_f32_32x32x16_bf16 v[72:87], v[240:243], v[48:51], v[72:87]
    ds_read_b128 v[232:235], v22 offset:0
    s_waitcnt lgkmcnt(3)
    v_mfma_f32_32x32x16_bf16 v[72:87], v[244:247], v[52:55], v[72:87]
    ds_read_b128 v[236:239], v23 offset:0
    s_waitcnt lgkmcnt(3)
    v_mfma_f32_32x32x16_bf16 v[72:87], v[248:251], v[56:59], v[72:87]
    ds_read_b128 v[240:243], v16 offset:8192
    s_waitcnt lgkmcnt(3)
    v_mfma_f32_32x32x16_bf16 v[72:87], v[252:255], v[60:63], v[72:87]
    ds_read_b128 v[244:247], v17 offset:8192
    s_waitcnt lgkmcnt(3)
    v_mfma_f32_32x32x16_bf16 v[72:87], v[232:235], v[64:67], v[72:87]
    ds_read_b128 v[248:251], v18 offset:8192
    s_waitcnt lgkmcnt(3)
    v_mfma_f32_32x32x16_bf16 v[72:87], v[236:239], v[68:71], v[72:87]
    ds_read_b128 v[252:255], v19 offset:8192
    s_waitcnt lgkmcnt(3)
    v_mfma_f32_32x32x16_bf16 v[88:103], v[240:243], v[40:43], v[136:151]
    ds_read_b128 v[232:235], v20 offset:8192
    s_waitcnt lgkmcnt(3)
    v_mfma_f32_32x32x16_bf16 v[88:103], v[244:247], v[44:47], v[88:103]
    ds_read_b128 v[236:239], v21 offset:8192
    s_waitcnt lgkmcnt(3)
    v_mfma_f32_32x32x16_bf16 v[88:103], v[248:251], v[48:51], v[88:103]
    ds_read_b128 v[240:243], v22 offset:8192
    s_waitcnt lgkmcnt(3)
    v_mfma_f32_32x32x16_bf16 v[88:103], v[252:255], v[52:55], v[88:103]
    ds_read_b128 v[244:247], v23 offset:8192
    s_waitcnt lgkmcnt(3)
    v_mfma_f32_32x32x16_bf16 v[88:103], v[232:235], v[56:59], v[88:103]
    s_waitcnt lgkmcnt(2)
    v_mfma_f32_32x32x16_bf16 v[88:103], v[236:239], v[60:63], v[88:103]
    s_waitcnt lgkmcnt(1)
    v_mfma_f32_32x32x16_bf16 v[88:103], v[240:243], v[64:67], v[88:103]
    s_waitcnt lgkmcnt(0)
    v_mfma_f32_32x32x16_bf16 v[88:103], v[244:247], v[68:71], v[88:103]
    s_nop 7
    s_nop 7
    v_cmp_gt_i32 vcc, 0, v3
    s_nop 1
    v_cndmask_b32 v72, v72, v2, vcc
    v_cmp_gt_i32 vcc, 1, v3
    s_nop 1
    v_cndmask_b32 v73, v73, v2, vcc
    v_cmp_gt_i32 vcc, 2, v3
    s_nop 1
    v_cndmask_b32 v74, v74, v2, vcc
    v_cmp_gt_i32 vcc, 3, v3
    s_nop 1
    v_cndmask_b32 v75, v75, v2, vcc
    v_cmp_gt_i32 vcc, 8, v3
    s_nop 1
    v_cndmask_b32 v76, v76, v2, vcc
    v_cmp_gt_i32 vcc, 9, v3
    s_nop 1
    v_cndmask_b32 v77, v77, v2, vcc
    v_cmp_gt_i32 vcc, 10, v3
    s_nop 1
    v_cndmask_b32 v78, v78, v2, vcc
    v_cmp_gt_i32 vcc, 11, v3
    s_nop 1
    v_cndmask_b32 v79, v79, v2, vcc
    v_cmp_gt_i32 vcc, 16, v3
    s_nop 1
    v_cndmask_b32 v80, v80, v2, vcc
    v_cmp_gt_i32 vcc, 17, v3
    s_nop 1
    v_cndmask_b32 v81, v81, v2, vcc
    v_cmp_gt_i32 vcc, 18, v3
    s_nop 1
    v_cndmask_b32 v82, v82, v2, vcc
    v_cmp_gt_i32 vcc, 19, v3
    s_nop 1
    v_cndmask_b32 v83, v83, v2, vcc
    v_cmp_gt_i32 vcc, 24, v3
    s_nop 1
    v_cndmask_b32 v84, v84, v2, vcc
    v_cmp_gt_i32 vcc, 25, v3
    s_nop 1
    v_cndmask_b32 v85, v85, v2, vcc
    v_cmp_gt_i32 vcc, 26, v3
    s_nop 1
    v_cndmask_b32 v86, v86, v2, vcc
    v_cmp_gt_i32 vcc, 27, v3
    s_nop 1
    v_cndmask_b32 v87, v87, v2, vcc
    v_cmp_gt_i32 vcc, 32, v3
    s_nop 1
    v_cndmask_b32 v88, v88, v2, vcc
    v_cmp_gt_i32 vcc, 33, v3
    s_nop 1
    v_cndmask_b32 v89, v89, v2, vcc
    v_cmp_gt_i32 vcc, 34, v3
    s_nop 1
    v_cndmask_b32 v90, v90, v2, vcc
    v_cmp_gt_i32 vcc, 35, v3
    s_nop 1
    v_cndmask_b32 v91, v91, v2, vcc
    v_cmp_gt_i32 vcc, 40, v3
    s_nop 1
    v_cndmask_b32 v92, v92, v2, vcc
    v_cmp_gt_i32 vcc, 41, v3
    s_nop 1
    v_cndmask_b32 v93, v93, v2, vcc
    v_cmp_gt_i32 vcc, 42, v3
    s_nop 1
    v_cndmask_b32 v94, v94, v2, vcc
    v_cmp_gt_i32 vcc, 43, v3
    s_nop 1
    v_cndmask_b32 v95, v95, v2, vcc
    v_cmp_gt_i32 vcc, 48, v3
    s_nop 1
    v_cndmask_b32 v96, v96, v2, vcc
    v_cmp_gt_i32 vcc, 49, v3
    s_nop 1
    v_cndmask_b32 v97, v97, v2, vcc
    v_cmp_gt_i32 vcc, 50, v3
    s_nop 1
    v_cndmask_b32 v98, v98, v2, vcc
    v_cmp_gt_i32 vcc, 51, v3
    s_nop 1
    v_cndmask_b32 v99, v99, v2, vcc
    v_cmp_gt_i32 vcc, 56, v3
    s_nop 1
    v_cndmask_b32 v100, v100, v2, vcc
    v_cmp_gt_i32 vcc, 57, v3
    s_nop 1
    v_cndmask_b32 v101, v101, v2, vcc
    v_cmp_gt_i32 vcc, 58, v3
    s_nop 1
    v_cndmask_b32 v102, v102, v2, vcc
    v_cmp_gt_i32 vcc, 59, v3
    s_nop 1
    v_cndmask_b32 v103, v103, v2, vcc
    v_max3_f32 v38, v72, v73, v74
    v_max3_f32 v4, v75, v76, v77
    v_max3_f32 v38, v38, v78, v79
    v_max3_f32 v4, v4, v80, v81
    v_max3_f32 v38, v38, v82, v83
    v_max3_f32 v4, v4, v84, v85
    v_max3_f32 v38, v38, v86, v87
    v_max3_f32 v4, v4, v88, v89
    v_max3_f32 v38, v38, v90, v91
    v_max3_f32 v4, v4, v92, v93
    v_max3_f32 v38, v38, v94, v95
    v_max3_f32 v4, v4, v96, v97
    v_max3_f32 v38, v38, v98, v99
    v_max3_f32 v4, v4, v100, v101
    v_max3_f32 v38, v38, v102, v103
    v_max_f32 v38, v38, v4
    v_cmp_lt_f32 vcc, s30, v38
    s_nop 1
    s_cbranch_vccnz slow_37
ret_38:
    v_subrev_u32 v3, 64, v3
    s_waitcnt vmcnt(0)
    s_barrier
    s_cmp_eq_u32 s21, 0
    s_cbranch_scc1 atB_i0
    s_add_u32 m0, s26, 0
    s_nop 0
    buffer_load_dwordx4 v28, s[8:11], s23 offen lds
    s_add_u32 m0, s26, 1024
    s_nop 0
    buffer_load_dwordx4 v29, s[8:11], s23 offen lds
    s_add_u32 m0, s26, 2048
    s_nop 0
    buffer_load_dwordx4 v30, s[8:11], s23 offen lds
    s_add_u32 m0, s26, 3072
    s_nop 0
    buffer_load_dwordx4 v31, s[8:11], s23 offen lds
    s_add_u32 s23, s23, 524288
    s_add_u32 m0, s26, 49152
    s_nop 0
    buffer_load_dwordx4 v32, s[8:11], s24 offen lds
    s_add_u32 m0, s26, 50176
    s_nop 0
    buffer_load_dwordx4 v33, s[8:11], s24 offen lds
    s_add_u32 m0, s26, 51200
    s_nop 0
    buffer_load_dwordx4 v34, s[8:11], s24 offen lds
    s_add_u32 m0, s26, 52224
    s_nop 0
    buffer_load_dwordx4 v35, s[8:11], s24 offen lds
    s_add_u32 s24, s24, 4096
atB_i0:
    ds_read_b128 v[248:251], v16 offset:16384
    ds_read_b128 v[252:255], v17 offset:16384
    ds_read_b128 v[232:235], v18 offset:16384
    ds_read_b128 v[236:239], v19 offset:16384
    v_exp_f32 v72, v72
    v_exp_f32 v73, v73
    s_waitcnt lgkmcnt(3)
    v_mfma_f32_32x32x16_bf16 v[104:119], v[248:251], v[40:43], v[136:151]
    v_exp_f32 v74, v74
    v_exp_f32 v75, v75
    v_exp_f32 v76, v76
    ds_read_b128 v[240:243], v20 offset:16384
    s_waitcnt lgkmcnt(3)
    v_mfma_f32_32x32x16_bf16 v[104:119], v[252:255], v[44:47], v[104:119]
    v_exp_f32 v77, v77
    v_exp_f32 v78, v78
    ds_read_b128 v[244:247], v21 offset:16384
    s_waitcnt lgkmcnt(3)
    v_mfma_f32_32x32x16_bf16 v[104:119], v[232:235], v[48:51], v[104:119]
    v_exp_f32 v79, v79
    v_exp_f32 v80, v80
    v_exp_f32 v81, v81
    ds_read_b128 v[248:251], v22 offset:16384
    s_waitcnt lgkmcnt(3)
    v_mfma_f32_32x32x16_bf16 v[104:119], v[236:239], v[52:55], v[104:119]
    v_exp_f32 v82, v82
    v_exp_f32 v83, v83
    ds_read_b128 v[252:255], v23 offset:16384
    s_waitcnt lgkmcnt(3)
    v_mfma_f32_32x32x16_bf16 v[104:119], v[240:243], v[56:59], v[104:119]
    v_exp_f32 v84, v84
    v_exp_f32 v85, v85
    v_exp_f32 v86, v86
    ds_read_b128 v[232:235], v16 offset:24576
    s_waitcnt lgkmcnt(3)
    v_mfma_f32_32x32x16_bf16 v[104:119], v[244:247], v[60:63], v[104:119]
    v_exp_f32 v87, v87
    v_cvt_pk_bf16_f32 v152, v72, v73
    ds_read_b128 v[236:239], v17 offset:24576
    s_waitcnt lgkmcnt(3)
    v_mfma_f32_32x32x16_bf16 v[104:119], v[248:251], v[64:67], v[104:119]
    v_cvt_pk_bf16_f32 v153, v74, v75
    v_cvt_pk_bf16_f32 v154, v76, v77
    v_cvt_pk_bf16_f32 v155, v78, v79
    ds_read_b128 v[240:243], v18 offset:24576
    s_waitcnt lgkmcnt(3)
    v_mfma_f32_32x32x16_bf16 v[104:119], v[252:255], v[68:71], v[104:119]
    v_cvt_pk_bf16_f32 v156, v80, v81
    v_cvt_pk_bf16_f32 v157, v82, v83
    ds_read_b128 v[244:247], v19 offset:24576
    s_waitcnt lgkmcnt(3)
    v_mfma_f32_32x32x16_bf16 v[120:135], v[232:235], v[40:43], v[136:151]
    v_cvt_pk_bf16_f32 v158, v84, v85
    v_cvt_pk_bf16_f32 v159, v86, v87
    v_add_f32 v36, v36, v72
    ds_read_b128 v[248:251], v20 offset:24576
    s_waitcnt lgkmcnt(3)
    v_mfma_f32_32x32x16_bf16 v[120:135], v[236:239], v[44:47], v[120:135]
    v_add_f32 v37, v37, v73
    v_add_f32 v36, v36, v74
    ds_read_b128 v[252:255], v21 offset:24576
    s_waitcnt lgkmcnt(3)
    v_mfma_f32_32x32x16_bf16 v[120:135], v[240:243], v[48:51], v[120:135]
    v_add_f32 v37, v37, v75
    v_add_f32 v36, v36, v76
    v_add_f32 v37, v37, v77
    ds_read_b128 v[232:235], v22 offset:24576
    s_waitcnt lgkmcnt(3)
    v_mfma_f32_32x32x16_bf16 v[120:135], v[244:247], v[52:55], v[120:135]
    v_add_f32 v36, v36, v78
    v_add_f32 v37, v37, v79
    ds_read_b128 v[236:239], v23 offset:24576
    s_waitcnt lgkmcnt(3)
    v_mfma_f32_32x32x16_bf16 v[120:135], v[248:251], v[56:59], v[120:135]
    v_add_f32 v36, v36, v80
    v_add_f32 v37, v37, v81
    v_add_f32 v36, v36, v82
    ds_read_b128 v[240:243], v24 offset:32768
    s_waitcnt lgkmcnt(3)
    v_mfma_f32_32x32x16_bf16 v[120:135], v[252:255], v[60:63], v[120:135]
    v_add_f32 v37, v37, v83
    v_add_f32 v36, v36, v84
    ds_read_b128 v[244:247], v24 offset:36864
    s_waitcnt lgkmcnt(3)
    v_mfma_f32_32x32x16_bf16 v[120:135], v[232:235], v[64:67], v[120:135]
    v_add_f32 v37, v37, v85
    v_add_f32 v36, v36, v86
    v_add_f32 v37, v37, v87
    ds_read_b128 v[248:251], v24 offset:40960
    s_waitcnt lgkmcnt(3)
    v_mfma_f32_32x32x16_bf16 v[120:135], v[236:239], v[68:71], v[120:135]
    s_nop 1
    v_exp_f32 v88, v88
    v_exp_f32 v89, v89
    v_exp_f32 v90, v90
    ds_read_b128 v[252:255], v24 offset:45056
    s_waitcnt lgkmcnt(3)
    v_mfma_f32_32x32x16_bf16 v[168:183], v[240:243], v[152:155], v[168:183]
    v_exp_f32 v91, v91
    v_exp_f32 v92, v92
    v_exp_f32 v93, v93
    ds_read_b128 v[232:235], v25 offset:32768
    s_waitcnt lgkmcnt(3)
    v_mfma_f32_32x32x16_bf16 v[184:199], v[244:247], v[152:155], v[184:199]
    v_exp_f32 v94, v94
    v_exp_f32 v95, v95
    v_exp_f32 v96, v96
    ds_read_b128 v[236:239], v25 offset:36864
    s_waitcnt lgkmcnt(3)
    v_mfma_f32_32x32x16_bf16 v[200:215], v[248:251], v[152:155], v[200:215]
    v_exp_f32 v97, v97
    v_exp_f32 v98, v98
    v_exp_f32 v99, v99
    ds_read_b128 v[240:243], v25 offset:40960
    s_waitcnt lgkmcnt(3)
    v_mfma_f32_32x32x16_bf16 v[216:231], v[252:255], v[152:155], v[216:231]
    v_exp_f32 v100, v100
    v_exp_f32 v101, v101
    v_exp_f32 v102, v102
    ds_read_b128 v[244:247], v25 offset:45056
    s_waitcnt lgkmcnt(3)
    v_mfma_f32_32x32x16_bf16 v[168:183], v[232:235], v[156:159], v[168:183]
    v_exp_f32 v103, v103
    v_cvt_pk_bf16_f32 v160, v88, v89
    v_cvt_pk_bf16_f32 v161, v90, v91
    ds_read_b128 v[248:251], v26 offset:32768
    s_waitcnt lgkmcnt(3)
    v_mfma_f32_32x32x16_bf16 v[184:199], v[236:239], v[156:159], v[184:199]
    v_cvt_pk_bf16_f32 v162, v92, v93
    v_cvt_pk_bf16_f32 v163, v94, v95
    v_cvt_pk_bf16_f32 v164, v96, v97
    ds_read_b128 v[252:255], v26 offset:36864
    s_waitcnt lgkmcnt(3)
    v_mfma_f32_32x32x16_bf16 v[200:215], v[240:243], v[156:159], v[200:215]
    v_cvt_pk_bf16_f32 v165, v98, v99
    v_cvt_pk_bf16_f32 v166, v100, v101
    v_cvt_pk_bf16_f32 v167, v102, v103
    ds_read_b128 v[232:235], v26 offset:40960
    s_waitcnt lgkmcnt(3)
    v_mfma_f32_32x32x16_bf16 v[216:231], v[244:247], v[156:159], v[216:231]
    s_nop 1
    v_add_f32 v36, v36, v88
    v_add_f32 v37, v37, v89
    v_add_f32 v36, v36, v90
    v_add_f32 v37, v37, v91
    v_add_f32 v36, v36, v92
    v_add_f32 v37, v37, v93
    v_add_f32 v36, v36, v94
    v_add_f32 v37, v37, v95
    ds_read_b128 v[236:239], v26 offset:45056
    s_waitcnt lgkmcnt(3)
    v_mfma_f32_32x32x16_bf16 v[168:183], v[248:251], v[160:163], v[168:183]
    v_add_f32 v36, v36, v96
    v_add_f32 v37, v37, v97
    v_add_f32 v36, v36, v98
    v_add_f32 v37, v37, v99
    v_add_f32 v36, v36, v100
    v_add_f32 v37, v37, v101
    v_add_f32 v36, v36, v102
    v_add_f32 v37, v37, v103
    ds_read_b128 v[240:243], v27 offset:32768
    s_waitcnt lgkmcnt(3)
    v_mfma_f32_32x32x16_bf16 v[184:199], v[252:255], v[160:163], v[184:199]
    v_cmp_gt_i32 vcc, 0, v3
    s_nop 1
    v_cndmask_b32 v104, v104, v2, vcc
    v_cmp_gt_i32 vcc, 1, v3
    s_nop 1
    v_cndmask_b32 v105, v105, v2, vcc
    v_cmp_gt_i32 vcc, 2, v3
    s_nop 1
    v_cndmask_b32 v106, v106, v2, vcc
    v_cmp_gt_i32 vcc, 3, v3
    s_nop 1
    v_cndmask_b32 v107, v107, v2, vcc
    v_cmp_gt_i32 vcc, 8, v3
    s_nop 1
    v_cndmask_b32 v108, v108, v2, vcc
    v_cmp_gt_i32 vcc, 9, v3
    s_nop 1
    v_cndmask_b32 v109, v109, v2, vcc
    v_cmp_gt_i32 vcc, 10, v3
    s_nop 1
    v_cndmask_b32 v110, v110, v2, vcc
    v_cmp_gt_i32 vcc, 11, v3
    s_nop 1
    v_cndmask_b32 v111, v111, v2, vcc
    ds_read_b128 v[244:247], v27 offset:36864
    s_waitcnt lgkmcnt(3)
    v_mfma_f32_32x32x16_bf16 v[200:215], v[232:235], v[160:163], v[200:215]
    v_cmp_gt_i32 vcc, 16, v3
    s_nop 1
    v_cndmask_b32 v112, v112, v2, vcc
    v_cmp_gt_i32 vcc, 17, v3
    s_nop 1
    v_cndmask_b32 v113, v113, v2, vcc
    v_cmp_gt_i32 vcc, 18, v3
    s_nop 1
    v_cndmask_b32 v114, v114, v2, vcc
    v_cmp_gt_i32 vcc, 19, v3
    s_nop 1
    v_cndmask_b32 v115, v115, v2, vcc
    v_cmp_gt_i32 vcc, 24, v3
    s_nop 1
    v_cndmask_b32 v116, v116, v2, vcc
    v_cmp_gt_i32 vcc, 25, v3
    s_nop 1
    v_cndmask_b32 v117, v117, v2, vcc
    v_cmp_gt_i32 vcc, 26, v3
    s_nop 1
    v_cndmask_b32 v118, v118, v2, vcc
    v_cmp_gt_i32 vcc, 27, v3
    s_nop 1
    v_cndmask_b32 v119, v119, v2, vcc
    ds_read_b128 v[248:251], v27 offset:40960
    s_waitcnt lgkmcnt(3)
    v_mfma_f32_32x32x16_bf16 v[216:231], v[236:239], v[160:163], v[216:231]
    v_cmp_gt_i32 vcc, 32, v3
    s_nop 1
    v_cndmask_b32 v120, v120, v2, vcc
    v_cmp_gt_i32 vcc, 33, v3
    s_nop 1
    v_cndmask_b32 v121, v121, v2, vcc
    v_cmp_gt_i32 vcc, 34, v3
    s_nop 1
    v_cndmask_b32 v122, v122, v2, vcc
    v_cmp_gt_i32 vcc, 35, v3
    s_nop 1
    v_cndmask_b32 v123, v123, v2, vcc
    v_cmp_gt_i32 vcc, 40, v3
    s_nop 1
    v_cndmask_b32 v124, v124, v2, vcc
    v_cmp_gt_i32 vcc, 41, v3
    s_nop 1
    v_cndmask_b32 v125, v125, v2, vcc
    v_cmp_gt_i32 vcc, 42, v3
    s_nop 1
    v_cndmask_b32 v126, v126, v2, vcc
    v_cmp_gt_i32 vcc, 43, v3
    s_nop 1
    v_cndmask_b32 v127, v127, v2, vcc
    ds_read_b128 v[252:255], v27 offset:45056
    s_waitcnt lgkmcnt(3)
    v_mfma_f32_32x32x16_bf16 v[168:183], v[240:243], v[164:167], v[168:183]
    v_cmp_gt_i32 vcc, 48, v3
    s_nop 1
    v_cndmask_b32 v128, v128, v2, vcc
    v_cmp_gt_i32 vcc, 49, v3
    s_nop 1
    v_cndmask_b32 v129, v129, v2, vcc
    v_cmp_gt_i32 vcc, 50, v3
    s_nop 1
    v_cndmask_b32 v130, v130, v2, vcc
    v_cmp_gt_i32 vcc, 51, v3
    s_nop 1
    v_cndmask_b32 v131, v131, v2, vcc
    v_cmp_gt_i32 vcc, 56, v3
    s_nop 1
    v_cndmask_b32 v132, v132, v2, vcc
    v_cmp_gt_i32 vcc, 57, v3
    s_nop 1
    v_cndmask_b32 v133, v133, v2, vcc
    v_cmp_gt_i32 vcc, 58, v3
    s_nop 1
    v_cndmask_b32 v134, v134, v2, vcc
    v_cmp_gt_i32 vcc, 59, v3
    s_nop 1
    v_cndmask_b32 v135, v135, v2, vcc
    s_waitcnt lgkmcnt(2)
    v_mfma_f32_32x32x16_bf16 v[184:199], v[244:247], v[164:167], v[184:199]
    v_max3_f32 v38, v104, v105, v106
    v_max3_f32 v4, v107, v108, v109
    v_max3_f32 v38, v38, v110, v111
    v_max3_f32 v4, v4, v112, v113
    v_max3_f32 v38, v38, v114, v115
    v_max3_f32 v4, v4, v116, v117
    v_max3_f32 v38, v38, v118, v119
    v_max3_f32 v4, v4, v120, v121
    s_waitcnt lgkmcnt(1)
    v_mfma_f32_32x32x16_bf16 v[200:215], v[248:251], v[164:167], v[200:215]
    v_max3_f32 v38, v38, v122, v123
    v_max3_f32 v4, v4, v124, v125
    v_max3_f32 v38, v38, v126, v127
    v_max3_f32 v4, v4, v128, v129
    v_max3_f32 v38, v38, v130, v131
    v_max3_f32 v4, v4, v132, v133
    v_max3_f32 v38, v38, v134, v135
    v_max_f32 v38, v38, v4
    v_cmp_lt_f32 vcc, s30, v38
    s_waitcnt lgkmcnt(0)
    v_mfma_f32_32x32x16_bf16 v[216:231], v[252:255], v[164:167], v[216:231]
    s_nop 1
    s_cbranch_vccnz slow_39
ret_40:
    s_cmp_eq_u32 s21, 0
    s_cbranch_scc1 atB_final
    s_mov_b32 s22, s21
    s_cmp_eq_u32 s21, 1
    s_cbranch_scc1 atB_mpair
atB_loop:
    s_waitcnt vmcnt(0)
    s_barrier
    s_add_u32 m0, s26, 16384
    s_nop 0
    buffer_load_dwordx4 v28, s[8:11], s23 offen lds
    s_add_u32 m0, s26, 17408
    s_nop 0
    buffer_load_dwordx4 v29, s[8:11], s23 offen lds
    s_add_u32 m0, s26, 18432
    s_nop 0
    buffer_load_dwordx4 v30, s[8:11], s23 offen lds
    s_add_u32 m0, s26, 19456
    s_nop 0
    buffer_load_dwordx4 v31, s[8:11], s23 offen lds
    s_add_u32 s23, s23, 524288
    s_add_u32 m0, s26, 32768
    s_nop 0
    buffer_load_dwordx4 v32, s[8:11], s24 offen lds
    s_add_u32 m0, s26, 33792
    s_nop 0
    buffer_load_dwordx4 v33, s[8:11], s24 offen lds
    s_add_u32 m0, s26, 34816
    s_nop 0
    buffer_load_dwordx4 v34, s[8:11], s24 offen lds
    s_add_u32 m0, s26, 35840
    s_nop 0
    buffer_load_dwordx4 v35, s[8:11], s24 offen lds
    s_add_u32 s24, s24, 4096
    ds_read_b128 v[232:235], v16 offset:0
    ds_read_b128 v[236:239], v17 offset:0
    ds_read_b128 v[240:243], v18 offset:0
    ds_read_b128 v[244:247], v19 offset:0
    v_exp_f32 v104, v104
    v_exp_f32 v105, v105
    s_waitcnt lgkmcnt(3)
    v_mfma_f32_32x32x16_bf16 v[72:87], v[232:235], v[40:43], v[136:151]
    v_exp_f32 v106, v106
    v_exp_f32 v107, v107
    v_exp_f32 v108, v108
    ds_read_b128 v[248:251], v20 offset:0
    s_waitcnt lgkmcnt(3)
    v_mfma_f32_32x32x16_bf16 v[72:87], v[236:239], v[44:47], v[72:87]
    v_exp_f32 v109, v109
    v_exp_f32 v110, v110
    ds_read_b128 v[252:255], v21 offset:0
    s_waitcnt lgkmcnt(3)
    v_mfma_f32_32x32x16_bf16 v[72:87], v[240:243], v[48:51], v[72:87]
    v_exp_f32 v111, v111
    v_exp_f32 v112, v112
    v_exp_f32 v113, v113
    ds_read_b128 v[232:235], v22 offset:0
    s_waitcnt lgkmcnt(3)
    v_mfma_f32_32x32x16_bf16 v[72:87], v[244:247], v[52:55], v[72:87]
    v_exp_f32 v114, v114
    v_exp_f32 v115, v115
    ds_read_b128 v[236:239], v23 offset:0
    s_waitcnt lgkmcnt(3)
    v_mfma_f32_32x32x16_bf16 v[72:87], v[248:251], v[56:59], v[72:87]
    v_exp_f32 v116, v116
    v_exp_f32 v117, v117
    v_exp_f32 v118, v118
    ds_read_b128 v[240:243], v16 offset:8192
    s_waitcnt lgkmcnt(3)
    v_mfma_f32_32x32x16_bf16 v[72:87], v[252:255], v[60:63], v[72:87]
    v_exp_f32 v119, v119
    v_cvt_pk_bf16_f32 v152, v104, v105
    ds_read_b128 v[244:247], v17 offset:8192
    s_waitcnt lgkmcnt(3)
    v_mfma_f32_32x32x16_bf16 v[72:87], v[232:235], v[64:67], v[72:87]
    v_cvt_pk_bf16_f32 v153, v106, v107
    v_cvt_pk_bf16_f32 v154, v108, v109
    v_cvt_pk_bf16_f32 v155, v110, v111
    ds_read_b128 v[248:251], v18 offset:8192
    s_waitcnt lgkmcnt(3)
    v_mfma_f32_32x32x16_bf16 v[72:87], v[236:239], v[68:71], v[72:87]
    v_cvt_pk_bf16_f32 v156, v112, v113
    v_cvt_pk_bf16_f32 v157, v114, v115
    ds_read_b128 v[252:255], v19 offset:8192
    s_waitcnt lgkmcnt(3)
    v_mfma_f32_32x32x16_bf16 v[88:103], v[240:243], v[40:43], v[136:151]
    v_cvt_pk_bf16_f32 v158, v116, v117
    v_cvt_pk_bf16_f32 v159, v118, v119
    v_add_f32 v36, v36, v104
    ds_read_b128 v[232:235], v20 offset:8192
    s_waitcnt lgkmcnt(3)
    v_mfma_f32_32x32x16_bf16 v[88:103], v[244:247], v[44:47], v[88:103]
    v_add_f32 v37, v37, v105
    v_add_f32 v36, v36, v106
    ds_read_b128 v[236:239], v21 offset:8192
    s_waitcnt lgkmcnt(3)
    v_mfma_f32_32x32x16_bf16 v[88:103], v[248:251], v[48:51], v[88:103]
    v_add_f32 v37, v37, v107
    v_add_f32 v36, v36, v108
    v_add_f32 v37, v37, v109
    ds_read_b128 v[240:243], v22 offset:8192
    s_waitcnt lgkmcnt(3)
    v_mfma_f32_32x32x16_bf16 v[88:103], v[252:255], v[52:55], v[88:103]
    v_add_f32 v36, v36, v110
    v_add_f32 v37, v37, v111
    ds_read_b128 v[244:247], v23 offset:8192
    s_waitcnt lgkmcnt(3)
    v_mfma_f32_32x32x16_bf16 v[88:103], v[232:235], v[56:59], v[88:103]
    v_add_f32 v36, v36, v112
    v_add_f32 v37, v37, v113
    v_add_f32 v36, v36, v114
    ds_read_b128 v[248:251], v24 offset:49152
    s_waitcnt lgkmcnt(3)
    v_mfma_f32_32x32x16_bf16 v[88:103], v[236:239], v[60:63], v[88:103]
    v_add_f32 v37, v37, v115
    v_add_f32 v36, v36, v116
    ds_read_b128 v[252:255], v24 offset:53248
    s_waitcnt lgkmcnt(3)
    v_mfma_f32_32x32x16_bf16 v[88:103], v[240:243], v[64:67], v[88:103]
    v_add_f32 v37, v37, v117
    v_add_f32 v36, v36, v118
    v_add_f32 v37, v37, v119
    ds_read_b128 v[232:235], v24 offset:57344
    s_waitcnt lgkmcnt(3)
    v_mfma_f32_32x32x16_bf16 v[88:103], v[244:247], v[68:71], v[88:103]
    s_nop 1
    v_exp_f32 v120, v120
    v_exp_f32 v121, v121
    v_exp_f32 v122, v122
    ds_read_b128 v[236:239], v24 offset:61440
    s_waitcnt lgkmcnt(3)
    v_mfma_f32_32x32x16_bf16 v[168:183], v[248:251], v[152:155], v[168:183]
    v_exp_f32 v123, v123
    v_exp_f32 v124, v124
    v_exp_f32 v125, v125
    ds_read_b128 v[240:243], v25 offset:49152
    s_waitcnt lgkmcnt(3)
    v_mfma_f32_32x32x16_bf16 v[184:199], v[252:255], v[152:155], v[184:199]
    v_exp_f32 v126, v126
    v_exp_f32 v127, v127
    v_exp_f32 v128, v128
    ds_read_b128 v[244:247], v25 offset:53248
    s_waitcnt lgkmcnt(3)
    v_mfma_f32_32x32x16_bf16 v[200:215], v[232:235], v[152:155], v[200:215]
    v_exp_f32 v129, v129
    v_exp_f32 v130, v130
    v_exp_f32 v131, v131
    ds_read_b128 v[248:251], v25 offset:57344
    s_waitcnt lgkmcnt(3)
    v_mfma_f32_32x32x16_bf16 v[216:231], v[236:239], v[152:155], v[216:231]
    v_exp_f32 v132, v132
    v_exp_f32 v133, v133
    v_exp_f32 v134, v134
    ds_read_b128 v[252:255], v25 offset:61440
    s_waitcnt lgkmcnt(3)
    v_mfma_f32_32x32x16_bf16 v[168:183], v[240:243], v[156:159], v[168:183]
    v_exp_f32 v135, v135
    v_cvt_pk_bf16_f32 v160, v120, v121
    v_cvt_pk_bf16_f32 v161, v122, v123
    ds_read_b128 v[232:235], v26 offset:49152
    s_waitcnt lgkmcnt(3)
    v_mfma_f32_32x32x16_bf16 v[184:199], v[244:247], v[156:159], v[184:199]
    v_cvt_pk_bf16_f32 v162, v124, v125
    v_cvt_pk_bf16_f32 v163, v126, v127
    v_cvt_pk_bf16_f32 v164, v128, v129
    ds_read_b128 v[236:239], v26 offset:53248
    s_waitcnt lgkmcnt(3)
    v_mfma_f32_32x32x16_bf16 v[200:215], v[248:251], v[156:159], v[200:215]
    v_cvt_pk_bf16_f32 v165, v130, v131
    v_cvt_pk_bf16_f32 v166, v132, v133
    v_cvt_pk_bf16_f32 v167, v134, v135
    ds_read_b128 v[240:243], v26 offset:57344
    s_waitcnt lgkmcnt(3)
    v_mfma_f32_32x32x16_bf16 v[216:231], v[252:255], v[156:159], v[216:231]
    s_nop 1
    v_add_f32 v36, v36, v120
    v_add_f32 v37, v37, v121
    v_add_f32 v36, v36, v122
    v_add_f32 v37, v37, v123
    ds_read_b128 v[244:247], v26 offset:61440
    s_waitcnt lgkmcnt(3)
    v_mfma_f32_32x32x16_bf16 v[168:183], v[232:235], v[160:163], v[168:183]
    v_add_f32 v36, v36, v124
    v_add_f32 v37, v37, v125
    v_add_f32 v36, v36, v126
    v_add_f32 v37, v37, v127
    ds_read_b128 v[248:251], v27 offset:49152
    s_waitcnt lgkmcnt(3)
    v_mfma_f32_32x32x16_bf16 v[184:199], v[236:239], v[160:163], v[184:199]
    v_add_f32 v36, v36, v128
    v_add_f32 v37, v37, v129
    v_add_f32 v36, v36, v130
    v_add_f32 v37, v37, v131
    ds_read_b128 v[252:255], v27 offset:53248
    s_waitcnt lgkmcnt(3)
    v_mfma_f32_32x32x16_bf16 v[200:215], v[240:243], v[160:163], v[200:215]
    v_add_f32 v36, v36, v132
    v_add_f32 v37, v37, v133
    v_add_f32 v36, v36, v134
    v_add_f32 v37, v37, v135
    ds_read_b128 v[232:235], v27 offset:57344
    s_waitcnt lgkmcnt(3)
    v_mfma_f32_32x32x16_bf16 v[216:231], v[244:247], v[160:163], v[216:231]
    v_max3_f32 v38, v72, v73, v74
    v_max3_f32 v4, v75, v76, v77
    v_max3_f32 v38, v38, v78, v79
    v_max3_f32 v4, v4, v80, v81
    ds_read_b128 v[236:239], v27 offset:61440
    s_waitcnt lgkmcnt(3)
    v_mfma_f32_32x32x16_bf16 v[168:183], v[248:251], v[164:167], v[168:183]
    v_max3_f32 v38, v38, v82, v83
    v_max3_f32 v4, v4, v84, v85
    v_max3_f32 v38, v38, v86, v87
    v_max3_f32 v4, v4, v88, v89
    s_waitcnt lgkmcnt(2)
    v_mfma_f32_32x32x16_bf16 v[184:199], v[252:255], v[164:167], v[184:199]
    v_max3_f32 v38, v38, v90, v91
    v_max3_f32 v4, v4, v92, v93
    v_max3_f32 v38, v38, v94, v95
    v_max3_f32 v4, v4, v96, v97
    s_waitcnt lgkmcnt(1)
    v_mfma_f32_32x32x16_bf16 v[200:215], v[232:235], v[164:167], v[200:215]
    v_max3_f32 v38, v38, v98, v99
    v_max3_f32 v4, v4, v100, v101
    v_max3_f32 v38, v38, v102, v103
    v_max_f32 v38, v38, v4
    v_cmp_lt_f32 vcc, s30, v38
    s_waitcnt lgkmcnt(0)
    v_mfma_f32_32x32x16_bf16 v[216:231], v[236:239], v[164:167], v[216:231]
    s_nop 1
    s_cbranch_vccnz slow_41
ret_42:
    s_waitcnt vmcnt(0)
    s_barrier
    s_add_u32 m0, s26, 0
    s_nop 0
    buffer_load_dwordx4 v28, s[8:11], s23 offen lds
    s_add_u32 m0, s26, 1024
    s_nop 0
    buffer_load_dwordx4 v29, s[8:11], s23 offen lds
    s_add_u32 m0, s26, 2048
    s_nop 0
    buffer_load_dwordx4 v30, s[8:11], s23 offen lds
    s_add_u32 m0, s26, 3072
    s_nop 0
    buffer_load_dwordx4 v31, s[8:11], s23 offen lds
    s_add_u32 s23, s23, 524288
    s_add_u32 m0, s26, 49152
    s_nop 0
    buffer_load_dwordx4 v32, s[8:11], s24 offen lds
    s_add_u32 m0, s26, 50176
    s_nop 0
    buffer_load_dwordx4 v33, s[8:11], s24 offen lds
    s_add_u32 m0, s26, 51200
    s_nop 0
    buffer_load_dwordx4 v34, s[8:11], s24 offen lds
    s_add_u32 m0, s26, 52224
    s_nop 0
    buffer_load_dwordx4 v35, s[8:11], s24 offen lds
    s_add_u32 s24, s24, 4096
    ds_read_b128 v[240:243], v16 offset:16384
    ds_read_b128 v[244:247], v17 offset:16384
    ds_read_b128 v[248:251], v18 offset:16384
    ds_read_b128 v[252:255], v19 offset:16384
    v_exp_f32 v72, v72
    v_exp_f32 v73, v73
    s_waitcnt lgkmcnt(3)
    v_mfma_f32_32x32x16_bf16 v[104:119], v[240:243], v[40:43], v[136:151]
    v_exp_f32 v74, v74
    v_exp_f32 v75, v75
    v_exp_f32 v76, v76
    ds_read_b128 v[232:235], v20 offset:16384
    s_waitcnt lgkmcnt(3)
    v_mfma_f32_32x32x16_bf16 v[104:119], v[244:247], v[44:47], v[104:119]
    v_exp_f32 v77, v77
    v_exp_f32 v78, v78
    ds_read_b128 v[236:239], v21 offset:16384
    s_waitcnt lgkmcnt(3)
    v_mfma_f32_32x32x16_bf16 v[104:119], v[248:251], v[48:51], v[104:119]
    v_exp_f32 v79, v79
    v_exp_f32 v80, v80
    v_exp_f32 v81, v81
    ds_read_b128 v[240:243], v22 offset:16384
    s_waitcnt lgkmcnt(3)
    v_mfma_f32_32x32x16_bf16 v[104:119], v[252:255], v[52:55], v[104:119]
    v_exp_f32 v82, v82
    v_exp_f32 v83, v83
    ds_read_b128 v[244:247], v23 offset:16384
    s_waitcnt lgkmcnt(3)
    v_mfma_f32_32x32x16_bf16 v[104:119], v[232:235], v[56:59], v[104:119]
    v_exp_f32 v84, v84
    v_exp_f32 v85, v85
    v_exp_f32 v86, v86
    ds_read_b128 v[248:251], v16 offset:24576
    s_waitcnt lgkmcnt(3)
    v_mfma_f32_32x32x16_bf16 v[104:119], v[236:239], v[60:63], v[104:119]
    v_exp_f32 v87, v87
    v_cvt_pk_bf16_f32 v152, v72, v73
    ds_read_b128 v[252:255], v17 offset:24576
    s_waitcnt lgkmcnt(3)
    v_mfma_f32_32x32x16_bf16 v[104:119], v[240:243], v[64:67], v[104:119]
    v_cvt_pk_bf16_f32 v153, v74, v75
    v_cvt_pk_bf16_f32 v154, v76, v77
    v_cvt_pk_bf16_f32 v155, v78, v79
    ds_read_b128 v[232:235], v18 offset:24576
    s_waitcnt lgkmcnt(3)
    v_mfma_f32_32x32x16_bf16 v[104:119], v[244:247], v[68:71], v[104:119]
    v_cvt_pk_bf16_f32 v156, v80, v81
    v_cvt_pk_bf16_f32 v157, v82, v83
    ds_read_b128 v[236:239], v19 offset:24576
    s_waitcnt lgkmcnt(3)
    v_mfma_f32_32x32x16_bf16 v[120:135], v[248:251], v[40:43], v[136:151]
    v_cvt_pk_bf16_f32 v158, v84, v85
    v_cvt_pk_bf16_f32 v159, v86, v87
    v_add_f32 v36, v36, v72
    ds_read_b128 v[240:243], v20 offset:24576
    s_waitcnt lgkmcnt(3)
    v_mfma_f32_32x32x16_bf16 v[120:135], v[252:255], v[44:47], v[120:135]
    v_add_f32 v37, v37, v73
    v_add_f32 v36, v36, v74
    ds_read_b128 v[244:247], v21 offset:24576
    s_waitcnt lgkmcnt(3)
    v_mfma_f32_32x32x16_bf16 v[120:135], v[232:235], v[48:51], v[120:135]
    v_add_f32 v37, v37, v75
    v_add_f32 v36, v36, v76
    v_add_f32 v37, v37, v77
    ds_read_b128 v[248:251], v22 offset:24576
    s_waitcnt lgkmcnt(3)
    v_mfma_f32_32x32x16_bf16 v[120:135], v[236:239], v[52:55], v[120:135]
    v_add_f32 v36, v36, v78
    v_add_f32 v37, v37, v79
    ds_read_b128 v[252:255], v23 offset:24576
    s_waitcnt lgkmcnt(3)
    v_mfma_f32_32x32x16_bf16 v[120:135], v[240:243], v[56:59], v[120:135]
    v_add_f32 v36, v36, v80
    v_add_f32 v37, v37, v81
    v_add_f32 v36, v36, v82
    ds_read_b128 v[232:235], v24 offset:32768
    s_waitcnt lgkmcnt(3)
    v_mfma_f32_32x32x16_bf16 v[120:135], v[244:247], v[60:63], v[120:135]
    v_add_f32 v37, v37, v83
    v_add_f32 v36, v36, v84
    ds_read_b128 v[236:239], v24 offset:36864
    s_waitcnt lgkmcnt(3)
    v_mfma_f32_32x32x16_bf16 v[120:135], v[248:251], v[64:67], v[120:135]
    v_add_f32 v37, v37, v85
    v_add_f32 v36, v36, v86
    v_add_f32 v37, v37, v87
    ds_read_b128 v[240:243], v24 offset:40960
    s_waitcnt lgkmcnt(3)
    v_mfma_f32_32x32x16_bf16 v[120:135], v[252:255], v[68:71], v[120:135]
    s_nop 1
    v_exp_f32 v88, v88
    v_exp_f32 v89, v89
    v_exp_f32 v90, v90
    ds_read_b128 v[244:247], v24 offset:45056
    s_waitcnt lgkmcnt(3)
    v_mfma_f32_32x32x16_bf16 v[168:183], v[232:235], v[152:155], v[168:183]
    v_exp_f32 v91, v91
    v_exp_f32 v92, v92
    v_exp_f32 v93, v93
    ds_read_b128 v[248:251], v25 offset:32768
    s_waitcnt lgkmcnt(3)
    v_mfma_f32_32x32x16_bf16 v[184:199], v[236:239], v[152:155], v[184:199]
    v_exp_f32 v94, v94
    v_exp_f32 v95, v95
    v_exp_f32 v96, v96
    ds_read_b128 v[252:255], v25 offset:36864
    s_waitcnt lgkmcnt(3)
    v_mfma_f32_32x32x16_bf16 v[200:215], v[240:243], v[152:155], v[200:215]
    v_exp_f32 v97, v97
    v_exp_f32 v98, v98
    v_exp_f32 v99, v99
    ds_read_b128 v[232:235], v25 offset:40960
    s_waitcnt lgkmcnt(3)
    v_mfma_f32_32x32x16_bf16 v[216:231], v[244:247], v[152:155], v[216:231]
    v_exp_f32 v100, v100
    v_exp_f32 v101, v101
    v_exp_f32 v102, v102
    ds_read_b128 v[236:239], v25 offset:45056
    s_waitcnt lgkmcnt(3)
    v_mfma_f32_32x32x16_bf16 v[168:183], v[248:251], v[156:159], v[168:183]
    v_exp_f32 v103, v103
    v_cvt_pk_bf16_f32 v160, v88, v89
    v_cvt_pk_bf16_f32 v161, v90, v91
    ds_read_b128 v[240:243], v26 offset:32768
    s_waitcnt lgkmcnt(3)
    v_mfma_f32_32x32x16_bf16 v[184:199], v[252:255], v[156:159], v[184:199]
    v_cvt_pk_bf16_f32 v162, v92, v93
    v_cvt_pk_bf16_f32 v163, v94, v95
    v_cvt_pk_bf16_f32 v164, v96, v97
    ds_read_b128 v[244:247], v26 offset:36864
    s_waitcnt lgkmcnt(3)
    v_mfma_f32_32x32x16_bf16 v[200:215], v[232:235], v[156:159], v[200:215]
    v_cvt_pk_bf16_f32 v165, v98, v99
    v_cvt_pk_bf16_f32 v166, v100, v101
    v_cvt_pk_bf16_f32 v167, v102, v103
    ds_read_b128 v[248:251], v26 offset:40960
    s_waitcnt lgkmcnt(3)
    v_mfma_f32_32x32x16_bf16 v[216:231], v[236:239], v[156:159], v[216:231]
    s_nop 1
    v_add_f32 v36, v36, v88
    v_add_f32 v37, v37, v89
    v_add_f32 v36, v36, v90
    v_add_f32 v37, v37, v91
    ds_read_b128 v[252:255], v26 offset:45056
    s_waitcnt lgkmcnt(3)
    v_mfma_f32_32x32x16_bf16 v[168:183], v[240:243], v[160:163], v[168:183]
    v_add_f32 v36, v36, v92
    v_add_f32 v37, v37, v93
    v_add_f32 v36, v36, v94
    v_add_f32 v37, v37, v95
    ds_read_b128 v[232:235], v27 offset:32768
    s_waitcnt lgkmcnt(3)
    v_mfma_f32_32x32x16_bf16 v[184:199], v[244:247], v[160:163], v[184:199]
    v_add_f32 v36, v36, v96
    v_add_f32 v37, v37, v97
    v_add_f32 v36, v36, v98
    v_add_f32 v37, v37, v99
    ds_read_b128 v[236:239], v27 offset:36864
    s_waitcnt lgkmcnt(3)
    v_mfma_f32_32x32x16_bf16 v[200:215], v[248:251], v[160:163], v[200:215]
    v_add_f32 v36, v36, v100
    v_add_f32 v37, v37, v101
    v_add_f32 v36, v36, v102
    v_add_f32 v37, v37, v103
    ds_read_b128 v[240:243], v27 offset:40960
    s_waitcnt lgkmcnt(3)
    v_mfma_f32_32x32x16_bf16 v[216:231], v[252:255], v[160:163], v[216:231]
    v_max3_f32 v38, v104, v105, v106
    v_max3_f32 v4, v107, v108, v109
    v_max3_f32 v38, v38, v110, v111
    v_max3_f32 v4, v4, v112, v113
    ds_read_b128 v[244:247], v27 offset:45056
    s_waitcnt lgkmcnt(3)
    v_mfma_f32_32x32x16_bf16 v[168:183], v[232:235], v[164:167], v[168:183]
    v_max3_f32 v38, v38, v114, v115
    v_max3_f32 v4, v4, v116, v117
    v_max3_f32 v38, v38, v118, v119
    v_max3_f32 v4, v4, v120, v121
    s_waitcnt lgkmcnt(2)
    v_mfma_f32_32x32x16_bf16 v[184:199], v[236:239], v[164:167], v[184:199]
    v_max3_f32 v38, v38, v122, v123
    v_max3_f32 v4, v4, v124, v125
    v_max3_f32 v38, v38, v126, v127
    v_max3_f32 v4, v4, v128, v129
    s_waitcnt lgkmcnt(1)
    v_mfma_f32_32x32x16_bf16 v[200:215], v[240:243], v[164:167], v[200:215]
    v_max3_f32 v38, v38, v130, v131
    v_max3_f32 v4, v4, v132, v133
    v_max3_f32 v38, v38, v134, v135
    v_max_f32 v38, v38, v4
    v_cmp_lt_f32 vcc, s30, v38
    s_waitcnt lgkmcnt(0)
    v_mfma_f32_32x32x16_bf16 v[216:231], v[244:247], v[164:167], v[216:231]
    s_nop 1
    s_cbranch_vccnz slow_43
ret_44:
    s_sub_u32 s22, s22, 1
    s_cmp_lg_u32 s22, 1
    s_cbranch_scc1 atB_loop
atB_mpair:
    s_lshl_b32 s36, s21, 7
    v_lshlrev_b32 v3, 2, v8
    v_sub_u32 v3, v9, v3
    v_subrev_u32 v3, s36, v3
    s_waitcnt vmcnt(0)
    s_barrier
    s_add_u32 m0, s26, 16384
    s_nop 0
    buffer_load_dwordx4 v28, s[8:11], s23 offen lds
    s_add_u32 m0, s26, 17408
    s_nop 0
    buffer_load_dwordx4 v29, s[8:11], s23 offen lds
    s_add_u32 m0, s26, 18432
    s_nop 0
    buffer_load_dwordx4 v30, s[8:11], s23 offen lds
    s_add_u32 m0, s26, 19456
    s_nop 0
    buffer_load_dwordx4 v31, s[8:11], s23 offen lds
    s_add_u32 s23, s23, 524288
    s_add_u32 m0, s26, 32768
    s_nop 0
    buffer_load_dwordx4 v32, s[8:11], s24 offen lds
    s_add_u32 m0, s26, 33792
    s_nop 0
    buffer_load_dwordx4 v33, s[8:11], s24 offen lds
    s_add_u32 m0, s26, 34816
    s_nop 0
    buffer_load_dwordx4 v34, s[8:11], s24 offen lds
    s_add_u32 m0, s26, 35840
    s_nop 0
    buffer_load_dwordx4 v35, s[8:11], s24 offen lds
    s_add_u32 s24, s24, 4096
    ds_read_b128 v[248:251], v16 offset:0
    ds_read_b128 v[252:255], v17 offset:0
    ds_read_b128 v[232:235], v18 offset:0
    ds_read_b128 v[236:239], v19 offset:0
    v_exp_f32 v104, v104
    v_exp_f32 v105, v105
    s_waitcnt lgkmcnt(3)
    v_mfma_f32_32x32x16_bf16 v[72:87], v[248:251], v[40:43], v[136:151]
    v_exp_f32 v106, v106
    v_exp_f32 v107, v107
    v_exp_f32 v108, v108
    ds_read_b128 v[240:243], v20 offset:0
    s_waitcnt lgkmcnt(3)
    v_mfma_f32_32x32x16_bf16 v[72:87], v[252:255], v[44:47], v[72:87]
    v_exp_f32 v109, v109
    v_exp_f32 v110, v110
    ds_read_b128 v[244:247], v21 offset:0
    s_waitcnt lgkmcnt(3)
    v_mfma_f32_32x32x16_bf16 v[72:87], v[232:235], v[48:51], v[72:87]
    v_exp_f32 v111, v111
    v_exp_f32 v112, v112
    v_exp_f32 v113, v113
    ds_read_b128 v[248:251], v22 offset:0
    s_waitcnt lgkmcnt(3)
    v_mfma_f32_32x32x16_bf16 v[72:87], v[236:239], v[52:55], v[72:87]
    v_exp_f32 v114, v114
    v_exp_f32 v115, v115
    ds_read_b128 v[252:255], v23 offset:0
    s_waitcnt lgkmcnt(3)
    v_mfma_f32_32x32x16_bf16 v[72:87], v[240:243], v[56:59], v[72:87]
    v_exp_f32 v116, v116
    v_exp_f32 v117, v117
    v_exp_f32 v118, v118
    ds_read_b128 v[232:235], v16 offset:8192
    s_waitcnt lgkmcnt(3)
    v_mfma_f32_32x32x16_bf16 v[72:87], v[244:247], v[60:63], v[72:87]
    v_exp_f32 v119, v119
    v_cvt_pk_bf16_f32 v152, v104, v105
    ds_read_b128 v[236:239], v17 offset:8192
    s_waitcnt lgkmcnt(3)
    v_mfma_f32_32x32x16_bf16 v[72:87], v[248:251], v[64:67], v[72:87]
    v_cvt_pk_bf16_f32 v153, v106, v107
    v_cvt_pk_bf16_f32 v154, v108, v109
    v_cvt_pk_bf16_f32 v155, v110, v111
    ds_read_b128 v[240:243], v18 offset:8192
    s_waitcnt lgkmcnt(3)
    v_mfma_f32_32x32x16_bf16 v[72:87], v[252:255], v[68:71], v[72:87]
    v_cvt_pk_bf16_f32 v156, v112, v113
    v_cvt_pk_bf16_f32 v157, v114, v115
    ds_read_b128 v[244:247], v19 offset:8192
    s_waitcnt lgkmcnt(3)
    v_mfma_f32_32x32x16_bf16 v[88:103], v[232:235], v[40:43], v[136:151]
    v_cvt_pk_bf16_f32 v158, v116, v117
    v_cvt_pk_bf16_f32 v159, v118, v119
    v_add_f32 v36, v36, v104
    ds_read_b128 v[248:251], v20 offset:8192
    s_waitcnt lgkmcnt(3)
    v_mfma_f32_32x32x16_bf16 v[88:103], v[236:239], v[44:47], v[88:103]
    v_add_f32 v37, v37, v105
    v_add_f32 v36, v36, v106
    ds_read_b128 v[252:255], v21 offset:8192
    s_waitcnt lgkmcnt(3)
    v_mfma_f32_32x32x16_bf16 v[88:103], v[240:243], v[48:51], v[88:103]
    v_add_f32 v37, v37, v107
    v_add_f32 v36, v36, v108
    v_add_f32 v37, v37, v109
    ds_read_b128 v[232:235], v22 offset:8192
    s_waitcnt lgkmcnt(3)
    v_mfma_f32_32x32x16_bf16 v[88:103], v[244:247], v[52:55], v[88:103]
    v_add_f32 v36, v36, v110
    v_add_f32 v37, v37, v111
    ds_read_b128 v[236:239], v23 offset:8192
    s_waitcnt lgkmcnt(3)
    v_mfma_f32_32x32x16_bf16 v[88:103], v[248:251], v[56:59], v[88:103]
    v_add_f32 v36, v36, v112
    v_add_f32 v37, v37, v113
    v_add_f32 v36, v36, v114
    ds_read_b128 v[240:243], v24 offset:49152
    s_waitcnt lgkmcnt(3)
    v_mfma_f32_32x32x16_bf16 v[88:103], v[252:255], v[60:63], v[88:103]
    v_add_f32 v37, v37, v115
    v_add_f32 v36, v36, v116
    ds_read_b128 v[244:247], v24 offset:53248
    s_waitcnt lgkmcnt(3)
    v_mfma_f32_32x32x16_bf16 v[88:103], v[232:235], v[64:67], v[88:103]
    v_add_f32 v37, v37, v117
    v_add_f32 v36, v36, v118
    v_add_f32 v37, v37, v119
    ds_read_b128 v[248:251], v24 offset:57344
    s_waitcnt lgkmcnt(3)
    v_mfma_f32_32x32x16_bf16 v[88:103], v[236:239], v[68:71], v[88:103]
    s_nop 1
    v_exp_f32 v120, v120
    v_exp_f32 v121, v121
    v_exp_f32 v122, v122
    ds_read_b128 v[252:255], v24 offset:61440
    s_waitcnt lgkmcnt(3)
    v_mfma_f32_32x32x16_bf16 v[168:183], v[240:243], v[152:155], v[168:183]
    v_exp_f32 v123, v123
    v_exp_f32 v124, v124
    v_exp_f32 v125, v125
    ds_read_b128 v[232:235], v25 offset:49152
    s_waitcnt lgkmcnt(3)
    v_mfma_f32_32x32x16_bf16 v[184:199], v[244:247], v[152:155], v[184:199]
    v_exp_f32 v126, v126
    v_exp_f32 v127, v127
    v_exp_f32 v128, v128
    ds_read_b128 v[236:239], v25 offset:53248
    s_waitcnt lgkmcnt(3)
    v_mfma_f32_32x32x16_bf16 v[200:215], v[248:251], v[152:155], v[200:215]
    v_exp_f32 v129, v129
    v_exp_f32 v130, v130
    v_exp_f32 v131, v131
    ds_read_b128 v[240:243], v25 offset:57344
    s_waitcnt lgkmcnt(3)
    v_mfma_f32_32x32x16_bf16 v[216:231], v[252:255], v[152:155], v[216:231]
    v_exp_f32 v132, v132
    v_exp_f32 v133, v133
    v_exp_f32 v134, v134
    ds_read_b128 v[244:247], v25 offset:61440
    s_waitcnt lgkmcnt(3)
    v_mfma_f32_32x32x16_bf16 v[168:183], v[232:235], v[156:159], v[168:183]
    v_exp_f32 v135, v135
    v_cvt_pk_bf16_f32 v160, v120, v121
    v_cvt_pk_bf16_f32 v161, v122, v123
    ds_read_b128 v[248:251], v26 offset:49152
    s_waitcnt lgkmcnt(3)
    v_mfma_f32_32x32x16_bf16 v[184:199], v[236:239], v[156:159], v[184:199]
    v_cvt_pk_bf16_f32 v162, v124, v125
    v_cvt_pk_bf16_f32 v163, v126, v127
    v_cvt_pk_bf16_f32 v164, v128, v129
    ds_read_b128 v[252:255], v26 offset:53248
    s_waitcnt lgkmcnt(3)
    v_mfma_f32_32x32x16_bf16 v[200:215], v[240:243], v[156:159], v[200:215]
    v_cvt_pk_bf16_f32 v165, v130, v131
    v_cvt_pk_bf16_f32 v166, v132, v133
    v_cvt_pk_bf16_f32 v167, v134, v135
    ds_read_b128 v[232:235], v26 offset:57344
    s_waitcnt lgkmcnt(3)
    v_mfma_f32_32x32x16_bf16 v[216:231], v[244:247], v[156:159], v[216:231]
    s_nop 1
    v_add_f32 v36, v36, v120
    v_add_f32 v37, v37, v121
    v_add_f32 v36, v36, v122
    v_add_f32 v37, v37, v123
    v_add_f32 v36, v36, v124
    v_add_f32 v37, v37, v125
    v_add_f32 v36, v36, v126
    v_add_f32 v37, v37, v127
    ds_read_b128 v[236:239], v26 offset:61440
    s_waitcnt lgkmcnt(3)
    v_mfma_f32_32x32x16_bf16 v[168:183], v[248:251], v[160:163], v[168:183]
    v_add_f32 v36, v36, v128
    v_add_f32 v37, v37, v129
    v_add_f32 v36, v36, v130
    v_add_f32 v37, v37, v131
    v_add_f32 v36, v36, v132
    v_add_f32 v37, v37, v133
    v_add_f32 v36, v36, v134
    v_add_f32 v37, v37, v135
    ds_read_b128 v[240:243], v27 offset:49152
    s_waitcnt lgkmcnt(3)
    v_mfma_f32_32x32x16_bf16 v[184:199], v[252:255], v[160:163], v[184:199]
    v_cmp_gt_i32 vcc, 0, v3
    s_nop 1
    v_cndmask_b32 v72, v72, v2, vcc
    v_cmp_gt_i32 vcc, 1, v3
    s_nop 1
    v_cndmask_b32 v73, v73, v2, vcc
    v_cmp_gt_i32 vcc, 2, v3
    s_nop 1
    v_cndmask_b32 v74, v74, v2, vcc
    v_cmp_gt_i32 vcc, 3, v3
    s_nop 1
    v_cndmask_b32 v75, v75, v2, vcc
    v_cmp_gt_i32 vcc, 8, v3
    s_nop 1
    v_cndmask_b32 v76, v76, v2, vcc
    v_cmp_gt_i32 vcc, 9, v3
    s_nop 1
    v_cndmask_b32 v77, v77, v2, vcc
    v_cmp_gt_i32 vcc, 10, v3
    s_nop 1
    v_cndmask_b32 v78, v78, v2, vcc
    v_cmp_gt_i32 vcc, 11, v3
    s_nop 1
    v_cndmask_b32 v79, v79, v2, vcc
    ds_read_b128 v[244:247], v27 offset:53248
    s_waitcnt lgkmcnt(3)
    v_mfma_f32_32x32x16_bf16 v[200:215], v[232:235], v[160:163], v[200:215]
    v_cmp_gt_i32 vcc, 16, v3
    s_nop 1
    v_cndmask_b32 v80, v80, v2, vcc
    v_cmp_gt_i32 vcc, 17, v3
    s_nop 1
    v_cndmask_b32 v81, v81, v2, vcc
    v_cmp_gt_i32 vcc, 18, v3
    s_nop 1
    v_cndmask_b32 v82, v82, v2, vcc
    v_cmp_gt_i32 vcc, 19, v3
    s_nop 1
    v_cndmask_b32 v83, v83, v2, vcc
    v_cmp_gt_i32 vcc, 24, v3
    s_nop 1
    v_cndmask_b32 v84, v84, v2, vcc
    v_cmp_gt_i32 vcc, 25, v3
    s_nop 1
    v_cndmask_b32 v85, v85, v2, vcc
    v_cmp_gt_i32 vcc, 26, v3
    s_nop 1
    v_cndmask_b32 v86, v86, v2, vcc
    v_cmp_gt_i32 vcc, 27, v3
    s_nop 1
    v_cndmask_b32 v87, v87, v2, vcc
    ds_read_b128 v[248:251], v27 offset:57344
    s_waitcnt lgkmcnt(3)
    v_mfma_f32_32x32x16_bf16 v[216:231], v[236:239], v[160:163], v[216:231]
    v_cmp_gt_i32 vcc, 32, v3
    s_nop 1
    v_cndmask_b32 v88, v88, v2, vcc
    v_cmp_gt_i32 vcc, 33, v3
    s_nop 1
    v_cndmask_b32 v89, v89, v2, vcc
    v_cmp_gt_i32 vcc, 34, v3
    s_nop 1
    v_cndmask_b32 v90, v90, v2, vcc
    v_cmp_gt_i32 vcc, 35, v3
    s_nop 1
    v_cndmask_b32 v91, v91, v2, vcc
    v_cmp_gt_i32 vcc, 40, v3
    s_nop 1
    v_cndmask_b32 v92, v92, v2, vcc
    v_cmp_gt_i32 vcc, 41, v3
    s_nop 1
    v_cndmask_b32 v93, v93, v2, vcc
    v_cmp_gt_i32 vcc, 42, v3
    s_nop 1
    v_cndmask_b32 v94, v94, v2, vcc
    v_cmp_gt_i32 vcc, 43, v3
    s_nop 1
    v_cndmask_b32 v95, v95, v2, vcc
    ds_read_b128 v[252:255], v27 offset:61440
    s_waitcnt lgkmcnt(3)
    v_mfma_f32_32x32x16_bf16 v[168:183], v[240:243], v[164:167], v[168:183]
    v_cmp_gt_i32 vcc, 48, v3
    s_nop 1
    v_cndmask_b32 v96, v96, v2, vcc
    v_cmp_gt_i32 vcc, 49, v3
    s_nop 1
    v_cndmask_b32 v97, v97, v2, vcc
    v_cmp_gt_i32 vcc, 50, v3
    s_nop 1
    v_cndmask_b32 v98, v98, v2, vcc
    v_cmp_gt_i32 vcc, 51, v3
    s_nop 1
    v_cndmask_b32 v99, v99, v2, vcc
    v_cmp_gt_i32 vcc, 56, v3
    s_nop 1
    v_cndmask_b32 v100, v100, v2, vcc
    v_cmp_gt_i32 vcc, 57, v3
    s_nop 1
    v_cndmask_b32 v101, v101, v2, vcc
    v_cmp_gt_i32 vcc, 58, v3
    s_nop 1
    v_cndmask_b32 v102, v102, v2, vcc
    v_cmp_gt_i32 vcc, 59, v3
    s_nop 1
    v_cndmask_b32 v103, v103, v2, vcc
    s_waitcnt lgkmcnt(2)
    v_mfma_f32_32x32x16_bf16 v[184:199], v[244:247], v[164:167], v[184:199]
    v_max3_f32 v38, v72, v73, v74
    v_max3_f32 v4, v75, v76, v77
    v_max3_f32 v38, v38, v78, v79
    v_max3_f32 v4, v4, v80, v81
    v_max3_f32 v38, v38, v82, v83
    v_max3_f32 v4, v4, v84, v85
    v_max3_f32 v38, v38, v86, v87
    v_max3_f32 v4, v4, v88, v89
    s_waitcnt lgkmcnt(1)
    v_mfma_f32_32x32x16_bf16 v[200:215], v[248:251], v[164:167], v[200:215]
    v_max3_f32 v38, v38, v90, v91
    v_max3_f32 v4, v4, v92, v93
    v_max3_f32 v38, v38, v94, v95
    v_max3_f32 v4, v4, v96, v97
    v_max3_f32 v38, v38, v98, v99
    v_max3_f32 v4, v4, v100, v101
    v_max3_f32 v38, v38, v102, v103
    v_max_f32 v38, v38, v4
    v_cmp_lt_f32 vcc, s30, v38
    s_waitcnt lgkmcnt(0)
    v_mfma_f32_32x32x16_bf16 v[216:231], v[252:255], v[164:167], v[216:231]
    s_nop 1
    s_cbranch_vccnz slow_45
ret_46:
    v_subrev_u32 v3, 64, v3
    s_waitcnt vmcnt(0)
    s_barrier
    s_add_u32 m0, s26, 49152
    s_nop 0
    buffer_load_dwordx4 v32, s[8:11], s24 offen lds
    s_add_u32 m0, s26, 50176
    s_nop 0
    buffer_load_dwordx4 v33, s[8:11], s24 offen lds
    s_add_u32 m0, s26, 51200
    s_nop 0
    buffer_load_dwordx4 v34, s[8:11], s24 offen lds
    s_add_u32 m0, s26, 52224
    s_nop 0
    buffer_load_dwordx4 v35, s[8:11], s24 offen lds
    s_add_u32 s24, s24, 4096
    ds_read_b128 v[232:235], v16 offset:16384
    ds_read_b128 v[236:239], v17 offset:16384
    ds_read_b128 v[240:243], v18 offset:16384
    ds_read_b128 v[244:247], v19 offset:16384
    v_exp_f32 v72, v72
    v_exp_f32 v73, v73
    s_waitcnt lgkmcnt(3)
    v_mfma_f32_32x32x16_bf16 v[104:119], v[232:235], v[40:43], v[136:151]
    v_exp_f32 v74, v74
    v_exp_f32 v75, v75
    v_exp_f32 v76, v76
    ds_read_b128 v[248:251], v20 offset:16384
    s_waitcnt lgkmcnt(3)
    v_mfma_f32_32x32x16_bf16 v[104:119], v[236:239], v[44:47], v[104:119]
    v_exp_f32 v77, v77
    v_exp_f32 v78, v78
    ds_read_b128 v[252:255], v21 offset:16384
    s_waitcnt lgkmcnt(3)
    v_mfma_f32_32x32x16_bf16 v[104:119], v[240:243], v[48:51], v[104:119]
    v_exp_f32 v79, v79
    v_exp_f32 v80, v80
    v_exp_f32 v81, v81
    ds_read_b128 v[232:235], v22 offset:16384
    s_waitcnt lgkmcnt(3)
    v_mfma_f32_32x32x16_bf16 v[104:119], v[244:247], v[52:55], v[104:119]
    v_exp_f32 v82, v82
    v_exp_f32 v83, v83
    ds_read_b128 v[236:239], v23 offset:16384
    s_waitcnt lgkmcnt(3)
    v_mfma_f32_32x32x16_bf16 v[104:119], v[248:251], v[56:59], v[104:119]
    v_exp_f32 v84, v84
    v_exp_f32 v85, v85
    v_exp_f32 v86, v86
    ds_read_b128 v[240:243], v16 offset:24576
    s_waitcnt lgkmcnt(3)
    v_mfma_f32_32x32x16_bf16 v[104:119], v[252:255], v[60:63], v[104:119]
    v_exp_f32 v87, v87
    v_cvt_pk_bf16_f32 v152, v72, v73
    ds_read_b128 v[244:247], v17 offset:24576
    s_waitcnt lgkmcnt(3)
    v_mfma_f32_32x32x16_bf16 v[104:119], v[232:235], v[64:67], v[104:119]
    v_cvt_pk_bf16_f32 v153, v74, v75
    v_cvt_pk_bf16_f32 v154, v76, v77
    v_cvt_pk_bf16_f32 v155, v78, v79
    ds_read_b128 v[248:251], v18 offset:24576
    s_waitcnt lgkmcnt(3)
    v_mfma_f32_32x32x16_bf16 v[104:119], v[236:239], v[68:71], v[104:119]
    v_cvt_pk_bf16_f32 v156, v80, v81
    v_cvt_pk_bf16_f32 v157, v82, v83
    ds_read_b128 v[252:255], v19 offset:24576
    s_waitcnt lgkmcnt(3)
    v_mfma_f32_32x32x16_bf16 v[120:135], v[240:243], v[40:43], v[136:151]
    v_cvt_pk_bf16_f32 v158, v84, v85
    v_cvt_pk_bf16_f32 v159, v86, v87
    v_add_f32 v36, v36, v72
    ds_read_b128 v[232:235], v20 offset:24576
    s_waitcnt lgkmcnt(3)
    v_mfma_f32_32x32x16_bf16 v[120:135], v[244:247], v[44:47], v[120:135]
    v_add_f32 v37, v37, v73
    v_add_f32 v36, v36, v74
    ds_read_b128 v[236:239], v21 offset:24576
    s_waitcnt lgkmcnt(3)
    v_mfma_f32_32x32x16_bf16 v[120:135], v[248:251], v[48:51], v[120:135]
    v_add_f32 v37, v37, v75
    v_add_f32 v36, v36, v76
    v_add_f32 v37, v37, v77
    ds_read_b128 v[240:243], v22 offset:24576
    s_waitcnt lgkmcnt(3)
    v_mfma_f32_32x32x16_bf16 v[120:135], v[252:255], v[52:55], v[120:135]
    v_add_f32 v36, v36, v78
    v_add_f32 v37, v37, v79
    ds_read_b128 v[244:247], v23 offset:24576
    s_waitcnt lgkmcnt(3)
    v_mfma_f32_32x32x16_bf16 v[120:135], v[232:235], v[56:59], v[120:135]
    v_add_f32 v36, v36, v80
    v_add_f32 v37, v37, v81
    v_add_f32 v36, v36, v82
    ds_read_b128 v[248:251], v24 offset:32768
    s_waitcnt lgkmcnt(3)
    v_mfma_f32_32x32x16_bf16 v[120:135], v[236:239], v[60:63], v[120:135]
    v_add_f32 v37, v37, v83
    v_add_f32 v36, v36, v84
    ds_read_b128 v[252:255], v24 offset:36864
    s_waitcnt lgkmcnt(3)
    v_mfma_f32_32x32x16_bf16 v[120:135], v[240:243], v[64:67], v[120:135]
    v_add_f32 v37, v37, v85
    v_add_f32 v36, v36, v86
    v_add_f32 v37, v37, v87
    ds_read_b128 v[232:235], v24 offset:40960
    s_waitcnt lgkmcnt(3)
    v_mfma_f32_32x32x16_bf16 v[120:135], v[244:247], v[68:71], v[120:135]
    s_nop 1
    v_exp_f32 v88, v88
    v_exp_f32 v89, v89
    v_exp_f32 v90, v90
    ds_read_b128 v[236:239], v24 offset:45056
    s_waitcnt lgkmcnt(3)
    v_mfma_f32_32x32x16_bf16 v[168:183], v[248:251], v[152:155], v[168:183]
    v_exp_f32 v91, v91
    v_exp_f32 v92, v92
    v_exp_f32 v93, v93
    ds_read_b128 v[240:243], v25 offset:32768
    s_waitcnt lgkmcnt(3)
    v_mfma_f32_32x32x16_bf16 v[184:199], v[252:255], v[152:155], v[184:199]
    v_exp_f32 v94, v94
    v_exp_f32 v95, v95
    v_exp_f32 v96, v96
    ds_read_b128 v[244:247], v25 offset:36864
    s_waitcnt lgkmcnt(3)
    v_mfma_f32_32x32x16_bf16 v[200:215], v[232:235], v[152:155], v[200:215]
    v_exp_f32 v97, v97
    v_exp_f32 v98, v98
    v_exp_f32 v99, v99
    ds_read_b128 v[248:251], v25 offset:40960
    s_waitcnt lgkmcnt(3)
    v_mfma_f32_32x32x16_bf16 v[216:231], v[236:239], v[152:155], v[216:231]
    v_exp_f32 v100, v100
    v_exp_f32 v101, v101
    v_exp_f32 v102, v102
    ds_read_b128 v[252:255], v25 offset:45056
    s_waitcnt lgkmcnt(3)
    v_mfma_f32_32x32x16_bf16 v[168:183], v[240:243], v[156:159], v[168:183]
    v_exp_f32 v103, v103
    v_cvt_pk_bf16_f32 v160, v88, v89
    v_cvt_pk_bf16_f32 v161, v90, v91
    ds_read_b128 v[232:235], v26 offset:32768
    s_waitcnt lgkmcnt(3)
    v_mfma_f32_32x32x16_bf16 v[184:199], v[244:247], v[156:159], v[184:199]
    v_cvt_pk_bf16_f32 v162, v92, v93
    v_cvt_pk_bf16_f32 v163, v94, v95
    v_cvt_pk_bf16_f32 v164, v96, v97
    ds_read_b128 v[236:239], v26 offset:36864
    s_waitcnt lgkmcnt(3)
    v_mfma_f32_32x32x16_bf16 v[200:215], v[248:251], v[156:159], v[200:215]
    v_cvt_pk_bf16_f32 v165, v98, v99
    v_cvt_pk_bf16_f32 v166, v100, v101
    v_cvt_pk_bf16_f32 v167, v102, v103
    ds_read_b128 v[240:243], v26 offset:40960
    s_waitcnt lgkmcnt(3)
    v_mfma_f32_32x32x16_bf16 v[216:231], v[252:255], v[156:159], v[216:231]
    s_nop 1
    v_add_f32 v36, v36, v88
    v_add_f32 v37, v37, v89
    v_add_f32 v36, v36, v90
    v_add_f32 v37, v37, v91
    v_add_f32 v36, v36, v92
    v_add_f32 v37, v37, v93
    v_add_f32 v36, v36, v94
    v_add_f32 v37, v37, v95
    ds_read_b128 v[244:247], v26 offset:45056
    s_waitcnt lgkmcnt(3)
    v_mfma_f32_32x32x16_bf16 v[168:183], v[232:235], v[160:163], v[168:183]
    v_add_f32 v36, v36, v96
    v_add_f32 v37, v37, v97
    v_add_f32 v36, v36, v98
    v_add_f32 v37, v37, v99
    v_add_f32 v36, v36, v100
    v_add_f32 v37, v37, v101
    v_add_f32 v36, v36, v102
    v_add_f32 v37, v37, v103
    ds_read_b128 v[248:251], v27 offset:32768
    s_waitcnt lgkmcnt(3)
    v_mfma_f32_32x32x16_bf16 v[184:199], v[236:239], v[160:163], v[184:199]
    v_cmp_gt_i32 vcc, 0, v3
    s_nop 1
    v_cndmask_b32 v104, v104, v2, vcc
    v_cmp_gt_i32 vcc, 1, v3
    s_nop 1
    v_cndmask_b32 v105, v105, v2, vcc
    v_cmp_gt_i32 vcc, 2, v3
    s_nop 1
    v_cndmask_b32 v106, v106, v2, vcc
    v_cmp_gt_i32 vcc, 3, v3
    s_nop 1
    v_cndmask_b32 v107, v107, v2, vcc
    v_cmp_gt_i32 vcc, 8, v3
    s_nop 1
    v_cndmask_b32 v108, v108, v2, vcc
    v_cmp_gt_i32 vcc, 9, v3
    s_nop 1
    v_cndmask_b32 v109, v109, v2, vcc
    v_cmp_gt_i32 vcc, 10, v3
    s_nop 1
    v_cndmask_b32 v110, v110, v2, vcc
    v_cmp_gt_i32 vcc, 11, v3
    s_nop 1
    v_cndmask_b32 v111, v111, v2, vcc
    ds_read_b128 v[252:255], v27 offset:36864
    s_waitcnt lgkmcnt(3)
    v_mfma_f32_32x32x16_bf16 v[200:215], v[240:243], v[160:163], v[200:215]
    v_cmp_gt_i32 vcc, 16, v3
    s_nop 1
    v_cndmask_b32 v112, v112, v2, vcc
    v_cmp_gt_i32 vcc, 17, v3
    s_nop 1
    v_cndmask_b32 v113, v113, v2, vcc
    v_cmp_gt_i32 vcc, 18, v3
    s_nop 1
    v_cndmask_b32 v114, v114, v2, vcc
    v_cmp_gt_i32 vcc, 19, v3
    s_nop 1
    v_cndmask_b32 v115, v115, v2, vcc
    v_cmp_gt_i32 vcc, 24, v3
    s_nop 1
    v_cndmask_b32 v116, v116, v2, vcc
    v_cmp_gt_i32 vcc, 25, v3
    s_nop 1
    v_cndmask_b32 v117, v117, v2, vcc
    v_cmp_gt_i32 vcc, 26, v3
    s_nop 1
    v_cndmask_b32 v118, v118, v2, vcc
    v_cmp_gt_i32 vcc, 27, v3
    s_nop 1
    v_cndmask_b32 v119, v119, v2, vcc
    ds_read_b128 v[232:235], v27 offset:40960
    s_waitcnt lgkmcnt(3)
    v_mfma_f32_32x32x16_bf16 v[216:231], v[244:247], v[160:163], v[216:231]
    v_cmp_gt_i32 vcc, 32, v3
    s_nop 1
    v_cndmask_b32 v120, v120, v2, vcc
    v_cmp_gt_i32 vcc, 33, v3
    s_nop 1
    v_cndmask_b32 v121, v121, v2, vcc
    v_cmp_gt_i32 vcc, 34, v3
    s_nop 1
    v_cndmask_b32 v122, v122, v2, vcc
    v_cmp_gt_i32 vcc, 35, v3
    s_nop 1
    v_cndmask_b32 v123, v123, v2, vcc
    v_cmp_gt_i32 vcc, 40, v3
    s_nop 1
    v_cndmask_b32 v124, v124, v2, vcc
    v_cmp_gt_i32 vcc, 41, v3
    s_nop 1
    v_cndmask_b32 v125, v125, v2, vcc
    v_cmp_gt_i32 vcc, 42, v3
    s_nop 1
    v_cndmask_b32 v126, v126, v2, vcc
    v_cmp_gt_i32 vcc, 43, v3
    s_nop 1
    v_cndmask_b32 v127, v127, v2, vcc
    ds_read_b128 v[236:239], v27 offset:45056
    s_waitcnt lgkmcnt(3)
    v_mfma_f32_32x32x16_bf16 v[168:183], v[248:251], v[164:167], v[168:183]
    v_cmp_gt_i32 vcc, 48, v3
    s_nop 1
    v_cndmask_b32 v128, v128, v2, vcc
    v_cmp_gt_i32 vcc, 49, v3
    s_nop 1
    v_cndmask_b32 v129, v129, v2, vcc
    v_cmp_gt_i32 vcc, 50, v3
    s_nop 1
    v_cndmask_b32 v130, v130, v2, vcc
    v_cmp_gt_i32 vcc, 51, v3
    s_nop 1
    v_cndmask_b32 v131, v131, v2, vcc
    v_cmp_gt_i32 vcc, 56, v3
    s_nop 1
    v_cndmask_b32 v132, v132, v2, vcc
    v_cmp_gt_i32 vcc, 57, v3
    s_nop 1
    v_cndmask_b32 v133, v133, v2, vcc
    v_cmp_gt_i32 vcc, 58, v3
    s_nop 1
    v_cndmask_b32 v134, v134, v2, vcc
    v_cmp_gt_i32 vcc, 59, v3
    s_nop 1
    v_cndmask_b32 v135, v135, v2, vcc
    s_waitcnt lgkmcnt(2)
    v_mfma_f32_32x32x16_bf16 v[184:199], v[252:255], v[164:167], v[184:199]
    v_max3_f32 v38, v104, v105, v106
    v_max3_f32 v4, v107, v108, v109
    v_max3_f32 v38, v38, v110, v111
    v_max3_f32 v4, v4, v112, v113
    v_max3_f32 v38, v38, v114, v115
    v_max3_f32 v4, v4, v116, v117
    v_max3_f32 v38, v38, v118, v119
    v_max3_f32 v4, v4, v120, v121
    s_waitcnt lgkmcnt(1)
    v_mfma_f32_32x32x16_bf16 v[200:215], v[232:235], v[164:167], v[200:215]
    v_max3_f32 v38, v38, v122, v123
    v_max3_f32 v4, v4, v124, v125
    v_max3_f32 v38, v38, v126, v127
    v_max3_f32 v4, v4, v128, v129
    v_max3_f32 v38, v38, v130, v131
    v_max3_f32 v4, v4, v132, v133
    v_max3_f32 v38, v38, v134, v135
    v_max_f32 v38, v38, v4
    v_cmp_lt_f32 vcc, s30, v38
    s_waitcnt lgkmcnt(0)
    v_mfma_f32_32x32x16_bf16 v[216:231], v[236:239], v[164:167], v[216:231]
    s_nop 1
    s_cbranch_vccnz slow_47
ret_48:
atB_final:
    s_cmp_lg_u32 s21, 0
    s_cbranch_scc1 atB_f2
    s_add_u32 m0, s26, 49152
    s_nop 0
    buffer_load_dwordx4 v32, s[8:11], s24 offen lds
    s_add_u32 m0, s26, 50176
    s_nop 0
    buffer_load_dwordx4 v33, s[8:11], s24 offen lds
    s_add_u32 m0, s26, 51200
    s_nop 0
    buffer_load_dwordx4 v34, s[8:11], s24 offen lds
    s_add_u32 m0, s26, 52224
    s_nop 0
    buffer_load_dwordx4 v35, s[8:11], s24 offen lds
    s_add_u32 s24, s24, 4096
atB_f2:
    s_waitcnt vmcnt(0)
    s_barrier
    ds_read_b128 v[240:243], v24 offset:49152
    ds_read_b128 v[244:247], v24 offset:53248
    ds_read_b128 v[248:251], v24 offset:57344
    ds_read_b128 v[252:255], v24 offset:61440
    v_exp_f32 v104, v104
    v_exp_f32 v105, v105
    v_exp_f32 v106, v106
    v_exp_f32 v107, v107
    v_exp_f32 v108, v108
    v_exp_f32 v109, v109
    v_exp_f32 v110, v110
    v_exp_f32 v111, v111
    v_exp_f32 v112, v112
    v_exp_f32 v113, v113
    v_exp_f32 v114, v114
    v_exp_f32 v115, v115
    v_exp_f32 v116, v116
    v_exp_f32 v117, v117
    v_exp_f32 v118, v118
    v_exp_f32 v119, v119
    v_cvt_pk_bf16_f32 v152, v104, v105
    v_cvt_pk_bf16_f32 v153, v106, v107
    v_cvt_pk_bf16_f32 v154, v108, v109
    v_cvt_pk_bf16_f32 v155, v110, v111
    v_cvt_pk_bf16_f32 v156, v112, v113
    v_cvt_pk_bf16_f32 v157, v114, v115
    v_cvt_pk_bf16_f32 v158, v116, v117
    v_cvt_pk_bf16_f32 v159, v118, v119
    v_add_f32 v36, v36, v104
    v_add_f32 v37, v37, v105
    v_add_f32 v36, v36, v106
    v_add_f32 v37, v37, v107
    v_add_f32 v36, v36, v108
    v_add_f32 v37, v37, v109
    v_add_f32 v36, v36, v110
    v_add_f32 v37, v37, v111
    v_add_f32 v36, v36, v112
    v_add_f32 v37, v37, v113
    v_add_f32 v36, v36, v114
    v_add_f32 v37, v37, v115
    v_add_f32 v36, v36, v116
    v_add_f32 v37, v37, v117
    v_add_f32 v36, v36, v118
    v_add_f32 v37, v37, v119
    s_nop 1
    v_exp_f32 v120, v120
    v_exp_f32 v121, v121
    v_exp_f32 v122, v122
    s_waitcnt lgkmcnt(3)
    v_mfma_f32_32x32x16_bf16 v[168:183], v[240:243], v[152:155], v[168:183]
    v_exp_f32 v123, v123
    v_exp_f32 v124, v124
    v_exp_f32 v125, v125
    ds_read_b128 v[232:235], v25 offset:49152
    s_waitcnt lgkmcnt(3)
    v_mfma_f32_32x32x16_bf16 v[184:199], v[244:247], v[152:155], v[184:199]
    v_exp_f32 v126, v126
    v_exp_f32 v127, v127
    v_exp_f32 v128, v128
    ds_read_b128 v[236:239], v25 offset:53248
    s_waitcnt lgkmcnt(3)
    v_mfma_f32_32x32x16_bf16 v[200:215], v[248:251], v[152:155], v[200:215]
    v_exp_f32 v129, v129
    v_exp_f32 v130, v130
    v_exp_f32 v131, v131
    ds_read_b128 v[240:243], v25 offset:57344
    s_waitcnt lgkmcnt(3)
    v_mfma_f32_32x32x16_bf16 v[216:231], v[252:255], v[152:155], v[216:231]
    v_exp_f32 v132, v132
    v_exp_f32 v133, v133
    v_exp_f32 v134, v134
    ds_read_b128 v[244:247], v25 offset:61440
    s_waitcnt lgkmcnt(3)
    v_mfma_f32_32x32x16_bf16 v[168:183], v[232:235], v[156:159], v[168:183]
    v_exp_f32 v135, v135
    v_cvt_pk_bf16_f32 v160, v120, v121
    v_cvt_pk_bf16_f32 v161, v122, v123
    ds_read_b128 v[248:251], v26 offset:49152
    s_waitcnt lgkmcnt(3)
    v_mfma_f32_32x32x16_bf16 v[184:199], v[236:239], v[156:159], v[184:199]
    v_cvt_pk_bf16_f32 v162, v124, v125
    v_cvt_pk_bf16_f32 v163, v126, v127
    v_cvt_pk_bf16_f32 v164, v128, v129
    ds_read_b128 v[252:255], v26 offset:53248
    s_waitcnt lgkmcnt(3)
    v_mfma_f32_32x32x16_bf16 v[200:215], v[240:243], v[156:159], v[200:215]
    v_cvt_pk_bf16_f32 v165, v130, v131
    v_cvt_pk_bf16_f32 v166, v132, v133
    v_cvt_pk_bf16_f32 v167, v134, v135
    ds_read_b128 v[232:235], v26 offset:57344
    s_waitcnt lgkmcnt(3)
    v_mfma_f32_32x32x16_bf16 v[216:231], v[244:247], v[156:159], v[216:231]
    s_nop 1
    v_add_f32 v36, v36, v120
    v_add_f32 v37, v37, v121
    ds_read_b128 v[236:239], v26 offset:61440
    s_waitcnt lgkmcnt(3)
    v_mfma_f32_32x32x16_bf16 v[168:183], v[248:251], v[160:163], v[168:183]
    v_add_f32 v36, v36, v122
    v_add_f32 v37, v37, v123
    ds_read_b128 v[240:243], v27 offset:49152
    s_waitcnt lgkmcnt(3)
    v_mfma_f32_32x32x16_bf16 v[184:199], v[252:255], v[160:163], v[184:199]
    v_add_f32 v36, v36, v124
    v_add_f32 v37, v37, v125
    ds_read_b128 v[244:247], v27 offset:53248
    s_waitcnt lgkmcnt(3)
    v_mfma_f32_32x32x16_bf16 v[200:215], v[232:235], v[160:163], v[200:215]
    v_add_f32 v36, v36, v126
    v_add_f32 v37, v37, v127
    ds_read_b128 v[248:251], v27 offset:57344
    s_waitcnt lgkmcnt(3)
    v_mfma_f32_32x32x16_bf16 v[216:231], v[236:239], v[160:163], v[216:231]
    v_add_f32 v36, v36, v128
    v_add_f32 v37, v37, v129
    ds_read_b128 v[252:255], v27 offset:61440
    s_waitcnt lgkmcnt(3)
    v_mfma_f32_32x32x16_bf16 v[168:183], v[240:243], v[164:167], v[168:183]
    v_add_f32 v36, v36, v130
    v_add_f32 v37, v37, v131
    s_waitcnt lgkmcnt(2)
    v_mfma_f32_32x32x16_bf16 v[184:199], v[244:247], v[164:167], v[184:199]
    v_add_f32 v36, v36, v132
    v_add_f32 v37, v37, v133
    s_waitcnt lgkmcnt(1)
    v_mfma_f32_32x32x16_bf16 v[200:215], v[248:251], v[164:167], v[200:215]
    v_add_f32 v36, v36, v134
    v_add_f32 v37, v37, v135
    s_waitcnt lgkmcnt(0)
    v_mfma_f32_32x32x16_bf16 v[216:231], v[252:255], v[164:167], v[216:231]
    v_add_f32 v36, v36, v37
    v_mov_b32 v37, v36
    s_nop 1
    v_permlane32_swap_b32 v36, v37
    v_add_f32 v36, v36, v37
    v_rcp_f32 v36, v36
    v_add_u32 v15, 50331648, v15
    s_movk_i32 s37, 0x1000
    s_nop 7
    v_mul_f32 v168, v168, v36
    v_mul_f32 v169, v169, v36
    v_mul_f32 v170, v170, v36
    v_mul_f32 v171, v171, v36
    v_mul_f32 v172, v172, v36
    v_mul_f32 v173, v173, v36
    v_mul_f32 v174, v174, v36
    v_mul_f32 v175, v175, v36
    v_cvt_pk_bf16_f32 v72, v168, v169
    v_cvt_pk_bf16_f32 v73, v170, v171
    v_cvt_pk_bf16_f32 v74, v172, v173
    v_cvt_pk_bf16_f32 v75, v174, v175
    buffer_store_dwordx4 v[72:75], v15, s[8:11], 0 offen offset:0
    v_mul_f32 v176, v176, v36
    v_mul_f32 v177, v177, v36
    v_mul_f32 v178, v178, v36
    v_mul_f32 v179, v179, v36
    v_mul_f32 v180, v180, v36
    v_mul_f32 v181, v181, v36
    v_mul_f32 v182, v182, v36
    v_mul_f32 v183, v183, v36
    v_cvt_pk_bf16_f32 v76, v176, v177
    v_cvt_pk_bf16_f32 v77, v178, v179
    v_cvt_pk_bf16_f32 v78, v180, v181
    v_cvt_pk_bf16_f32 v79, v182, v183
    buffer_store_dwordx4 v[76:79], v15, s[8:11], 0 offen offset:1024
    v_mul_f32 v184, v184, v36
    v_mul_f32 v185, v185, v36
    v_mul_f32 v186, v186, v36
    v_mul_f32 v187, v187, v36
    v_mul_f32 v188, v188, v36
    v_mul_f32 v189, v189, v36
    v_mul_f32 v190, v190, v36
    v_mul_f32 v191, v191, v36
    v_cvt_pk_bf16_f32 v80, v184, v185
    v_cvt_pk_bf16_f32 v81, v186, v187
    v_cvt_pk_bf16_f32 v82, v188, v189
    v_cvt_pk_bf16_f32 v83, v190, v191
    buffer_store_dwordx4 v[80:83], v15, s[8:11], 0 offen offset:2048
    v_mul_f32 v192, v192, v36
    v_mul_f32 v193, v193, v36
    v_mul_f32 v194, v194, v36
    v_mul_f32 v195, v195, v36
    v_mul_f32 v196, v196, v36
    v_mul_f32 v197, v197, v36
    v_mul_f32 v198, v198, v36
    v_mul_f32 v199, v199, v36
    v_cvt_pk_bf16_f32 v84, v192, v193
    v_cvt_pk_bf16_f32 v85, v194, v195
    v_cvt_pk_bf16_f32 v86, v196, v197
    v_cvt_pk_bf16_f32 v87, v198, v199
    buffer_store_dwordx4 v[84:87], v15, s[8:11], 0 offen offset:3072
    v_mul_f32 v200, v200, v36
    v_mul_f32 v201, v201, v36
    v_mul_f32 v202, v202, v36
    v_mul_f32 v203, v203, v36
    v_mul_f32 v204, v204, v36
    v_mul_f32 v205, v205, v36
    v_mul_f32 v206, v206, v36
    v_mul_f32 v207, v207, v36
    v_cvt_pk_bf16_f32 v72, v200, v201
    v_cvt_pk_bf16_f32 v73, v202, v203
    v_cvt_pk_bf16_f32 v74, v204, v205
    v_cvt_pk_bf16_f32 v75, v206, v207
    buffer_store_dwordx4 v[72:75], v15, s[8:11], s37 offen offset:0
    v_mul_f32 v208, v208, v36
    v_mul_f32 v209, v209, v36
    v_mul_f32 v210, v210, v36
    v_mul_f32 v211, v211, v36
    v_mul_f32 v212, v212, v36
    v_mul_f32 v213, v213, v36
    v_mul_f32 v214, v214, v36
    v_mul_f32 v215, v215, v36
    v_cvt_pk_bf16_f32 v76, v208, v209
    v_cvt_pk_bf16_f32 v77, v210, v211
    v_cvt_pk_bf16_f32 v78, v212, v213
    v_cvt_pk_bf16_f32 v79, v214, v215
    buffer_store_dwordx4 v[76:79], v15, s[8:11], s37 offen offset:1024
    v_mul_f32 v216, v216, v36
    v_mul_f32 v217, v217, v36
    v_mul_f32 v218, v218, v36
    v_mul_f32 v219, v219, v36
    v_mul_f32 v220, v220, v36
    v_mul_f32 v221, v221, v36
    v_mul_f32 v222, v222, v36
    v_mul_f32 v223, v223, v36
    v_cvt_pk_bf16_f32 v80, v216, v217
    v_cvt_pk_bf16_f32 v81, v218, v219
    v_cvt_pk_bf16_f32 v82, v220, v221
    v_cvt_pk_bf16_f32 v83, v222, v223
    buffer_store_dwordx4 v[80:83], v15, s[8:11], s37 offen offset:2048
    v_mul_f32 v224, v224, v36
    v_mul_f32 v225, v225, v36
    v_mul_f32 v226, v226, v36
    v_mul_f32 v227, v227, v36
    v_mul_f32 v228, v228, v36
    v_mul_f32 v229, v229, v36
    v_mul_f32 v230, v230, v36
    v_mul_f32 v231, v231, v36
    v_cvt_pk_bf16_f32 v84, v224, v225
    v_cvt_pk_bf16_f32 v85, v226, v227
    v_cvt_pk_bf16_f32 v86, v228, v229
    v_cvt_pk_bf16_f32 v87, v230, v231
    buffer_store_dwordx4 v[84:87], v15, s[8:11], s37 offen offset:3072
    s_sub_u32 s21, 15, s21
    s_sub_u32 s50, s50, 1
    s_cmp_lg_u32 s50, 0
    s_cbranch_scc1 atB_outer
    s_endpgm
slow_37:
    s_nop 7
    s_nop 7
    v_mov_b32 v4, v38
    v_mov_b32 v5, v38
    s_nop 1
    v_permlane32_swap_b32 v4, v5
    v_max_f32 v4, v4, v5
    v_max_f32 v4, s31, v4
    v_max_f32 v5, 0, v4
    v_sub_f32 v5, 0, v5
    v_exp_f32 v5, v5
    v_sub_f32 v136, v136, v4
    v_sub_f32 v137, v137, v4
    v_sub_f32 v138, v138, v4
    v_sub_f32 v139, v139, v4
    v_sub_f32 v140, v140, v4
    v_sub_f32 v141, v141, v4
    v_sub_f32 v142, v142, v4
    v_sub_f32 v143, v143, v4
    v_sub_f32 v144, v144, v4
    v_sub_f32 v145, v145, v4
    v_sub_f32 v146, v146, v4
    v_sub_f32 v147, v147, v4
    v_sub_f32 v148, v148, v4
    v_sub_f32 v149, v149, v4
    v_sub_f32 v150, v150, v4
    v_sub_f32 v151, v151, v4
    v_sub_f32 v72, v72, v4
    v_sub_f32 v73, v73, v4
    v_sub_f32 v74, v74, v4
    v_sub_f32 v75, v75, v4
    v_sub_f32 v76, v76, v4
    v_sub_f32 v77, v77, v4
    v_sub_f32 v78, v78, v4
    v_sub_f32 v79, v79, v4
    v_sub_f32 v80, v80, v4
    v_sub_f32 v81, v81, v4
    v_sub_f32 v82, v82, v4
    v_sub_f32 v83, v83, v4
    v_sub_f32 v84, v84, v4
    v_sub_f32 v85, v85, v4
    v_sub_f32 v86, v86, v4
    v_sub_f32 v87, v87, v4
    v_sub_f32 v88, v88, v4
    v_sub_f32 v89, v89, v4
    v_sub_f32 v90, v90, v4
    v_sub_f32 v91, v91, v4
    v_sub_f32 v92, v92, v4
    v_sub_f32 v93, v93, v4
    v_sub_f32 v94, v94, v4
    v_sub_f32 v95, v95, v4
    v_sub_f32 v96, v96, v4
    v_sub_f32 v97, v97, v4
    v_sub_f32 v98, v98, v4
    v_sub_f32 v99, v99, v4
    v_sub_f32 v100, v100, v4
    v_sub_f32 v101, v101, v4
    v_sub_f32 v102, v102, v4
    v_sub_f32 v103, v103, v4
    v_mul_f32 v168, v168, v5
    v_mul_f32 v169, v169, v5
    v_mul_f32 v170, v170, v5
    v_mul_f32 v171, v171, v5
    v_mul_f32 v172, v172, v5
    v_mul_f32 v173, v173, v5
    v_mul_f32 v174, v174, v5
    v_mul_f32 v175, v175, v5
    v_mul_f32 v176, v176, v5
    v_mul_f32 v177, v177, v5
    v_mul_f32 v178, v178, v5
    v_mul_f32 v179, v179, v5
    v_mul_f32 v180, v180, v5
    v_mul_f32 v181, v181, v5
    v_mul_f32 v182, v182, v5
    v_mul_f32 v183, v183, v5
    v_mul_f32 v184, v184, v5
    v_mul_f32 v185, v185, v5
    v_mul_f32 v186, v186, v5
    v_mul_f32 v187, v187, v5
    v_mul_f32 v188, v188, v5
    v_mul_f32 v189, v189, v5
    v_mul_f32 v190, v190, v5
    v_mul_f32 v191, v191, v5
    v_mul_f32 v192, v192, v5
    v_mul_f32 v193, v193, v5
    v_mul_f32 v194, v194, v5
    v_mul_f32 v195, v195, v5
    v_mul_f32 v196, v196, v5
    v_mul_f32 v197, v197, v5
    v_mul_f32 v198, v198, v5
    v_mul_f32 v199, v199, v5
    v_mul_f32 v200, v200, v5
    v_mul_f32 v201, v201, v5
    v_mul_f32 v202, v202, v5
    v_mul_f32 v203, v203, v5
    v_mul_f32 v204, v204, v5
    v_mul_f32 v205, v205, v5
    v_mul_f32 v206, v206, v5
    v_mul_f32 v207, v207, v5
    v_mul_f32 v208, v208, v5
    v_mul_f32 v209, v209, v5
    v_mul_f32 v210, v210, v5
    v_mul_f32 v211, v211, v5
    v_mul_f32 v212, v212, v5
    v_mul_f32 v213, v213, v5
    v_mul_f32 v214, v214, v5
    v_mul_f32 v215, v215, v5
    v_mul_f32 v216, v216, v5
    v_mul_f32 v217, v217, v5
    v_mul_f32 v218, v218, v5
    v_mul_f32 v219, v219, v5
    v_mul_f32 v220, v220, v5
    v_mul_f32 v221, v221, v5
    v_mul_f32 v222, v222, v5
    v_mul_f32 v223, v223, v5
    v_mul_f32 v224, v224, v5
    v_mul_f32 v225, v225, v5
    v_mul_f32 v226, v226, v5
    v_mul_f32 v227, v227, v5
    v_mul_f32 v228, v228, v5
    v_mul_f32 v229, v229, v5
    v_mul_f32 v230, v230, v5
    v_mul_f32 v231, v231, v5
    v_mul_f32 v36, v36, v5
    v_mul_f32 v37, v37, v5
    s_mov_b32 s30, 8.0
    s_mov_b32 s31, 0
    s_branch ret_38
slow_39:
    s_nop 7
    s_nop 7
    v_mov_b32 v4, v38
    v_mov_b32 v5, v38
    s_nop 1
    v_permlane32_swap_b32 v4, v5
    v_max_f32 v4, v4, v5
    v_max_f32 v4, s31, v4
    v_max_f32 v5, 0, v4
    v_sub_f32 v5, 0, v5
    v_exp_f32 v5, v5
    v_sub_f32 v136, v136, v4
    v_sub_f32 v137, v137, v4
    v_sub_f32 v138, v138, v4
    v_sub_f32 v139, v139, v4
    v_sub_f32 v140, v140, v4
    v_sub_f32 v141, v141, v4
    v_sub_f32 v142, v142, v4
    v_sub_f32 v143, v143, v4
    v_sub_f32 v144, v144, v4
    v_sub_f32 v145, v145, v4
    v_sub_f32 v146, v146, v4
    v_sub_f32 v147, v147, v4
    v_sub_f32 v148, v148, v4
    v_sub_f32 v149, v149, v4
    v_sub_f32 v150, v150, v4
    v_sub_f32 v151, v151, v4
    v_sub_f32 v104, v104, v4
    v_sub_f32 v105, v105, v4
    v_sub_f32 v106, v106, v4
    v_sub_f32 v107, v107, v4
    v_sub_f32 v108, v108, v4
    v_sub_f32 v109, v109, v4
    v_sub_f32 v110, v110, v4
    v_sub_f32 v111, v111, v4
    v_sub_f32 v112, v112, v4
    v_sub_f32 v113, v113, v4
    v_sub_f32 v114, v114, v4
    v_sub_f32 v115, v115, v4
    v_sub_f32 v116, v116, v4
    v_sub_f32 v117, v117, v4
    v_sub_f32 v118, v118, v4
    v_sub_f32 v119, v119, v4
    v_sub_f32 v120, v120, v4
    v_sub_f32 v121, v121, v4
    v_sub_f32 v122, v122, v4
    v_sub_f32 v123, v123, v4
    v_sub_f32 v124, v124, v4
    v_sub_f32 v125, v125, v4
    v_sub_f32 v126, v126, v4
    v_sub_f32 v127, v127, v4
    v_sub_f32 v128, v128, v4
    v_sub_f32 v129, v129, v4
    v_sub_f32 v130, v130, v4
    v_sub_f32 v131, v131, v4
    v_sub_f32 v132, v132, v4
    v_sub_f32 v133, v133, v4
    v_sub_f32 v134, v134, v4
    v_sub_f32 v135, v135, v4
    v_mul_f32 v168, v168, v5
    v_mul_f32 v169, v169, v5
    v_mul_f32 v170, v170, v5
    v_mul_f32 v171, v171, v5
    v_mul_f32 v172, v172, v5
    v_mul_f32 v173, v173, v5
    v_mul_f32 v174, v174, v5
    v_mul_f32 v175, v175, v5
    v_mul_f32 v176, v176, v5
    v_mul_f32 v177, v177, v5
    v_mul_f32 v178, v178, v5
    v_mul_f32 v179, v179, v5
    v_mul_f32 v180, v180, v5
    v_mul_f32 v181, v181, v5
    v_mul_f32 v182, v182, v5
    v_mul_f32 v183, v183, v5
    v_mul_f32 v184, v184, v5
    v_mul_f32 v185, v185, v5
    v_mul_f32 v186, v186, v5
    v_mul_f32 v187, v187, v5
    v_mul_f32 v188, v188, v5
    v_mul_f32 v189, v189, v5
    v_mul_f32 v190, v190, v5
    v_mul_f32 v191, v191, v5
    v_mul_f32 v192, v192, v5
    v_mul_f32 v193, v193, v5
    v_mul_f32 v194, v194, v5
    v_mul_f32 v195, v195, v5
    v_mul_f32 v196, v196, v5
    v_mul_f32 v197, v197, v5
    v_mul_f32 v198, v198, v5
    v_mul_f32 v199, v199, v5
    v_mul_f32 v200, v200, v5
    v_mul_f32 v201, v201, v5
    v_mul_f32 v202, v202, v5
    v_mul_f32 v203, v203, v5
    v_mul_f32 v204, v204, v5
    v_mul_f32 v205, v205, v5
    v_mul_f32 v206, v206, v5
    v_mul_f32 v207, v207, v5
    v_mul_f32 v208, v208, v5
    v_mul_f32 v209, v209, v5
    v_mul_f32 v210, v210, v5
    v_mul_f32 v211, v211, v5
    v_mul_f32 v212, v212, v5
    v_mul_f32 v213, v213, v5
    v_mul_f32 v214, v214, v5
    v_mul_f32 v215, v215, v5
    v_mul_f32 v216, v216, v5
    v_mul_f32 v217, v217, v5
    v_mul_f32 v218, v218, v5
    v_mul_f32 v219, v219, v5
    v_mul_f32 v220, v220, v5
    v_mul_f32 v221, v221, v5
    v_mul_f32 v222, v222, v5
    v_mul_f32 v223, v223, v5
    v_mul_f32 v224, v224, v5
    v_mul_f32 v225, v225, v5
    v_mul_f32 v226, v226, v5
    v_mul_f32 v227, v227, v5
    v_mul_f32 v228, v228, v5
    v_mul_f32 v229, v229, v5
    v_mul_f32 v230, v230, v5
    v_mul_f32 v231, v231, v5
    v_mul_f32 v36, v36, v5
    v_mul_f32 v37, v37, v5
    s_mov_b32 s30, 8.0
    s_mov_b32 s31, 0
    s_branch ret_40
slow_41:
    s_nop 7
    s_nop 7
    v_mov_b32 v4, v38
    v_mov_b32 v5, v38
    s_nop 1
    v_permlane32_swap_b32 v4, v5
    v_max_f32 v4, v4, v5
    v_max_f32 v4, s31, v4
    v_max_f32 v5, 0, v4
    v_sub_f32 v5, 0, v5
    v_exp_f32 v5, v5
    v_sub_f32 v136, v136, v4
    v_sub_f32 v137, v137, v4
    v_sub_f32 v138, v138, v4
    v_sub_f32 v139, v139, v4
    v_sub_f32 v140, v140, v4
    v_sub_f32 v141, v141, v4
    v_sub_f32 v142, v142, v4
    v_sub_f32 v143, v143, v4
    v_sub_f32 v144, v144, v4
    v_sub_f32 v145, v145, v4
    v_sub_f32 v146, v146, v4
    v_sub_f32 v147, v147, v4
    v_sub_f32 v148, v148, v4
    v_sub_f32 v149, v149, v4
    v_sub_f32 v150, v150, v4
    v_sub_f32 v151, v151, v4
    v_sub_f32 v72, v72, v4
    v_sub_f32 v73, v73, v4
    v_sub_f32 v74, v74, v4
    v_sub_f32 v75, v75, v4
    v_sub_f32 v76, v76, v4
    v_sub_f32 v77, v77, v4
    v_sub_f32 v78, v78, v4
    v_sub_f32 v79, v79, v4
    v_sub_f32 v80, v80, v4
    v_sub_f32 v81, v81, v4
    v_sub_f32 v82, v82, v4
    v_sub_f32 v83, v83, v4
    v_sub_f32 v84, v84, v4
    v_sub_f32 v85, v85, v4
    v_sub_f32 v86, v86, v4
    v_sub_f32 v87, v87, v4
    v_sub_f32 v88, v88, v4
    v_sub_f32 v89, v89, v4
    v_sub_f32 v90, v90, v4
    v_sub_f32 v91, v91, v4
    v_sub_f32 v92, v92, v4
    v_sub_f32 v93, v93, v4
    v_sub_f32 v94, v94, v4
    v_sub_f32 v95, v95, v4
    v_sub_f32 v96, v96, v4
    v_sub_f32 v97, v97, v4
    v_sub_f32 v98, v98, v4
    v_sub_f32 v99, v99, v4
    v_sub_f32 v100, v100, v4
    v_sub_f32 v101, v101, v4
    v_sub_f32 v102, v102, v4
    v_sub_f32 v103, v103, v4
    v_mul_f32 v168, v168, v5
    v_mul_f32 v169, v169, v5
    v_mul_f32 v170, v170, v5
    v_mul_f32 v171, v171, v5
    v_mul_f32 v172, v172, v5
    v_mul_f32 v173, v173, v5
    v_mul_f32 v174, v174, v5
    v_mul_f32 v175, v175, v5
    v_mul_f32 v176, v176, v5
    v_mul_f32 v177, v177, v5
    v_mul_f32 v178, v178, v5
    v_mul_f32 v179, v179, v5
    v_mul_f32 v180, v180, v5
    v_mul_f32 v181, v181, v5
    v_mul_f32 v182, v182, v5
    v_mul_f32 v183, v183, v5
    v_mul_f32 v184, v184, v5
    v_mul_f32 v185, v185, v5
    v_mul_f32 v186, v186, v5
    v_mul_f32 v187, v187, v5
    v_mul_f32 v188, v188, v5
    v_mul_f32 v189, v189, v5
    v_mul_f32 v190, v190, v5
    v_mul_f32 v191, v191, v5
    v_mul_f32 v192, v192, v5
    v_mul_f32 v193, v193, v5
    v_mul_f32 v194, v194, v5
    v_mul_f32 v195, v195, v5
    v_mul_f32 v196, v196, v5
    v_mul_f32 v197, v197, v5
    v_mul_f32 v198, v198, v5
    v_mul_f32 v199, v199, v5
    v_mul_f32 v200, v200, v5
    v_mul_f32 v201, v201, v5
    v_mul_f32 v202, v202, v5
    v_mul_f32 v203, v203, v5
    v_mul_f32 v204, v204, v5
    v_mul_f32 v205, v205, v5
    v_mul_f32 v206, v206, v5
    v_mul_f32 v207, v207, v5
    v_mul_f32 v208, v208, v5
    v_mul_f32 v209, v209, v5
    v_mul_f32 v210, v210, v5
    v_mul_f32 v211, v211, v5
    v_mul_f32 v212, v212, v5
    v_mul_f32 v213, v213, v5
    v_mul_f32 v214, v214, v5
    v_mul_f32 v215, v215, v5
    v_mul_f32 v216, v216, v5
    v_mul_f32 v217, v217, v5
    v_mul_f32 v218, v218, v5
    v_mul_f32 v219, v219, v5
    v_mul_f32 v220, v220, v5
    v_mul_f32 v221, v221, v5
    v_mul_f32 v222, v222, v5
    v_mul_f32 v223, v223, v5
    v_mul_f32 v224, v224, v5
    v_mul_f32 v225, v225, v5
    v_mul_f32 v226, v226, v5
    v_mul_f32 v227, v227, v5
    v_mul_f32 v228, v228, v5
    v_mul_f32 v229, v229, v5
    v_mul_f32 v230, v230, v5
    v_mul_f32 v231, v231, v5
    v_mul_f32 v36, v36, v5
    v_mul_f32 v37, v37, v5
    s_mov_b32 s30, 8.0
    s_mov_b32 s31, 0
    s_branch ret_42
slow_43:
    s_nop 7
    s_nop 7
    v_mov_b32 v4, v38
    v_mov_b32 v5, v38
    s_nop 1
    v_permlane32_swap_b32 v4, v5
    v_max_f32 v4, v4, v5
    v_max_f32 v4, s31, v4
    v_max_f32 v5, 0, v4
    v_sub_f32 v5, 0, v5
    v_exp_f32 v5, v5
    v_sub_f32 v136, v136, v4
    v_sub_f32 v137, v137, v4
    v_sub_f32 v138, v138, v4
    v_sub_f32 v139, v139, v4
    v_sub_f32 v140, v140, v4
    v_sub_f32 v141, v141, v4
    v_sub_f32 v142, v142, v4
    v_sub_f32 v143, v143, v4
    v_sub_f32 v144, v144, v4
    v_sub_f32 v145, v145, v4
    v_sub_f32 v146, v146, v4
    v_sub_f32 v147, v147, v4
    v_sub_f32 v148, v148, v4
    v_sub_f32 v149, v149, v4
    v_sub_f32 v150, v150, v4
    v_sub_f32 v151, v151, v4
    v_sub_f32 v104, v104, v4
    v_sub_f32 v105, v105, v4
    v_sub_f32 v106, v106, v4
    v_sub_f32 v107, v107, v4
    v_sub_f32 v108, v108, v4
    v_sub_f32 v109, v109, v4
    v_sub_f32 v110, v110, v4
    v_sub_f32 v111, v111, v4
    v_sub_f32 v112, v112, v4
    v_sub_f32 v113, v113, v4
    v_sub_f32 v114, v114, v4
    v_sub_f32 v115, v115, v4
    v_sub_f32 v116, v116, v4
    v_sub_f32 v117, v117, v4
    v_sub_f32 v118, v118, v4
    v_sub_f32 v119, v119, v4
    v_sub_f32 v120, v120, v4
    v_sub_f32 v121, v121, v4
    v_sub_f32 v122, v122, v4
    v_sub_f32 v123, v123, v4
    v_sub_f32 v124, v124, v4
    v_sub_f32 v125, v125, v4
    v_sub_f32 v126, v126, v4
    v_sub_f32 v127, v127, v4
    v_sub_f32 v128, v128, v4
    v_sub_f32 v129, v129, v4
    v_sub_f32 v130, v130, v4
    v_sub_f32 v131, v131, v4
    v_sub_f32 v132, v132, v4
    v_sub_f32 v133, v133, v4
    v_sub_f32 v134, v134, v4
    v_sub_f32 v135, v135, v4
    v_mul_f32 v168, v168, v5
    v_mul_f32 v169, v169, v5
    v_mul_f32 v170, v170, v5
    v_mul_f32 v171, v171, v5
    v_mul_f32 v172, v172, v5
    v_mul_f32 v173, v173, v5
    v_mul_f32 v174, v174, v5
    v_mul_f32 v175, v175, v5
    v_mul_f32 v176, v176, v5
    v_mul_f32 v177, v177, v5
    v_mul_f32 v178, v178, v5
    v_mul_f32 v179, v179, v5
    v_mul_f32 v180, v180, v5
    v_mul_f32 v181, v181, v5
    v_mul_f32 v182, v182, v5
    v_mul_f32 v183, v183, v5
    v_mul_f32 v184, v184, v5
    v_mul_f32 v185, v185, v5
    v_mul_f32 v186, v186, v5
    v_mul_f32 v187, v187, v5
    v_mul_f32 v188, v188, v5
    v_mul_f32 v189, v189, v5
    v_mul_f32 v190, v190, v5
    v_mul_f32 v191, v191, v5
    v_mul_f32 v192, v192, v5
    v_mul_f32 v193, v193, v5
    v_mul_f32 v194, v194, v5
    v_mul_f32 v195, v195, v5
    v_mul_f32 v196, v196, v5
    v_mul_f32 v197, v197, v5
    v_mul_f32 v198, v198, v5
    v_mul_f32 v199, v199, v5
    v_mul_f32 v200, v200, v5
    v_mul_f32 v201, v201, v5
    v_mul_f32 v202, v202, v5
    v_mul_f32 v203, v203, v5
    v_mul_f32 v204, v204, v5
    v_mul_f32 v205, v205, v5
    v_mul_f32 v206, v206, v5
    v_mul_f32 v207, v207, v5
    v_mul_f32 v208, v208, v5
    v_mul_f32 v209, v209, v5
    v_mul_f32 v210, v210, v5
    v_mul_f32 v211, v211, v5
    v_mul_f32 v212, v212, v5
    v_mul_f32 v213, v213, v5
    v_mul_f32 v214, v214, v5
    v_mul_f32 v215, v215, v5
    v_mul_f32 v216, v216, v5
    v_mul_f32 v217, v217, v5
    v_mul_f32 v218, v218, v5
    v_mul_f32 v219, v219, v5
    v_mul_f32 v220, v220, v5
    v_mul_f32 v221, v221, v5
    v_mul_f32 v222, v222, v5
    v_mul_f32 v223, v223, v5
    v_mul_f32 v224, v224, v5
    v_mul_f32 v225, v225, v5
    v_mul_f32 v226, v226, v5
    v_mul_f32 v227, v227, v5
    v_mul_f32 v228, v228, v5
    v_mul_f32 v229, v229, v5
    v_mul_f32 v230, v230, v5
    v_mul_f32 v231, v231, v5
    v_mul_f32 v36, v36, v5
    v_mul_f32 v37, v37, v5
    s_mov_b32 s30, 8.0
    s_mov_b32 s31, 0
    s_branch ret_44
slow_45:
    s_nop 7
    s_nop 7
    v_mov_b32 v4, v38
    v_mov_b32 v5, v38
    s_nop 1
    v_permlane32_swap_b32 v4, v5
    v_max_f32 v4, v4, v5
    v_max_f32 v4, s31, v4
    v_max_f32 v5, 0, v4
    v_sub_f32 v5, 0, v5
    v_exp_f32 v5, v5
    v_sub_f32 v136, v136, v4
    v_sub_f32 v137, v137, v4
    v_sub_f32 v138, v138, v4
    v_sub_f32 v139, v139, v4
    v_sub_f32 v140, v140, v4
    v_sub_f32 v141, v141, v4
    v_sub_f32 v142, v142, v4
    v_sub_f32 v143, v143, v4
    v_sub_f32 v144, v144, v4
    v_sub_f32 v145, v145, v4
    v_sub_f32 v146, v146, v4
    v_sub_f32 v147, v147, v4
    v_sub_f32 v148, v148, v4
    v_sub_f32 v149, v149, v4
    v_sub_f32 v150, v150, v4
    v_sub_f32 v151, v151, v4
    v_sub_f32 v72, v72, v4
    v_sub_f32 v73, v73, v4
    v_sub_f32 v74, v74, v4
    v_sub_f32 v75, v75, v4
    v_sub_f32 v76, v76, v4
    v_sub_f32 v77, v77, v4
    v_sub_f32 v78, v78, v4
    v_sub_f32 v79, v79, v4
    v_sub_f32 v80, v80, v4
    v_sub_f32 v81, v81, v4
    v_sub_f32 v82, v82, v4
    v_sub_f32 v83, v83, v4
    v_sub_f32 v84, v84, v4
    v_sub_f32 v85, v85, v4
    v_sub_f32 v86, v86, v4
    v_sub_f32 v87, v87, v4
    v_sub_f32 v88, v88, v4
    v_sub_f32 v89, v89, v4
    v_sub_f32 v90, v90, v4
    v_sub_f32 v91, v91, v4
    v_sub_f32 v92, v92, v4
    v_sub_f32 v93, v93, v4
    v_sub_f32 v94, v94, v4
    v_sub_f32 v95, v95, v4
    v_sub_f32 v96, v96, v4
    v_sub_f32 v97, v97, v4
    v_sub_f32 v98, v98, v4
    v_sub_f32 v99, v99, v4
    v_sub_f32 v100, v100, v4
    v_sub_f32 v101, v101, v4
    v_sub_f32 v102, v102, v4
    v_sub_f32 v103, v103, v4
    v_mul_f32 v168, v168, v5
    v_mul_f32 v169, v169, v5
    v_mul_f32 v170, v170, v5
    v_mul_f32 v171, v171, v5
    v_mul_f32 v172, v172, v5
    v_mul_f32 v173, v173, v5
    v_mul_f32 v174, v174, v5
    v_mul_f32 v175, v175, v5
    v_mul_f32 v176, v176, v5
    v_mul_f32 v177, v177, v5
    v_mul_f32 v178, v178, v5
    v_mul_f32 v179, v179, v5
    v_mul_f32 v180, v180, v5
    v_mul_f32 v181, v181, v5
    v_mul_f32 v182, v182, v5
    v_mul_f32 v183, v183, v5
    v_mul_f32 v184, v184, v5
    v_mul_f32 v185, v185, v5
    v_mul_f32 v186, v186, v5
    v_mul_f32 v187, v187, v5
    v_mul_f32 v188, v188, v5
    v_mul_f32 v189, v189, v5
    v_mul_f32 v190, v190, v5
    v_mul_f32 v191, v191, v5
    v_mul_f32 v192, v192, v5
    v_mul_f32 v193, v193, v5
    v_mul_f32 v194, v194, v5
    v_mul_f32 v195, v195, v5
    v_mul_f32 v196, v196, v5
    v_mul_f32 v197, v197, v5
    v_mul_f32 v198, v198, v5
    v_mul_f32 v199, v199, v5
    v_mul_f32 v200, v200, v5
    v_mul_f32 v201, v201, v5
    v_mul_f32 v202, v202, v5
    v_mul_f32 v203, v203, v5
    v_mul_f32 v204, v204, v5
    v_mul_f32 v205, v205, v5
    v_mul_f32 v206, v206, v5
    v_mul_f32 v207, v207, v5
    v_mul_f32 v208, v208, v5
    v_mul_f32 v209, v209, v5
    v_mul_f32 v210, v210, v5
    v_mul_f32 v211, v211, v5
    v_mul_f32 v212, v212, v5
    v_mul_f32 v213, v213, v5
    v_mul_f32 v214, v214, v5
    v_mul_f32 v215, v215, v5
    v_mul_f32 v216, v216, v5
    v_mul_f32 v217, v217, v5
    v_mul_f32 v218, v218, v5
    v_mul_f32 v219, v219, v5
    v_mul_f32 v220, v220, v5
    v_mul_f32 v221, v221, v5
    v_mul_f32 v222, v222, v5
    v_mul_f32 v223, v223, v5
    v_mul_f32 v224, v224, v5
    v_mul_f32 v225, v225, v5
    v_mul_f32 v226, v226, v5
    v_mul_f32 v227, v227, v5
    v_mul_f32 v228, v228, v5
    v_mul_f32 v229, v229, v5
    v_mul_f32 v230, v230, v5
    v_mul_f32 v231, v231, v5
    v_mul_f32 v36, v36, v5
    v_mul_f32 v37, v37, v5
    s_mov_b32 s30, 8.0
    s_mov_b32 s31, 0
    s_branch ret_46
slow_47:
    s_nop 7
    s_nop 7
    v_mov_b32 v4, v38
    v_mov_b32 v5, v38
    s_nop 1
    v_permlane32_swap_b32 v4, v5
    v_max_f32 v4, v4, v5
    v_max_f32 v4, s31, v4
    v_max_f32 v5, 0, v4
    v_sub_f32 v5, 0, v5
    v_exp_f32 v5, v5
    v_sub_f32 v136, v136, v4
    v_sub_f32 v137, v137, v4
    v_sub_f32 v138, v138, v4
    v_sub_f32 v139, v139, v4
    v_sub_f32 v140, v140, v4
    v_sub_f32 v141, v141, v4
    v_sub_f32 v142, v142, v4
    v_sub_f32 v143, v143, v4
    v_sub_f32 v144, v144, v4
    v_sub_f32 v145, v145, v4
    v_sub_f32 v146, v146, v4
    v_sub_f32 v147, v147, v4
    v_sub_f32 v148, v148, v4
    v_sub_f32 v149, v149, v4
    v_sub_f32 v150, v150, v4
    v_sub_f32 v151, v151, v4
    v_sub_f32 v104, v104, v4
    v_sub_f32 v105, v105, v4
    v_sub_f32 v106, v106, v4
    v_sub_f32 v107, v107, v4
    v_sub_f32 v108, v108, v4
    v_sub_f32 v109, v109, v4
    v_sub_f32 v110, v110, v4
    v_sub_f32 v111, v111, v4
    v_sub_f32 v112, v112, v4
    v_sub_f32 v113, v113, v4
    v_sub_f32 v114, v114, v4
    v_sub_f32 v115, v115, v4
    v_sub_f32 v116, v116, v4
    v_sub_f32 v117, v117, v4
    v_sub_f32 v118, v118, v4
    v_sub_f32 v119, v119, v4
    v_sub_f32 v120, v120, v4
    v_sub_f32 v121, v121, v4
    v_sub_f32 v122, v122, v4
    v_sub_f32 v123, v123, v4
    v_sub_f32 v124, v124, v4
    v_sub_f32 v125, v125, v4
    v_sub_f32 v126, v126, v4
    v_sub_f32 v127, v127, v4
    v_sub_f32 v128, v128, v4
    v_sub_f32 v129, v129, v4
    v_sub_f32 v130, v130, v4
    v_sub_f32 v131, v131, v4
    v_sub_f32 v132, v132, v4
    v_sub_f32 v133, v133, v4
    v_sub_f32 v134, v134, v4
    v_sub_f32 v135, v135, v4
    v_mul_f32 v168, v168, v5
    v_mul_f32 v169, v169, v5
    v_mul_f32 v170, v170, v5
    v_mul_f32 v171, v171, v5
    v_mul_f32 v172, v172, v5
    v_mul_f32 v173, v173, v5
    v_mul_f32 v174, v174, v5
    v_mul_f32 v175, v175, v5
    v_mul_f32 v176, v176, v5
    v_mul_f32 v177, v177, v5
    v_mul_f32 v178, v178, v5
    v_mul_f32 v179, v179, v5
    v_mul_f32 v180, v180, v5
    v_mul_f32 v181, v181, v5
    v_mul_f32 v182, v182, v5
    v_mul_f32 v183, v183, v5
    v_mul_f32 v184, v184, v5
    v_mul_f32 v185, v185, v5
    v_mul_f32 v186, v186, v5
    v_mul_f32 v187, v187, v5
    v_mul_f32 v188, v188, v5
    v_mul_f32 v189, v189, v5
    v_mul_f32 v190, v190, v5
    v_mul_f32 v191, v191, v5
    v_mul_f32 v192, v192, v5
    v_mul_f32 v193, v193, v5
    v_mul_f32 v194, v194, v5
    v_mul_f32 v195, v195, v5
    v_mul_f32 v196, v196, v5
    v_mul_f32 v197, v197, v5
    v_mul_f32 v198, v198, v5
    v_mul_f32 v199, v199, v5
    v_mul_f32 v200, v200, v5
    v_mul_f32 v201, v201, v5
    v_mul_f32 v202, v202, v5
    v_mul_f32 v203, v203, v5
    v_mul_f32 v204, v204, v5
    v_mul_f32 v205, v205, v5
    v_mul_f32 v206, v206, v5
    v_mul_f32 v207, v207, v5
    v_mul_f32 v208, v208, v5
    v_mul_f32 v209, v209, v5
    v_mul_f32 v210, v210, v5
    v_mul_f32 v211, v211, v5
    v_mul_f32 v212, v212, v5
    v_mul_f32 v213, v213, v5
    v_mul_f32 v214, v214, v5
    v_mul_f32 v215, v215, v5
    v_mul_f32 v216, v216, v5
    v_mul_f32 v217, v217, v5
    v_mul_f32 v218, v218, v5
    v_mul_f32 v219, v219, v5
    v_mul_f32 v220, v220, v5
    v_mul_f32 v221, v221, v5
    v_mul_f32 v222, v222, v5
    v_mul_f32 v223, v223, v5
    v_mul_f32 v224, v224, v5
    v_mul_f32 v225, v225, v5
    v_mul_f32 v226, v226, v5
    v_mul_f32 v227, v227, v5
    v_mul_f32 v228, v228, v5
    v_mul_f32 v229, v229, v5
    v_mul_f32 v230, v230, v5
    v_mul_f32 v231, v231, v5
    v_mul_f32 v36, v36, v5
    v_mul_f32 v37, v37, v5
    s_mov_b32 s30, 8.0
    s_mov_b32 s31, 0
    s_branch ret_48
at_A:
    s_sub_u32 s21, s2, 256
    s_lshr_b32 s21, s21, 5
    s_lshl_b32 s22, s21, 8
    s_lshl_b32 s36, s27, 6
    s_add_u32 s22, s22, s36
    v_and_b32 v4, 31, v1
    v_add_u32 v9, s22, v4
    s_lshl_b32 s36, s20, 11
    v_add_u32 v5, s36, v9
    v_mul_u32_u24 v5, 40, v5
    v_add_u32 v5, 67108864, v5
    v_lshl_add_u32 v6, v8, 4, v5
    v_cmp_eq_u32 vcc, 0, v8
    buffer_load_dwordx2 v[40:41], v6, s[8:11], 0 offen offset:0
    buffer_load_dwordx2 v[42:43], v6, s[8:11], 0 offen offset:8
    buffer_load_dwordx2 v[44:45], v5, s[8:11], 0 offen offset:32
    v_mov_b32 v46, 0
    v_mov_b32 v47, 0
    buffer_load_dwordx2 v[48:49], v6, s[8:11], 0 offen offset:1280
    buffer_load_dwordx2 v[50:51], v6, s[8:11], 0 offen offset:1288
    buffer_load_dwordx2 v[52:53], v5, s[8:11], 0 offen offset:1312
    v_mov_b32 v54, 0
    v_mov_b32 v55, 0
    s_waitcnt vmcnt(0)
    v_cndmask_b32 v44, 0, v44, vcc
    v_cndmask_b32 v45, 0, v45, vcc
    v_cndmask_b32 v52, 0, v52, vcc
    v_cndmask_b32 v53, 0, v53, vcc
    v_and_b32 v4, 31, v1
    v_and_b32 v5, 15, v1
    v_xor_b32 v5, v5, v8
    v_lshlrev_b32 v4, 8, v4
    v_xor_b32 v6, 0, v5
    v_lshl_add_u32 v16, v6, 4, v4
    v_xor_b32 v6, 2, v5
    v_lshl_add_u32 v17, v6, 4, v4
    v_xor_b32 v6, 4, v5
    v_lshl_add_u32 v18, v6, 4, v4
    v_xor_b32 v6, 6, v5
    v_lshl_add_u32 v19, v6, 4, v4
    v_xor_b32 v6, 8, v5
    v_lshl_add_u32 v20, v6, 4, v4
    v_xor_b32 v6, 10, v5
    v_lshl_add_u32 v21, v6, 4, v4
    v_xor_b32 v6, 12, v5
    v_lshl_add_u32 v22, v6, 4, v4
    v_xor_b32 v6, 14, v5
    v_lshl_add_u32 v23, v6, 4, v4
    v_and_b32 v4, 31, v1
    v_mul_u32_u24 v4, 40, v4
    v_lshl_add_u32 v24, v8, 4, v4
    v_add_u32 v25, 32, v4
    v_lshlrev_b32 v4, 2, v1
    v_mov_b32 v5, 0x3f803f80
    ds_write_b32 v4, v5 offset:13312
    ds_write_b32 v4, v5 offset:29696
    ds_write_b32 v4, v5 offset:46080
    ds_write_b32 v4, v5 offset:62464
    s_mul_i32 s36, s27, 3
    s_add_u32 s36, s36, 0
    s_cmp_ge_u32 s36, 10
    s_cselect_b32 s37, 10, 0
    s_sub_u32 s36, s36, s37
    s_mov_b32 s40, 0
    s_cmp_ge_u32 s36, 5
    s_cbranch_scc1 slv_49
    s_lshl_b32 s46, s36, 10
    s_mov_b32 s43, 5120
    s_mul_i32 s37, s20, 81920
    s_add_u32 s37, s37, s46
    s_add_u32 s37, s37, 69730304
    v_lshl_add_u32 v28, v1, 4, s37
    s_branch sld_50
slv_49:
    s_sub_u32 s36, s36, 5
    s_lshl_b32 s46, s36, 10
    s_add_u32 s46, s46, 8192
    s_mov_b32 s43, 256
    s_lshl_b32 s36, s36, 2
    v_lshrrev_b32 v4, 4, v1
    v_add_u32 v4, s36, v4
    v_and_b32 v5, 15, v4
    v_and_b32 v6, 15, v1
    v_xor_b32 v5, v5, v6
    s_mul_i32 s37, s20, 20
    v_add_u32 v4, s37, v4
    v_lshlrev_b32 v4, 12, v4
    v_lshl_add_u32 v4, v5, 4, v4
    v_add_u32 v28, 73400320, v4
sld_50:
    s_mul_i32 s36, s27, 3
    s_add_u32 s36, s36, 1
    s_cmp_ge_u32 s36, 10
    s_cselect_b32 s37, 10, 0
    s_sub_u32 s36, s36, s37
    s_mov_b32 s41, 0
    s_cmp_ge_u32 s36, 5
    s_cbranch_scc1 slv_51
    s_lshl_b32 s47, s36, 10
    s_mov_b32 s44, 5120
    s_mul_i32 s37, s20, 81920
    s_add_u32 s37, s37, s47
    s_add_u32 s37, s37, 69730304
    v_lshl_add_u32 v29, v1, 4, s37
    s_branch sld_52
slv_51:
    s_sub_u32 s36, s36, 5
    s_lshl_b32 s47, s36, 10
    s_add_u32 s47, s47, 8192
    s_mov_b32 s44, 256
    s_lshl_b32 s36, s36, 2
    v_lshrrev_b32 v4, 4, v1
    v_add_u32 v4, s36, v4
    v_and_b32 v5, 15, v4
    v_and_b32 v6, 15, v1
    v_xor_b32 v5, v5, v6
    s_mul_i32 s37, s20, 20
    v_add_u32 v4, s37, v4
    v_lshlrev_b32 v4, 12, v4
    v_lshl_add_u32 v4, v5, 4, v4
    v_add_u32 v29, 73400320, v4
sld_52:
    s_mul_i32 s36, s27, 3
    s_add_u32 s36, s36, 2
    s_cmp_ge_u32 s36, 10
    s_cselect_b32 s37, 10, 0
    s_sub_u32 s36, s36, s37
    s_mov_b32 s42, 0
    s_cmp_ge_u32 s36, 5
    s_cbranch_scc1 slv_53
    s_lshl_b32 s48, s36, 10
    s_mov_b32 s45, 5120
    s_mul_i32 s37, s20, 81920
    s_add_u32 s37, s37, s48
    s_add_u32 s37, s37, 69730304
    v_lshl_add_u32 v30, v1, 4, s37
    s_branch sld_54
slv_53:
    s_sub_u32 s36, s36, 5
    s_lshl_b32 s48, s36, 10
    s_add_u32 s48, s48, 8192
    s_mov_b32 s45, 256
    s_lshl_b32 s36, s36, 2
    v_lshrrev_b32 v4, 4, v1
    v_add_u32 v4, s36, v4
    v_and_b32 v5, 15, v4
    v_and_b32 v6, 15, v1
    v_xor_b32 v5, v5, v6
    s_mul_i32 s37, s20, 20
    v_add_u32 v4, s37, v4
    v_lshlrev_b32 v4, 12, v4
    v_lshl_add_u32 v4, v5, 4, v4
    v_add_u32 v30, 73400320, v4
sld_54:
    v_mov_b32 v136, 0
    v_mov_b32 v137, 0
    v_mov_b32 v138, 0
    v_mov_b32 v139, 0
    v_mov_b32 v140, 0
    v_mov_b32 v141, 0
    v_mov_b32 v142, 0
    v_mov_b32 v143, 0
    v_mov_b32 v144, 0
    v_mov_b32 v145, 0
    v_mov_b32 v146, 0
    v_mov_b32 v147, 0
    v_mov_b32 v148, 0
    v_mov_b32 v149, 0
    v_mov_b32 v150, 0
    v_mov_b32 v151, 0
    v_mov_b32 v152, 0
    v_mov_b32 v153, 0
    v_mov_b32 v154, 0
    v_mov_b32 v155, 0
    v_mov_b32 v156, 0
    v_mov_b32 v157, 0
    v_mov_b32 v158, 0
    v_mov_b32 v159, 0
    v_mov_b32 v160, 0
    v_mov_b32 v161, 0
    v_mov_b32 v162, 0
    v_mov_b32 v163, 0
    v_mov_b32 v164, 0
    v_mov_b32 v165, 0
    v_mov_b32 v166, 0
    v_mov_b32 v167, 0
    v_mov_b32 v184, 0
    v_mov_b32 v185, 0
    v_mov_b32 v186, 0
    v_mov_b32 v187, 0
    v_mov_b32 v188, 0
    v_mov_b32 v189, 0
    v_mov_b32 v190, 0
    v_mov_b32 v191, 0
    v_mov_b32 v192, 0
    v_mov_b32 v193, 0
    v_mov_b32 v194, 0
    v_mov_b32 v195, 0
    v_mov_b32 v196, 0
    v_mov_b32 v197, 0
    v_mov_b32 v198, 0
    v_mov_b32 v199, 0
    v_mov_b32 v200, 0
    v_mov_b32 v201, 0
    v_mov_b32 v202, 0
    v_mov_b32 v203, 0
    v_mov_b32 v204, 0
    v_mov_b32 v205, 0
    v_mov_b32 v206, 0
    v_mov_b32 v207, 0
    v_mov_b32 v208, 0
    v_mov_b32 v209, 0
    v_mov_b32 v210, 0
    v_mov_b32 v211, 0
    v_mov_b32 v212, 0
    v_mov_b32 v213, 0
    v_mov_b32 v214, 0
    v_mov_b32 v215, 0
    v_mov_b32 v36, 0
    v_mov_b32 v37, 0
    s_mov_b32 s30, 0xff7fffff
    s_mov_b32 s31, 0xff7fffff
    s_mov_b32 s49, 0
    s_add_u32 m0, s46, s49
    s_nop 0
    buffer_load_dwordx4 v28, s[8:11], s40 offen lds
    s_add_u32 s40, s40, s43
    s_add_u32 m0, s47, s49
    s_nop 0
    buffer_load_dwordx4 v29, s[8:11], s41 offen lds
    s_add_u32 s41, s41, s44
    s_add_u32 m0, s48, s49
    s_nop 0
    buffer_load_dwordx4 v30, s[8:11], s42 offen lds
    s_add_u32 s42, s42, s45
    s_add_u32 s49, s49, 16384
    s_and_b32 s49, s49, 0xffff
    s_add_u32 m0, s46, s49
    s_nop 0
    buffer_load_dwordx4 v28, s[8:11], s40 offen lds
    s_add_u32 s40, s40, s43
    s_add_u32 m0, s47, s49
    s_nop 0
    buffer_load_dwordx4 v29, s[8:11], s41 offen lds
    s_add_u32 s41, s41, s44
    s_add_u32 m0, s48, s49
    s_nop 0
    buffer_load_dwordx4 v30, s[8:11], s42 offen lds
    s_add_u32 s42, s42, s45
    s_add_u32 s49, s49, 16384
    s_and_b32 s49, s49, 0xffff
    s_mov_b32 s21, 15
    s_waitcnt vmcnt(3) lgkmcnt(0)
    s_barrier
    ds_read_b64 v[232:233], v24 offset:0
    ds_read_b64 v[234:235], v24 offset:8
    ds_read_b64 v[236:237], v25 offset:0
    v_mov_b32 v238, 0
    v_mov_b32 v239, 0
    s_waitcnt lgkmcnt(1)
    v_mfma_f32_32x32x16_bf16 v[72:87], v[232:235], v[40:43], v[136:151]
    v_mfma_f32_32x32x16_bf16 v[88:103], v[232:235], v[48:51], v[152:167]
    s_waitcnt lgkmcnt(0)
    v_mfma_f32_32x32x16_bf16 v[72:87], v[236:239], v[44:47], v[72:87]
    v_mfma_f32_32x32x16_bf16 v[88:103], v[236:239], v[52:55], v[88:103]
    s_nop 7
    s_nop 7
    v_max_f32 v38, v72, v73
    v_max_f32 v39, v88, v89
    v_max3_f32 v38, v38, v74, v75
    v_max3_f32 v39, v39, v90, v91
    v_max3_f32 v38, v38, v76, v77
    v_max3_f32 v39, v39, v92, v93
    v_max3_f32 v38, v38, v78, v79
    v_max3_f32 v39, v39, v94, v95
    v_max3_f32 v38, v38, v80, v81
    v_max3_f32 v39, v39, v96, v97
    v_max3_f32 v38, v38, v82, v83
    v_max3_f32 v39, v39, v98, v99
    v_max3_f32 v38, v38, v84, v85
    v_max3_f32 v39, v39, v100, v101
    v_max3_f32 v38, v38, v86, v87
    v_max3_f32 v39, v39, v102, v103
    v_max_f32 v6, v38, v39
    v_cmp_lt_f32 vcc, s30, v6
    s_nop 1
    s_cbranch_vccnz slow_55
ret_56:
atA_loop:
    ds_read_b64 v[240:241], v24 offset:1280
    ds_read_b64 v[242:243], v24 offset:1288
    ds_read_b64 v[244:245], v25 offset:1280
    v_mov_b32 v246, 0
    v_mov_b32 v247, 0
    ds_read_b128 v[248:251], v16 offset:8192
    ds_read_b128 v[252:255], v17 offset:8192
    v_exp_f32 v72, v72
    v_exp_f32 v73, v73
    v_exp_f32 v74, v74
    v_exp_f32 v75, v75
    v_exp_f32 v76, v76
    v_exp_f32 v77, v77
    s_waitcnt lgkmcnt(3)
    v_mfma_f32_32x32x16_bf16 v[104:119], v[240:243], v[40:43], v[136:151]
    v_exp_f32 v78, v78
    v_exp_f32 v79, v79
    v_exp_f32 v80, v80
    v_exp_f32 v81, v81
    v_exp_f32 v82, v82
    v_exp_f32 v83, v83
    v_mfma_f32_32x32x16_bf16 v[120:135], v[240:243], v[48:51], v[152:167]
    v_exp_f32 v84, v84
    v_exp_f32 v85, v85
    v_exp_f32 v86, v86
    v_exp_f32 v87, v87
    v_cvt_pk_bf16_f32 v168, v72, v73
    v_cvt_pk_bf16_f32 v169, v74, v75
    s_waitcnt lgkmcnt(2)
    v_mfma_f32_32x32x16_bf16 v[104:119], v[244:247], v[44:47], v[104:119]
    v_cvt_pk_bf16_f32 v170, v76, v77
    v_cvt_pk_bf16_f32 v171, v78, v79
    v_cvt_pk_bf16_f32 v172, v80, v81
    v_cvt_pk_bf16_f32 v173, v82, v83
    v_cvt_pk_bf16_f32 v174, v84, v85
    v_cvt_pk_bf16_f32 v175, v86, v87
    v_mfma_f32_32x32x16_bf16 v[120:135], v[244:247], v[52:55], v[120:135]
    s_nop 1
    v_exp_f32 v88, v88
    v_exp_f32 v89, v89
    v_exp_f32 v90, v90
    v_exp_f32 v91, v91
    v_exp_f32 v92, v92
    v_exp_f32 v93, v93
    v_exp_f32 v94, v94
    v_exp_f32 v95, v95
    v_exp_f32 v96, v96
    v_exp_f32 v97, v97
    v_exp_f32 v98, v98
    v_exp_f32 v99, v99
    s_waitcnt lgkmcnt(1)
    v_mfma_f32_32x32x16_bf16 v[184:199], v[248:251], v[168:171], v[184:199]
    v_exp_f32 v100, v100
    v_exp_f32 v101, v101
    v_exp_f32 v102, v102
    v_exp_f32 v103, v103
    v_cvt_pk_bf16_f32 v176, v88, v89
    v_cvt_pk_bf16_f32 v177, v90, v91
    v_cvt_pk_bf16_f32 v178, v92, v93
    v_cvt_pk_bf16_f32 v179, v94, v95
    v_cvt_pk_bf16_f32 v180, v96, v97
    v_cvt_pk_bf16_f32 v181, v98, v99
    v_cvt_pk_bf16_f32 v182, v100, v101
    v_cvt_pk_bf16_f32 v183, v102, v103
    s_waitcnt lgkmcnt(0)
    v_mfma_f32_32x32x16_bf16 v[184:199], v[252:255], v[172:175], v[184:199]
    s_nop 1
    v_max_f32 v38, v104, v105
    v_max_f32 v39, v120, v121
    v_max3_f32 v38, v38, v106, v107
    v_max3_f32 v39, v39, v122, v123
    v_max3_f32 v38, v38, v108, v109
    v_max3_f32 v39, v39, v124, v125
    v_max3_f32 v38, v38, v110, v111
    v_max3_f32 v39, v39, v126, v127
    v_max3_f32 v38, v38, v112, v113
    v_mfma_f32_32x32x16_bf16 v[200:215], v[248:251], v[176:179], v[200:215]
    v_max3_f32 v39, v39, v128, v129
    v_max3_f32 v38, v38, v114, v115
    v_max3_f32 v39, v39, v130, v131
    v_max3_f32 v38, v38, v116, v117
    v_max3_f32 v39, v39, v132, v133
    v_max3_f32 v38, v38, v118, v119
    v_max3_f32 v39, v39, v134, v135
    v_max_f32 v6, v38, v39
    v_cmp_lt_f32 vcc, s30, v6
    v_mfma_f32_32x32x16_bf16 v[200:215], v[252:255], v[180:183], v[200:215]
    s_nop 1
    s_cbranch_vccnz slow_57
ret_58:
    ds_read_b64 v[232:233], v24 offset:2560
    ds_read_b64 v[234:235], v24 offset:2568
    ds_read_b64 v[236:237], v25 offset:2560
    v_mov_b32 v238, 0
    v_mov_b32 v239, 0
    ds_read_b128 v[240:243], v18 offset:8192
    ds_read_b128 v[244:247], v19 offset:8192
    v_exp_f32 v104, v104
    v_exp_f32 v105, v105
    v_exp_f32 v106, v106
    v_exp_f32 v107, v107
    v_exp_f32 v108, v108
    v_exp_f32 v109, v109
    s_waitcnt lgkmcnt(3)
    v_mfma_f32_32x32x16_bf16 v[72:87], v[232:235], v[40:43], v[136:151]
    v_exp_f32 v110, v110
    v_exp_f32 v111, v111
    v_exp_f32 v112, v112
    v_exp_f32 v113, v113
    v_exp_f32 v114, v114
    v_exp_f32 v115, v115
    v_mfma_f32_32x32x16_bf16 v[88:103], v[232:235], v[48:51], v[152:167]
    v_exp_f32 v116, v116
    v_exp_f32 v117, v117
    v_exp_f32 v118, v118
    v_exp_f32 v119, v119
    v_cvt_pk_bf16_f32 v168, v104, v105
    v_cvt_pk_bf16_f32 v169, v106, v107
    s_waitcnt lgkmcnt(2)
    v_mfma_f32_32x32x16_bf16 v[72:87], v[236:239], v[44:47], v[72:87]
    v_cvt_pk_bf16_f32 v170, v108, v109
    v_cvt_pk_bf16_f32 v171, v110, v111
    v_cvt_pk_bf16_f32 v172, v112, v113
    v_cvt_pk_bf16_f32 v173, v114, v115
    v_cvt_pk_bf16_f32 v174, v116, v117
    v_cvt_pk_bf16_f32 v175, v118, v119
    v_mfma_f32_32x32x16_bf16 v[88:103], v[236:239], v[52:55], v[88:103]
    s_nop 1
    v_exp_f32 v120, v120
    v_exp_f32 v121, v121
    v_exp_f32 v122, v122
    v_exp_f32 v123, v123
    v_exp_f32 v124, v124
    v_exp_f32 v125, v125
    v_exp_f32 v126, v126
    v_exp_f32 v127, v127
    v_exp_f32 v128, v128
    v_exp_f32 v129, v129
    v_exp_f32 v130, v130
    v_exp_f32 v131, v131
    s_waitcnt lgkmcnt(1)
    v_mfma_f32_32x32x16_bf16 v[184:199], v[240:243], v[168:171], v[184:199]
    v_exp_f32 v132, v132
    v_exp_f32 v133, v133
    v_exp_f32 v134, v134
    v_exp_f32 v135, v135
    v_cvt_pk_bf16_f32 v176, v120, v121
    v_cvt_pk_bf16_f32 v177, v122, v123
    v_cvt_pk_bf16_f32 v178, v124, v125
    v_cvt_pk_bf16_f32 v179, v126, v127
    v_cvt_pk_bf16_f32 v180, v128, v129
    v_cvt_pk_bf16_f32 v181, v130, v131
    v_cvt_pk_bf16_f32 v182, v132, v133
    v_cvt_pk_bf16_f32 v183, v134, v135
    s_waitcnt lgkmcnt(0)
    v_mfma_f32_32x32x16_bf16 v[184:199], v[244:247], v[172:175], v[184:199]
    s_nop 1
    v_max_f32 v38, v72, v73
    v_max_f32 v39, v88, v89
    v_max3_f32 v38, v38, v74, v75
    v_max3_f32 v39, v39, v90, v91
    v_max3_f32 v38, v38, v76, v77
    v_max3_f32 v39, v39, v92, v93
    v_max3_f32 v38, v38, v78, v79
    v_max3_f32 v39, v39, v94, v95
    v_max3_f32 v38, v38, v80, v81
    v_mfma_f32_32x32x16_bf16 v[200:215], v[240:243], v[176:179], v[200:215]
    v_max3_f32 v39, v39, v96, v97
    v_max3_f32 v38, v38, v82, v83
    v_max3_f32 v39, v39, v98, v99
    v_max3_f32 v38, v38, v84, v85
    v_max3_f32 v39, v39, v100, v101
    v_max3_f32 v38, v38, v86, v87
    v_max3_f32 v39, v39, v102, v103
    v_max_f32 v6, v38, v39
    v_cmp_lt_f32 vcc, s30, v6
    v_mfma_f32_32x32x16_bf16 v[200:215], v[244:247], v[180:183], v[200:215]
    s_nop 1
    s_cbranch_vccnz slow_59
ret_60:
    ds_read_b64 v[248:249], v24 offset:3840
    ds_read_b64 v[250:251], v24 offset:3848
    ds_read_b64 v[252:253], v25 offset:3840
    v_mov_b32 v254, 0
    v_mov_b32 v255, 0
    ds_read_b128 v[232:235], v20 offset:8192
    ds_read_b128 v[236:239], v21 offset:8192
    v_exp_f32 v72, v72
    v_exp_f32 v73, v73
    v_exp_f32 v74, v74
    v_exp_f32 v75, v75
    v_exp_f32 v76, v76
    v_exp_f32 v77, v77
    s_waitcnt lgkmcnt(3)
    v_mfma_f32_32x32x16_bf16 v[104:119], v[248:251], v[40:43], v[136:151]
    v_exp_f32 v78, v78
    v_exp_f32 v79, v79
    v_exp_f32 v80, v80
    v_exp_f32 v81, v81
    v_exp_f32 v82, v82
    v_exp_f32 v83, v83
    v_mfma_f32_32x32x16_bf16 v[120:135], v[248:251], v[48:51], v[152:167]
    v_exp_f32 v84, v84
    v_exp_f32 v85, v85
    v_exp_f32 v86, v86
    v_exp_f32 v87, v87
    v_cvt_pk_bf16_f32 v168, v72, v73
    v_cvt_pk_bf16_f32 v169, v74, v75
    s_waitcnt lgkmcnt(2)
    v_mfma_f32_32x32x16_bf16 v[104:119], v[252:255], v[44:47], v[104:119]
    v_cvt_pk_bf16_f32 v170, v76, v77
    v_cvt_pk_bf16_f32 v171, v78, v79
    v_cvt_pk_bf16_f32 v172, v80, v81
    v_cvt_pk_bf16_f32 v173, v82, v83
    v_cvt_pk_bf16_f32 v174, v84, v85
    v_cvt_pk_bf16_f32 v175, v86, v87
    v_mfma_f32_32x32x16_bf16 v[120:135], v[252:255], v[52:55], v[120:135]
    s_nop 1
    v_exp_f32 v88, v88
    v_exp_f32 v89, v89
    v_exp_f32 v90, v90
    v_exp_f32 v91, v91
    v_exp_f32 v92, v92
    v_exp_f32 v93, v93
    v_exp_f32 v94, v94
    v_exp_f32 v95, v95
    v_exp_f32 v96, v96
    v_exp_f32 v97, v97
    v_exp_f32 v98, v98
    v_exp_f32 v99, v99
    s_waitcnt lgkmcnt(1)
    v_mfma_f32_32x32x16_bf16 v[184:199], v[232:235], v[168:171], v[184:199]
    v_exp_f32 v100, v100
    v_exp_f32 v101, v101
    v_exp_f32 v102, v102
    v_exp_f32 v103, v103
    v_cvt_pk_bf16_f32 v176, v88, v89
    v_cvt_pk_bf16_f32 v177, v90, v91
    v_cvt_pk_bf16_f32 v178, v92, v93
    v_cvt_pk_bf16_f32 v179, v94, v95
    v_cvt_pk_bf16_f32 v180, v96, v97
    v_cvt_pk_bf16_f32 v181, v98, v99
    v_cvt_pk_bf16_f32 v182, v100, v101
    v_cvt_pk_bf16_f32 v183, v102, v103
    s_waitcnt lgkmcnt(0)
    v_mfma_f32_32x32x16_bf16 v[184:199], v[236:239], v[172:175], v[184:199]
    s_nop 1
    v_max_f32 v38, v104, v105
    v_max_f32 v39, v120, v121
    v_max3_f32 v38, v38, v106, v107
    v_max3_f32 v39, v39, v122, v123
    v_max3_f32 v38, v38, v108, v109
    v_max3_f32 v39, v39, v124, v125
    v_max3_f32 v38, v38, v110, v111
    v_max3_f32 v39, v39, v126, v127
    v_max3_f32 v38, v38, v112, v113
    v_mfma_f32_32x32x16_bf16 v[200:215], v[232:235], v[176:179], v[200:215]
    v_max3_f32 v39, v39, v128, v129
    v_max3_f32 v38, v38, v114, v115
    v_max3_f32 v39, v39, v130, v131
    v_max3_f32 v38, v38, v116, v117
    v_max3_f32 v39, v39, v132, v133
    v_max3_f32 v38, v38, v118, v119
    v_max3_f32 v39, v39, v134, v135
    v_max_f32 v6, v38, v39
    v_cmp_lt_f32 vcc, s30, v6
    v_mfma_f32_32x32x16_bf16 v[200:215], v[236:239], v[180:183], v[200:215]
    s_nop 1
    s_cbranch_vccnz slow_61
ret_62:
    s_waitcnt vmcnt(0)
    s_barrier
    s_cmp_eq_u32 s21, 1
    s_cbranch_scc1 atA_nold
    s_add_u32 m0, s46, s49
    s_nop 0
    buffer_load_dwordx4 v28, s[8:11], s40 offen lds
    s_add_u32 s40, s40, s43
    s_add_u32 m0, s47, s49
    s_nop 0
    buffer_load_dwordx4 v29, s[8:11], s41 offen lds
    s_add_u32 s41, s41, s44
    s_add_u32 m0, s48, s49
    s_nop 0
    buffer_load_dwordx4 v30, s[8:11], s42 offen lds
    s_add_u32 s42, s42, s45
    s_add_u32 s49, s49, 16384
    s_and_b32 s49, s49, 0xffff
atA_nold:
    v_add_u32 v24, 0x4000, v24
    v_and_b32 v24, 0xffff, v24
    v_add_u32 v25, 0x4000, v25
    v_and_b32 v25, 0xffff, v25
    ds_read_b64 v[240:241], v24 offset:0
    ds_read_b64 v[242:243], v24 offset:8
    ds_read_b64 v[244:245], v25 offset:0
    v_mov_b32 v246, 0
    v_mov_b32 v247, 0
    ds_read_b128 v[248:251], v22 offset:8192
    ds_read_b128 v[252:255], v23 offset:8192
    v_exp_f32 v104, v104
    v_exp_f32 v105, v105
    v_exp_f32 v106, v106
    v_exp_f32 v107, v107
    v_exp_f32 v108, v108
    v_exp_f32 v109, v109
    s_waitcnt lgkmcnt(3)
    v_mfma_f32_32x32x16_bf16 v[72:87], v[240:243], v[40:43], v[136:151]
    v_exp_f32 v110, v110
    v_exp_f32 v111, v111
    v_exp_f32 v112, v112
    v_exp_f32 v113, v113
    v_exp_f32 v114, v114
    v_exp_f32 v115, v115
    v_mfma_f32_32x32x16_bf16 v[88:103], v[240:243], v[48:51], v[152:167]
    v_exp_f32 v116, v116
    v_exp_f32 v117, v117
    v_exp_f32 v118, v118
    v_exp_f32 v119, v119
    v_cvt_pk_bf16_f32 v168, v104, v105
    v_cvt_pk_bf16_f32 v169, v106, v107
    s_waitcnt lgkmcnt(2)
    v_mfma_f32_32x32x16_bf16 v[72:87], v[244:247], v[44:47], v[72:87]
    v_cvt_pk_bf16_f32 v170, v108, v109
    v_cvt_pk_bf16_f32 v171, v110, v111
    v_cvt_pk_bf16_f32 v172, v112, v113
    v_cvt_pk_bf16_f32 v173, v114, v115
    v_cvt_pk_bf16_f32 v174, v116, v117
    v_cvt_pk_bf16_f32 v175, v118, v119
    v_mfma_f32_32x32x16_bf16 v[88:103], v[244:247], v[52:55], v[88:103]
    s_nop 1
    v_exp_f32 v120, v120
    v_exp_f32 v121, v121
    v_exp_f32 v122, v122
    v_exp_f32 v123, v123
    v_exp_f32 v124, v124
    v_exp_f32 v125, v125
    v_exp_f32 v126, v126
    v_exp_f32 v127, v127
    v_exp_f32 v128, v128
    v_exp_f32 v129, v129
    v_exp_f32 v130, v130
    v_exp_f32 v131, v131
    s_waitcnt lgkmcnt(1)
    v_mfma_f32_32x32x16_bf16 v[184:199], v[248:251], v[168:171], v[184:199]
    v_exp_f32 v132, v132
    v_exp_f32 v133, v133
    v_exp_f32 v134, v134
    v_exp_f32 v135, v135
    v_cvt_pk_bf16_f32 v176, v120, v121
    v_cvt_pk_bf16_f32 v177, v122, v123
    v_cvt_pk_bf16_f32 v178, v124, v125
    v_cvt_pk_bf16_f32 v179, v126, v127
    v_cvt_pk_bf16_f32 v180, v128, v129
    v_cvt_pk_bf16_f32 v181, v130, v131
    v_cvt_pk_bf16_f32 v182, v132, v133
    v_cvt_pk_bf16_f32 v183, v134, v135
    s_waitcnt lgkmcnt(0)
    v_mfma_f32_32x32x16_bf16 v[184:199], v[252:255], v[172:175], v[184:199]
    s_nop 1
    v_max_f32 v38, v72, v73
    v_max_f32 v39, v88, v89
    v_max3_f32 v38, v38, v74, v75
    v_max3_f32 v39, v39, v90, v91
    v_max3_f32 v38, v38, v76, v77
    v_max3_f32 v39, v39, v92, v93
    v_max3_f32 v38, v38, v78, v79
    v_max3_f32 v39, v39, v94, v95
    v_max3_f32 v38, v38, v80, v81
    v_mfma_f32_32x32x16_bf16 v[200:215], v[248:251], v[176:179], v[200:215]
    v_max3_f32 v39, v39, v96, v97
    v_max3_f32 v38, v38, v82, v83
    v_max3_f32 v39, v39, v98, v99
    v_max3_f32 v38, v38, v84, v85
    v_max3_f32 v39, v39, v100, v101
    v_max3_f32 v38, v38, v86, v87
    v_max3_f32 v39, v39, v102, v103
    v_max_f32 v6, v38, v39
    v_cmp_lt_f32 vcc, s30, v6
    v_mfma_f32_32x32x16_bf16 v[200:215], v[252:255], v[180:183], v[200:215]
    v_add_u32 v16, 0x4000, v16
    v_and_b32 v16, 0xffff, v16
    v_add_u32 v17, 0x4000, v17
    v_and_b32 v17, 0xffff, v17
    v_add_u32 v18, 0x4000, v18
    v_and_b32 v18, 0xffff, v18
    v_add_u32 v19, 0x4000, v19
    v_and_b32 v19, 0xffff, v19
    v_add_u32 v20, 0x4000, v20
    v_and_b32 v20, 0xffff, v20
    v_add_u32 v21, 0x4000, v21
    v_and_b32 v21, 0xffff, v21
    v_add_u32 v22, 0x4000, v22
    v_and_b32 v22, 0xffff, v22
    v_add_u32 v23, 0x4000, v23
    v_and_b32 v23, 0xffff, v23
    s_nop 1
    s_cbranch_vccnz slow_63
ret_64:
    s_sub_u32 s21, s21, 1
    s_cmp_lg_u32 s21, 0
    s_cbranch_scc1 atA_loop
    ds_read_b64 v[232:233], v24 offset:1280
    ds_read_b64 v[234:235], v24 offset:1288
    ds_read_b64 v[236:237], v25 offset:1280
    v_mov_b32 v238, 0
    v_mov_b32 v239, 0
    ds_read_b128 v[240:243], v16 offset:8192
    ds_read_b128 v[244:247], v17 offset:8192
    v_exp_f32 v72, v72
    v_exp_f32 v73, v73
    v_exp_f32 v74, v74
    v_exp_f32 v75, v75
    v_exp_f32 v76, v76
    v_exp_f32 v77, v77
    s_waitcnt lgkmcnt(3)
    v_mfma_f32_32x32x16_bf16 v[104:119], v[232:235], v[40:43], v[136:151]
    v_exp_f32 v78, v78
    v_exp_f32 v79, v79
    v_exp_f32 v80, v80
    v_exp_f32 v81, v81
    v_exp_f32 v82, v82
    v_exp_f32 v83, v83
    v_mfma_f32_32x32x16_bf16 v[120:135], v[232:235], v[48:51], v[152:167]
    v_exp_f32 v84, v84
    v_exp_f32 v85, v85
    v_exp_f32 v86, v86
    v_exp_f32 v87, v87
    v_cvt_pk_bf16_f32 v168, v72, v73
    v_cvt_pk_bf16_f32 v169, v74, v75
    s_waitcnt lgkmcnt(2)
    v_mfma_f32_32x32x16_bf16 v[104:119], v[236:239], v[44:47], v[104:119]
    v_cvt_pk_bf16_f32 v170, v76, v77
    v_cvt_pk_bf16_f32 v171, v78, v79
    v_cvt_pk_bf16_f32 v172, v80, v81
    v_cvt_pk_bf16_f32 v173, v82, v83
    v_cvt_pk_bf16_f32 v174, v84, v85
    v_cvt_pk_bf16_f32 v175, v86, v87
    v_mfma_f32_32x32x16_bf16 v[120:135], v[236:239], v[52:55], v[120:135]
    s_nop 1
    v_exp_f32 v88, v88
    v_exp_f32 v89, v89
    v_exp_f32 v90, v90
    v_exp_f32 v91, v91
    v_exp_f32 v92, v92
    v_exp_f32 v93, v93
    v_exp_f32 v94, v94
    v_exp_f32 v95, v95
    v_exp_f32 v96, v96
    v_exp_f32 v97, v97
    v_exp_f32 v98, v98
    v_exp_f32 v99, v99
    s_waitcnt lgkmcnt(1)
    v_mfma_f32_32x32x16_bf16 v[184:199], v[240:243], v[168:171], v[184:199]
    v_exp_f32 v100, v100
    v_exp_f32 v101, v101
    v_exp_f32 v102, v102
    v_exp_f32 v103, v103
    v_cvt_pk_bf16_f32 v176, v88, v89
    v_cvt_pk_bf16_f32 v177, v90, v91
    v_cvt_pk_bf16_f32 v178, v92, v93
    v_cvt_pk_bf16_f32 v179, v94, v95
    v_cvt_pk_bf16_f32 v180, v96, v97
    v_cvt_pk_bf16_f32 v181, v98, v99
    v_cvt_pk_bf16_f32 v182, v100, v101
    v_cvt_pk_bf16_f32 v183, v102, v103
    s_waitcnt lgkmcnt(0)
    v_mfma_f32_32x32x16_bf16 v[184:199], v[244:247], v[172:175], v[184:199]
    s_nop 1
    v_max_f32 v38, v104, v105
    v_max_f32 v39, v120, v121
    v_max3_f32 v38, v38, v106, v107
    v_max3_f32 v39, v39, v122, v123
    v_max3_f32 v38, v38, v108, v109
    v_max3_f32 v39, v39, v124, v125
    v_max3_f32 v38, v38, v110, v111
    v_max3_f32 v39, v39, v126, v127
    v_max3_f32 v38, v38, v112, v113
    v_mfma_f32_32x32x16_bf16 v[200:215], v[240:243], v[176:179], v[200:215]
    v_max3_f32 v39, v39, v128, v129
    v_max3_f32 v38, v38, v114, v115
    v_max3_f32 v39, v39, v130, v131
    v_max3_f32 v38, v38, v116, v117
    v_max3_f32 v39, v39, v132, v133
    v_max3_f32 v38, v38, v118, v119
    v_max3_f32 v39, v39, v134, v135
    v_max_f32 v6, v38, v39
    v_cmp_lt_f32 vcc, s30, v6
    v_mfma_f32_32x32x16_bf16 v[200:215], v[244:247], v[180:183], v[200:215]
    s_nop 1
    s_cbranch_vccnz slow_65
ret_66:
    ds_read_b64 v[248:249], v24 offset:2560
    ds_read_b64 v[250:251], v24 offset:2568
    ds_read_b64 v[252:253], v25 offset:2560
    v_mov_b32 v254, 0
    v_mov_b32 v255, 0
    ds_read_b128 v[232:235], v18 offset:8192
    ds_read_b128 v[236:239], v19 offset:8192
    v_exp_f32 v104, v104
    v_exp_f32 v105, v105
    v_exp_f32 v106, v106
    v_exp_f32 v107, v107
    v_exp_f32 v108, v108
    v_exp_f32 v109, v109
    s_waitcnt lgkmcnt(3)
    v_mfma_f32_32x32x16_bf16 v[72:87], v[248:251], v[40:43], v[136:151]
    v_exp_f32 v110, v110
    v_exp_f32 v111, v111
    v_exp_f32 v112, v112
    v_exp_f32 v113, v113
    v_exp_f32 v114, v114
    v_exp_f32 v115, v115
    v_mfma_f32_32x32x16_bf16 v[88:103], v[248:251], v[48:51], v[152:167]
    v_exp_f32 v116, v116
    v_exp_f32 v117, v117
    v_exp_f32 v118, v118
    v_exp_f32 v119, v119
    v_cvt_pk_bf16_f32 v168, v104, v105
    v_cvt_pk_bf16_f32 v169, v106, v107
    s_waitcnt lgkmcnt(2)
    v_mfma_f32_32x32x16_bf16 v[72:87], v[252:255], v[44:47], v[72:87]
    v_cvt_pk_bf16_f32 v170, v108, v109
    v_cvt_pk_bf16_f32 v171, v110, v111
    v_cvt_pk_bf16_f32 v172, v112, v113
    v_cvt_pk_bf16_f32 v173, v114, v115
    v_cvt_pk_bf16_f32 v174, v116, v117
    v_cvt_pk_bf16_f32 v175, v118, v119
    v_mfma_f32_32x32x16_bf16 v[88:103], v[252:255], v[52:55], v[88:103]
    s_nop 1
    v_exp_f32 v120, v120
    v_exp_f32 v121, v121
    v_exp_f32 v122, v122
    v_exp_f32 v123, v123
    v_exp_f32 v124, v124
    v_exp_f32 v125, v125
    v_exp_f32 v126, v126
    v_exp_f32 v127, v127
    v_exp_f32 v128, v128
    v_exp_f32 v129, v129
    v_exp_f32 v130, v130
    v_exp_f32 v131, v131
    s_waitcnt lgkmcnt(1)
    v_mfma_f32_32x32x16_bf16 v[184:199], v[232:235], v[168:171], v[184:199]
    v_exp_f32 v132, v132
    v_exp_f32 v133, v133
    v_exp_f32 v134, v134
    v_exp_f32 v135, v135
    v_cvt_pk_bf16_f32 v176, v120, v121
    v_cvt_pk_bf16_f32 v177, v122, v123
    v_cvt_pk_bf16_f32 v178, v124, v125
    v_cvt_pk_bf16_f32 v179, v126, v127
    v_cvt_pk_bf16_f32 v180, v128, v129
    v_cvt_pk_bf16_f32 v181, v130, v131
    v_cvt_pk_bf16_f32 v182, v132, v133
    v_cvt_pk_bf16_f32 v183, v134, v135
    s_waitcnt lgkmcnt(0)
    v_mfma_f32_32x32x16_bf16 v[184:199], v[236:239], v[172:175], v[184:199]
    s_nop 1
    v_max_f32 v38, v72, v73
    v_max_f32 v39, v88, v89
    v_max3_f32 v38, v38, v74, v75
    v_max3_f32 v39, v39, v90, v91
    v_max3_f32 v38, v38, v76, v77
    v_max3_f32 v39, v39, v92, v93
    v_max3_f32 v38, v38, v78, v79
    v_max3_f32 v39, v39, v94, v95
    v_max3_f32 v38, v38, v80, v81
    v_mfma_f32_32x32x16_bf16 v[200:215], v[232:235], v[176:179], v[200:215]
    v_max3_f32 v39, v39, v96, v97
    v_max3_f32 v38, v38, v82, v83
    v_max3_f32 v39, v39, v98, v99
    v_max3_f32 v38, v38, v84, v85
    v_max3_f32 v39, v39, v100, v101
    v_max3_f32 v38, v38, v86, v87
    v_max3_f32 v39, v39, v102, v103
    v_max_f32 v6, v38, v39
    v_cmp_lt_f32 vcc, s30, v6
    v_mfma_f32_32x32x16_bf16 v[200:215], v[236:239], v[180:183], v[200:215]
    s_nop 1
    s_cbranch_vccnz slow_67
ret_68:
    ds_read_b64 v[240:241], v24 offset:3840
    ds_read_b64 v[242:243], v24 offset:3848
    ds_read_b64 v[244:245], v25 offset:3840
    v_mov_b32 v246, 0
    v_mov_b32 v247, 0
    ds_read_b128 v[248:251], v20 offset:8192
    ds_read_b128 v[252:255], v21 offset:8192
    v_exp_f32 v72, v72
    v_exp_f32 v73, v73
    v_exp_f32 v74, v74
    v_exp_f32 v75, v75
    v_exp_f32 v76, v76
    v_exp_f32 v77, v77
    s_waitcnt lgkmcnt(3)
    v_mfma_f32_32x32x16_bf16 v[104:119], v[240:243], v[40:43], v[136:151]
    v_exp_f32 v78, v78
    v_exp_f32 v79, v79
    v_exp_f32 v80, v80
    v_exp_f32 v81, v81
    v_exp_f32 v82, v82
    v_exp_f32 v83, v83
    v_mfma_f32_32x32x16_bf16 v[120:135], v[240:243], v[48:51], v[152:167]
    v_exp_f32 v84, v84
    v_exp_f32 v85, v85
    v_exp_f32 v86, v86
    v_exp_f32 v87, v87
    v_cvt_pk_bf16_f32 v168, v72, v73
    v_cvt_pk_bf16_f32 v169, v74, v75
    s_waitcnt lgkmcnt(2)
    v_mfma_f32_32x32x16_bf16 v[104:119], v[244:247], v[44:47], v[104:119]
    v_cvt_pk_bf16_f32 v170, v76, v77
    v_cvt_pk_bf16_f32 v171, v78, v79
    v_cvt_pk_bf16_f32 v172, v80, v81
    v_cvt_pk_bf16_f32 v173, v82, v83
    v_cvt_pk_bf16_f32 v174, v84, v85
    v_cvt_pk_bf16_f32 v175, v86, v87
    v_mfma_f32_32x32x16_bf16 v[120:135], v[244:247], v[52:55], v[120:135]
    s_nop 1
    v_exp_f32 v88, v88
    v_exp_f32 v89, v89
    v_exp_f32 v90, v90
    v_exp_f32 v91, v91
    v_exp_f32 v92, v92
    v_exp_f32 v93, v93
    v_exp_f32 v94, v94
    v_exp_f32 v95, v95
    v_exp_f32 v96, v96
    v_exp_f32 v97, v97
    v_exp_f32 v98, v98
    v_exp_f32 v99, v99
    s_waitcnt lgkmcnt(1)
    v_mfma_f32_32x32x16_bf16 v[184:199], v[248:251], v[168:171], v[184:199]
    v_exp_f32 v100, v100
    v_exp_f32 v101, v101
    v_exp_f32 v102, v102
    v_exp_f32 v103, v103
    v_cvt_pk_bf16_f32 v176, v88, v89
    v_cvt_pk_bf16_f32 v177, v90, v91
    v_cvt_pk_bf16_f32 v178, v92, v93
    v_cvt_pk_bf16_f32 v179, v94, v95
    v_cvt_pk_bf16_f32 v180, v96, v97
    v_cvt_pk_bf16_f32 v181, v98, v99
    v_cvt_pk_bf16_f32 v182, v100, v101
    v_cvt_pk_bf16_f32 v183, v102, v103
    s_waitcnt lgkmcnt(0)
    v_mfma_f32_32x32x16_bf16 v[184:199], v[252:255], v[172:175], v[184:199]
    s_nop 1
    v_max_f32 v38, v104, v105
    v_max_f32 v39, v120, v121
    v_max3_f32 v38, v38, v106, v107
    v_max3_f32 v39, v39, v122, v123
    v_max3_f32 v38, v38, v108, v109
    v_max3_f32 v39, v39, v124, v125
    v_max3_f32 v38, v38, v110, v111
    v_max3_f32 v39, v39, v126, v127
    v_max3_f32 v38, v38, v112, v113
    v_mfma_f32_32x32x16_bf16 v[200:215], v[248:251], v[176:179], v[200:215]
    v_max3_f32 v39, v39, v128, v129
    v_max3_f32 v38, v38, v114, v115
    v_max3_f32 v39, v39, v130, v131
    v_max3_f32 v38, v38, v116, v117
    v_max3_f32 v39, v39, v132, v133
    v_max3_f32 v38, v38, v118, v119
    v_max3_f32 v39, v39, v134, v135
    v_max_f32 v6, v38, v39
    v_cmp_lt_f32 vcc, s30, v6
    v_mfma_f32_32x32x16_bf16 v[200:215], v[252:255], v[180:183], v[200:215]
    s_nop 1
    s_cbranch_vccnz slow_69
ret_70:
    ds_read_b128 v[232:235], v22 offset:8192
    ds_read_b128 v[236:239], v23 offset:8192
    v_exp_f32 v104, v104
    v_exp_f32 v105, v105
    v_exp_f32 v106, v106
    v_exp_f32 v107, v107
    v_exp_f32 v108, v108
    v_exp_f32 v109, v109
    v_exp_f32 v110, v110
    v_exp_f32 v111, v111
    v_exp_f32 v112, v112
    v_exp_f32 v113, v113
    v_exp_f32 v114, v114
    v_exp_f32 v115, v115
    v_exp_f32 v116, v116
    v_exp_f32 v117, v117
    v_exp_f32 v118, v118
    v_exp_f32 v119, v119
    v_cvt_pk_bf16_f32 v168, v104, v105
    v_cvt_pk_bf16_f32 v169, v106, v107
    v_cvt_pk_bf16_f32 v170, v108, v109
    v_cvt_pk_bf16_f32 v171, v110, v111
    v_cvt_pk_bf16_f32 v172, v112, v113
    v_cvt_pk_bf16_f32 v173, v114, v115
    v_cvt_pk_bf16_f32 v174, v116, v117
    v_cvt_pk_bf16_f32 v175, v118, v119
    s_nop 1
    v_exp_f32 v120, v120
    v_exp_f32 v121, v121
    v_exp_f32 v122, v122
    v_exp_f32 v123, v123
    v_exp_f32 v124, v124
    v_exp_f32 v125, v125
    v_exp_f32 v126, v126
    v_exp_f32 v127, v127
    v_exp_f32 v128, v128
    v_exp_f32 v129, v129
    v_exp_f32 v130, v130
    v_exp_f32 v131, v131
    s_waitcnt lgkmcnt(1)
    v_mfma_f32_32x32x16_bf16 v[184:199], v[232:235], v[168:171], v[184:199]
    v_exp_f32 v132, v132
    v_exp_f32 v133, v133
    v_exp_f32 v134, v134
    v_exp_f32 v135, v135
    v_cvt_pk_bf16_f32 v176, v120, v121
    v_cvt_pk_bf16_f32 v177, v122, v123
    v_cvt_pk_bf16_f32 v178, v124, v125
    v_cvt_pk_bf16_f32 v179, v126, v127
    v_cvt_pk_bf16_f32 v180, v128, v129
    v_cvt_pk_bf16_f32 v181, v130, v131
    v_cvt_pk_bf16_f32 v182, v132, v133
    v_cvt_pk_bf16_f32 v183, v134, v135
    s_waitcnt lgkmcnt(0)
    v_mfma_f32_32x32x16_bf16 v[184:199], v[236:239], v[172:175], v[184:199]
    s_nop 1
    v_mfma_f32_32x32x16_bf16 v[200:215], v[232:235], v[176:179], v[200:215]
    v_mfma_f32_32x32x16_bf16 v[200:215], v[236:239], v[180:183], v[200:215]
    s_nop 7
    s_nop 7
    v_mul_u32_u24 v5, 1280, v9
    s_mul_i32 s36, s20, 40
    s_add_u32 s36, s36, 76546048
    v_lshl_add_u32 v5, v8, 3, v5
    v_add_u32 v5, s36, v5
    v_mov_b32 v6, v192
    v_mov_b32 v7, v192
    s_nop 1
    v_permlane32_swap_b32 v6, v7
    v_rcp_f32 v7, v7
    s_nop 0
    v_mul_f32 v184, v184, v7
    v_mul_f32 v185, v185, v7
    v_mul_f32 v186, v186, v7
    v_mul_f32 v187, v187, v7
    v_mul_f32 v188, v188, v7
    v_mul_f32 v189, v189, v7
    v_mul_f32 v190, v190, v7
    v_mul_f32 v191, v191, v7
    v_mul_f32 v192, v192, v7
    v_mul_f32 v193, v193, v7
    v_mul_f32 v194, v194, v7
    v_mul_f32 v195, v195, v7
    v_cvt_pk_bf16_f32 v72, v184, v185
    v_cvt_pk_bf16_f32 v73, v186, v187
    buffer_store_dwordx2 v[72:73], v5, s[8:11], 0 offen offset:0
    v_cvt_pk_bf16_f32 v74, v188, v189
    v_cvt_pk_bf16_f32 v75, v190, v191
    buffer_store_dwordx2 v[74:75], v5, s[8:11], 0 offen offset:16
    v_cvt_pk_bf16_f32 v76, v192, v193
    v_cvt_pk_bf16_f32 v77, v194, v195
    s_mov_b32 exec_hi, 0
    buffer_store_dwordx2 v[76:77], v5, s[8:11], 0 offen offset:32
    s_mov_b32 exec_hi, -1
    v_add_u32 v5, 40960, v5
    v_mov_b32 v6, v208
    v_mov_b32 v7, v208
    s_nop 1
    v_permlane32_swap_b32 v6, v7
    v_rcp_f32 v7, v7
    s_nop 0
    v_mul_f32 v200, v200, v7
    v_mul_f32 v201, v201, v7
    v_mul_f32 v202, v202, v7
    v_mul_f32 v203, v203, v7
    v_mul_f32 v204, v204, v7
    v_mul_f32 v205, v205, v7
    v_mul_f32 v206, v206, v7
    v_mul_f32 v207, v207, v7
    v_mul_f32 v208, v208, v7
    v_mul_f32 v209, v209, v7
    v_mul_f32 v210, v210, v7
    v_mul_f32 v211, v211, v7
    v_cvt_pk_bf16_f32 v78, v200, v201
    v_cvt_pk_bf16_f32 v79, v202, v203
    buffer_store_dwordx2 v[78:79], v5, s[8:11], 0 offen offset:0
    v_cvt_pk_bf16_f32 v80, v204, v205
    v_cvt_pk_bf16_f32 v81, v206, v207
    buffer_store_dwordx2 v[80:81], v5, s[8:11], 0 offen offset:16
    v_cvt_pk_bf16_f32 v82, v208, v209
    v_cvt_pk_bf16_f32 v83, v210, v211
    s_mov_b32 exec_hi, 0
    buffer_store_dwordx2 v[82:83], v5, s[8:11], 0 offen offset:32
    s_mov_b32 exec_hi, -1
    s_endpgm
slow_55:
    s_nop 7
    s_nop 7
    v_mov_b32 v4, v38
    v_mov_b32 v5, v38
    s_nop 1
    v_permlane32_swap_b32 v4, v5
    v_max_f32 v4, v4, v5
    v_max_f32 v4, s31, v4
    v_max_f32 v5, 0, v4
    v_sub_f32 v5, 0, v5
    v_exp_f32 v5, v5
    v_sub_f32 v136, v136, v4
    v_sub_f32 v137, v137, v4
    v_sub_f32 v138, v138, v4
    v_sub_f32 v139, v139, v4
    v_sub_f32 v140, v140, v4
    v_sub_f32 v141, v141, v4
    v_sub_f32 v142, v142, v4
    v_sub_f32 v143, v143, v4
    v_sub_f32 v144, v144, v4
    v_sub_f32 v145, v145, v4
    v_sub_f32 v146, v146, v4
    v_sub_f32 v147, v147, v4
    v_sub_f32 v148, v148, v4
    v_sub_f32 v149, v149, v4
    v_sub_f32 v150, v150, v4
    v_sub_f32 v151, v151, v4
    v_sub_f32 v72, v72, v4
    v_sub_f32 v73, v73, v4
    v_sub_f32 v74, v74, v4
    v_sub_f32 v75, v75, v4
    v_sub_f32 v76, v76, v4
    v_sub_f32 v77, v77, v4
    v_sub_f32 v78, v78, v4
    v_sub_f32 v79, v79, v4
    v_sub_f32 v80, v80, v4
    v_sub_f32 v81, v81, v4
    v_sub_f32 v82, v82, v4
    v_sub_f32 v83, v83, v4
    v_sub_f32 v84, v84, v4
    v_sub_f32 v85, v85, v4
    v_sub_f32 v86, v86, v4
    v_sub_f32 v87, v87, v4
    v_mul_f32 v184, v184, v5
    v_mul_f32 v185, v185, v5
    v_mul_f32 v186, v186, v5
    v_mul_f32 v187, v187, v5
    v_mul_f32 v188, v188, v5
    v_mul_f32 v189, v189, v5
    v_mul_f32 v190, v190, v5
    v_mul_f32 v191, v191, v5
    v_mul_f32 v192, v192, v5
    v_mul_f32 v193, v193, v5
    v_mul_f32 v194, v194, v5
    v_mul_f32 v195, v195, v5
    v_mul_f32 v196, v196, v5
    v_mul_f32 v197, v197, v5
    v_mul_f32 v198, v198, v5
    v_mul_f32 v199, v199, v5
    v_mov_b32 v4, v39
    v_mov_b32 v5, v39
    s_nop 1
    v_permlane32_swap_b32 v4, v5
    v_max_f32 v4, v4, v5
    v_max_f32 v4, s31, v4
    v_max_f32 v5, 0, v4
    v_sub_f32 v5, 0, v5
    v_exp_f32 v5, v5
    v_sub_f32 v152, v152, v4
    v_sub_f32 v153, v153, v4
    v_sub_f32 v154, v154, v4
    v_sub_f32 v155, v155, v4
    v_sub_f32 v156, v156, v4
    v_sub_f32 v157, v157, v4
    v_sub_f32 v158, v158, v4
    v_sub_f32 v159, v159, v4
    v_sub_f32 v160, v160, v4
    v_sub_f32 v161, v161, v4
    v_sub_f32 v162, v162, v4
    v_sub_f32 v163, v163, v4
    v_sub_f32 v164, v164, v4
    v_sub_f32 v165, v165, v4
    v_sub_f32 v166, v166, v4
    v_sub_f32 v167, v167, v4
    v_sub_f32 v88, v88, v4
    v_sub_f32 v89, v89, v4
    v_sub_f32 v90, v90, v4
    v_sub_f32 v91, v91, v4
    v_sub_f32 v92, v92, v4
    v_sub_f32 v93, v93, v4
    v_sub_f32 v94, v94, v4
    v_sub_f32 v95, v95, v4
    v_sub_f32 v96, v96, v4
    v_sub_f32 v97, v97, v4
    v_sub_f32 v98, v98, v4
    v_sub_f32 v99, v99, v4
    v_sub_f32 v100, v100, v4
    v_sub_f32 v101, v101, v4
    v_sub_f32 v102, v102, v4
    v_sub_f32 v103, v103, v4
    v_mul_f32 v200, v200, v5
    v_mul_f32 v201, v201, v5
    v_mul_f32 v202, v202, v5
    v_mul_f32 v203, v203, v5
    v_mul_f32 v204, v204, v5
    v_mul_f32 v205, v205, v5
    v_mul_f32 v206, v206, v5
    v_mul_f32 v207, v207, v5
    v_mul_f32 v208, v208, v5
    v_mul_f32 v209, v209, v5
    v_mul_f32 v210, v210, v5
    v_mul_f32 v211, v211, v5
    v_mul_f32 v212, v212, v5
    v_mul_f32 v213, v213, v5
    v_mul_f32 v214, v214, v5
    v_mul_f32 v215, v215, v5
    s_mov_b32 s30, 8.0
    s_mov_b32 s31, 0
    s_branch ret_56
slow_57:
    s_nop 7
    s_nop 7
    v_mov_b32 v4, v38
    v_mov_b32 v5, v38
    s_nop 1
    v_permlane32_swap_b32 v4, v5
    v_max_f32 v4, v4, v5
    v_max_f32 v4, s31, v4
    v_max_f32 v5, 0, v4
    v_sub_f32 v5, 0, v5
    v_exp_f32 v5, v5
    v_sub_f32 v136, v136, v4
    v_sub_f32 v137, v137, v4
    v_sub_f32 v138, v138, v4
    v_sub_f32 v139, v139, v4
    v_sub_f32 v140, v140, v4
    v_sub_f32 v141, v141, v4
    v_sub_f32 v142, v142, v4
    v_sub_f32 v143, v143, v4
    v_sub_f32 v144, v144, v4
    v_sub_f32 v145, v145, v4
    v_sub_f32 v146, v146, v4
    v_sub_f32 v147, v147, v4
    v_sub_f32 v148, v148, v4
    v_sub_f32 v149, v149, v4
    v_sub_f32 v150, v150, v4
    v_sub_f32 v151, v151, v4
    v_sub_f32 v104, v104, v4
    v_sub_f32 v105, v105, v4
    v_sub_f32 v106, v106, v4
    v_sub_f32 v107, v107, v4
    v_sub_f32 v108, v108, v4
    v_sub_f32 v109, v109, v4
    v_sub_f32 v110, v110, v4
    v_sub_f32 v111, v111, v4
    v_sub_f32 v112, v112, v4
    v_sub_f32 v113, v113, v4
    v_sub_f32 v114, v114, v4
    v_sub_f32 v115, v115, v4
    v_sub_f32 v116, v116, v4
    v_sub_f32 v117, v117, v4
    v_sub_f32 v118, v118, v4
    v_sub_f32 v119, v119, v4
    v_mul_f32 v184, v184, v5
    v_mul_f32 v185, v185, v5
    v_mul_f32 v186, v186, v5
    v_mul_f32 v187, v187, v5
    v_mul_f32 v188, v188, v5
    v_mul_f32 v189, v189, v5
    v_mul_f32 v190, v190, v5
    v_mul_f32 v191, v191, v5
    v_mul_f32 v192, v192, v5
    v_mul_f32 v193, v193, v5
    v_mul_f32 v194, v194, v5
    v_mul_f32 v195, v195, v5
    v_mul_f32 v196, v196, v5
    v_mul_f32 v197, v197, v5
    v_mul_f32 v198, v198, v5
    v_mul_f32 v199, v199, v5
    v_mov_b32 v4, v39
    v_mov_b32 v5, v39
    s_nop 1
    v_permlane32_swap_b32 v4, v5
    v_max_f32 v4, v4, v5
    v_max_f32 v4, s31, v4
    v_max_f32 v5, 0, v4
    v_sub_f32 v5, 0, v5
    v_exp_f32 v5, v5
    v_sub_f32 v152, v152, v4
    v_sub_f32 v153, v153, v4
    v_sub_f32 v154, v154, v4
    v_sub_f32 v155, v155, v4
    v_sub_f32 v156, v156, v4
    v_sub_f32 v157, v157, v4
    v_sub_f32 v158, v158, v4
    v_sub_f32 v159, v159, v4
    v_sub_f32 v160, v160, v4
    v_sub_f32 v161, v161, v4
    v_sub_f32 v162, v162, v4
    v_sub_f32 v163, v163, v4
    v_sub_f32 v164, v164, v4
    v_sub_f32 v165, v165, v4
    v_sub_f32 v166, v166, v4
    v_sub_f32 v167, v167, v4
    v_sub_f32 v120, v120, v4
    v_sub_f32 v121, v121, v4
    v_sub_f32 v122, v122, v4
    v_sub_f32 v123, v123, v4
    v_sub_f32 v124, v124, v4
    v_sub_f32 v125, v125, v4
    v_sub_f32 v126, v126, v4
    v_sub_f32 v127, v127, v4
    v_sub_f32 v128, v128, v4
    v_sub_f32 v129, v129, v4
    v_sub_f32 v130, v130, v4
    v_sub_f32 v131, v131, v4
    v_sub_f32 v132, v132, v4
    v_sub_f32 v133, v133, v4
    v_sub_f32 v134, v134, v4
    v_sub_f32 v135, v135, v4
    v_mul_f32 v200, v200, v5
    v_mul_f32 v201, v201, v5
    v_mul_f32 v202, v202, v5
    v_mul_f32 v203, v203, v5
    v_mul_f32 v204, v204, v5
    v_mul_f32 v205, v205, v5
    v_mul_f32 v206, v206, v5
    v_mul_f32 v207, v207, v5
    v_mul_f32 v208, v208, v5
    v_mul_f32 v209, v209, v5
    v_mul_f32 v210, v210, v5
    v_mul_f32 v211, v211, v5
    v_mul_f32 v212, v212, v5
    v_mul_f32 v213, v213, v5
    v_mul_f32 v214, v214, v5
    v_mul_f32 v215, v215, v5
    s_mov_b32 s30, 8.0
    s_mov_b32 s31, 0
    s_branch ret_58
slow_59:
    s_nop 7
    s_nop 7
    v_mov_b32 v4, v38
    v_mov_b32 v5, v38
    s_nop 1
    v_permlane32_swap_b32 v4, v5
    v_max_f32 v4, v4, v5
    v_max_f32 v4, s31, v4
    v_max_f32 v5, 0, v4
    v_sub_f32 v5, 0, v5
    v_exp_f32 v5, v5
    v_sub_f32 v136, v136, v4
    v_sub_f32 v137, v137, v4
    v_sub_f32 v138, v138, v4
    v_sub_f32 v139, v139, v4
    v_sub_f32 v140, v140, v4
    v_sub_f32 v141, v141, v4
    v_sub_f32 v142, v142, v4
    v_sub_f32 v143, v143, v4
    v_sub_f32 v144, v144, v4
    v_sub_f32 v145, v145, v4
    v_sub_f32 v146, v146, v4
    v_sub_f32 v147, v147, v4
    v_sub_f32 v148, v148, v4
    v_sub_f32 v149, v149, v4
    v_sub_f32 v150, v150, v4
    v_sub_f32 v151, v151, v4
    v_sub_f32 v72, v72, v4
    v_sub_f32 v73, v73, v4
    v_sub_f32 v74, v74, v4
    v_sub_f32 v75, v75, v4
    v_sub_f32 v76, v76, v4
    v_sub_f32 v77, v77, v4
    v_sub_f32 v78, v78, v4
    v_sub_f32 v79, v79, v4
    v_sub_f32 v80, v80, v4
    v_sub_f32 v81, v81, v4
    v_sub_f32 v82, v82, v4
    v_sub_f32 v83, v83, v4
    v_sub_f32 v84, v84, v4
    v_sub_f32 v85, v85, v4
    v_sub_f32 v86, v86, v4
    v_sub_f32 v87, v87, v4
    v_mul_f32 v184, v184, v5
    v_mul_f32 v185, v185, v5
    v_mul_f32 v186, v186, v5
    v_mul_f32 v187, v187, v5
    v_mul_f32 v188, v188, v5
    v_mul_f32 v189, v189, v5
    v_mul_f32 v190, v190, v5
    v_mul_f32 v191, v191, v5
    v_mul_f32 v192, v192, v5
    v_mul_f32 v193, v193, v5
    v_mul_f32 v194, v194, v5
    v_mul_f32 v195, v195, v5
    v_mul_f32 v196, v196, v5
    v_mul_f32 v197, v197, v5
    v_mul_f32 v198, v198, v5
    v_mul_f32 v199, v199, v5
    v_mov_b32 v4, v39
    v_mov_b32 v5, v39
    s_nop 1
    v_permlane32_swap_b32 v4, v5
    v_max_f32 v4, v4, v5
    v_max_f32 v4, s31, v4
    v_max_f32 v5, 0, v4
    v_sub_f32 v5, 0, v5
    v_exp_f32 v5, v5
    v_sub_f32 v152, v152, v4
    v_sub_f32 v153, v153, v4
    v_sub_f32 v154, v154, v4
    v_sub_f32 v155, v155, v4
    v_sub_f32 v156, v156, v4
    v_sub_f32 v157, v157, v4
    v_sub_f32 v158, v158, v4
    v_sub_f32 v159, v159, v4
    v_sub_f32 v160, v160, v4
    v_sub_f32 v161, v161, v4
    v_sub_f32 v162, v162, v4
    v_sub_f32 v163, v163, v4
    v_sub_f32 v164, v164, v4
    v_sub_f32 v165, v165, v4
    v_sub_f32 v166, v166, v4
    v_sub_f32 v167, v167, v4
    v_sub_f32 v88, v88, v4
    v_sub_f32 v89, v89, v4
    v_sub_f32 v90, v90, v4
    v_sub_f32 v91, v91, v4
    v_sub_f32 v92, v92, v4
    v_sub_f32 v93, v93, v4
    v_sub_f32 v94, v94, v4
    v_sub_f32 v95, v95, v4
    v_sub_f32 v96, v96, v4
    v_sub_f32 v97, v97, v4
    v_sub_f32 v98, v98, v4
    v_sub_f32 v99, v99, v4
    v_sub_f32 v100, v100, v4
    v_sub_f32 v101, v101, v4
    v_sub_f32 v102, v102, v4
    v_sub_f32 v103, v103, v4
    v_mul_f32 v200, v200, v5
    v_mul_f32 v201, v201, v5
    v_mul_f32 v202, v202, v5
    v_mul_f32 v203, v203, v5
    v_mul_f32 v204, v204, v5
    v_mul_f32 v205, v205, v5
    v_mul_f32 v206, v206, v5
    v_mul_f32 v207, v207, v5
    v_mul_f32 v208, v208, v5
    v_mul_f32 v209, v209, v5
    v_mul_f32 v210, v210, v5
    v_mul_f32 v211, v211, v5
    v_mul_f32 v212, v212, v5
    v_mul_f32 v213, v213, v5
    v_mul_f32 v214, v214, v5
    v_mul_f32 v215, v215, v5
    s_mov_b32 s30, 8.0
    s_mov_b32 s31, 0
    s_branch ret_60
slow_61:
    s_nop 7
    s_nop 7
    v_mov_b32 v4, v38
    v_mov_b32 v5, v38
    s_nop 1
    v_permlane32_swap_b32 v4, v5
    v_max_f32 v4, v4, v5
    v_max_f32 v4, s31, v4
    v_max_f32 v5, 0, v4
    v_sub_f32 v5, 0, v5
    v_exp_f32 v5, v5
    v_sub_f32 v136, v136, v4
    v_sub_f32 v137, v137, v4
    v_sub_f32 v138, v138, v4
    v_sub_f32 v139, v139, v4
    v_sub_f32 v140, v140, v4
    v_sub_f32 v141, v141, v4
    v_sub_f32 v142, v142, v4
    v_sub_f32 v143, v143, v4
    v_sub_f32 v144, v144, v4
    v_sub_f32 v145, v145, v4
    v_sub_f32 v146, v146, v4
    v_sub_f32 v147, v147, v4
    v_sub_f32 v148, v148, v4
    v_sub_f32 v149, v149, v4
    v_sub_f32 v150, v150, v4
    v_sub_f32 v151, v151, v4
    v_sub_f32 v104, v104, v4
    v_sub_f32 v105, v105, v4
    v_sub_f32 v106, v106, v4
    v_sub_f32 v107, v107, v4
    v_sub_f32 v108, v108, v4
    v_sub_f32 v109, v109, v4
    v_sub_f32 v110, v110, v4
    v_sub_f32 v111, v111, v4
    v_sub_f32 v112, v112, v4
    v_sub_f32 v113, v113, v4
    v_sub_f32 v114, v114, v4
    v_sub_f32 v115, v115, v4
    v_sub_f32 v116, v116, v4
    v_sub_f32 v117, v117, v4
    v_sub_f32 v118, v118, v4
    v_sub_f32 v119, v119, v4
    v_mul_f32 v184, v184, v5
    v_mul_f32 v185, v185, v5
    v_mul_f32 v186, v186, v5
    v_mul_f32 v187, v187, v5
    v_mul_f32 v188, v188, v5
    v_mul_f32 v189, v189, v5
    v_mul_f32 v190, v190, v5
    v_mul_f32 v191, v191, v5
    v_mul_f32 v192, v192, v5
    v_mul_f32 v193, v193, v5
    v_mul_f32 v194, v194, v5
    v_mul_f32 v195, v195, v5
    v_mul_f32 v196, v196, v5
    v_mul_f32 v197, v197, v5
    v_mul_f32 v198, v198, v5
    v_mul_f32 v199, v199, v5
    v_mov_b32 v4, v39
    v_mov_b32 v5, v39
    s_nop 1
    v_permlane32_swap_b32 v4, v5
    v_max_f32 v4, v4, v5
    v_max_f32 v4, s31, v4
    v_max_f32 v5, 0, v4
    v_sub_f32 v5, 0, v5
    v_exp_f32 v5, v5
    v_sub_f32 v152, v152, v4
    v_sub_f32 v153, v153, v4
    v_sub_f32 v154, v154, v4
    v_sub_f32 v155, v155, v4
    v_sub_f32 v156, v156, v4
    v_sub_f32 v157, v157, v4
    v_sub_f32 v158, v158, v4
    v_sub_f32 v159, v159, v4
    v_sub_f32 v160, v160, v4
    v_sub_f32 v161, v161, v4
    v_sub_f32 v162, v162, v4
    v_sub_f32 v163, v163, v4
    v_sub_f32 v164, v164, v4
    v_sub_f32 v165, v165, v4
    v_sub_f32 v166, v166, v4
    v_sub_f32 v167, v167, v4
    v_sub_f32 v120, v120, v4
    v_sub_f32 v121, v121, v4
    v_sub_f32 v122, v122, v4
    v_sub_f32 v123, v123, v4
    v_sub_f32 v124, v124, v4
    v_sub_f32 v125, v125, v4
    v_sub_f32 v126, v126, v4
    v_sub_f32 v127, v127, v4
    v_sub_f32 v128, v128, v4
    v_sub_f32 v129, v129, v4
    v_sub_f32 v130, v130, v4
    v_sub_f32 v131, v131, v4
    v_sub_f32 v132, v132, v4
    v_sub_f32 v133, v133, v4
    v_sub_f32 v134, v134, v4
    v_sub_f32 v135, v135, v4
    v_mul_f32 v200, v200, v5
    v_mul_f32 v201, v201, v5
    v_mul_f32 v202, v202, v5
    v_mul_f32 v203, v203, v5
    v_mul_f32 v204, v204, v5
    v_mul_f32 v205, v205, v5
    v_mul_f32 v206, v206, v5
    v_mul_f32 v207, v207, v5
    v_mul_f32 v208, v208, v5
    v_mul_f32 v209, v209, v5
    v_mul_f32 v210, v210, v5
    v_mul_f32 v211, v211, v5
    v_mul_f32 v212, v212, v5
    v_mul_f32 v213, v213, v5
    v_mul_f32 v214, v214, v5
    v_mul_f32 v215, v215, v5
    s_mov_b32 s30, 8.0
    s_mov_b32 s31, 0
    s_branch ret_62
slow_63:
    s_nop 7
    s_nop 7
    v_mov_b32 v4, v38
    v_mov_b32 v5, v38
    s_nop 1
    v_permlane32_swap_b32 v4, v5
    v_max_f32 v4, v4, v5
    v_max_f32 v4, s31, v4
    v_max_f32 v5, 0, v4
    v_sub_f32 v5, 0, v5
    v_exp_f32 v5, v5
    v_sub_f32 v136, v136, v4
    v_sub_f32 v137, v137, v4
    v_sub_f32 v138, v138, v4
    v_sub_f32 v139, v139, v4
    v_sub_f32 v140, v140, v4
    v_sub_f32 v141, v141, v4
    v_sub_f32 v142, v142, v4
    v_sub_f32 v143, v143, v4
    v_sub_f32 v144, v144, v4
    v_sub_f32 v145, v145, v4
    v_sub_f32 v146, v146, v4
    v_sub_f32 v147, v147, v4
    v_sub_f32 v148, v148, v4
    v_sub_f32 v149, v149, v4
    v_sub_f32 v150, v150, v4
    v_sub_f32 v151, v151, v4
    v_sub_f32 v72, v72, v4
    v_sub_f32 v73, v73, v4
    v_sub_f32 v74, v74, v4
    v_sub_f32 v75, v75, v4
    v_sub_f32 v76, v76, v4
    v_sub_f32 v77, v77, v4
    v_sub_f32 v78, v78, v4
    v_sub_f32 v79, v79, v4
    v_sub_f32 v80, v80, v4
    v_sub_f32 v81, v81, v4
    v_sub_f32 v82, v82, v4
    v_sub_f32 v83, v83, v4
    v_sub_f32 v84, v84, v4
    v_sub_f32 v85, v85, v4
    v_sub_f32 v86, v86, v4
    v_sub_f32 v87, v87, v4
    v_mul_f32 v184, v184, v5
    v_mul_f32 v185, v185, v5
    v_mul_f32 v186, v186, v5
    v_mul_f32 v187, v187, v5
    v_mul_f32 v188, v188, v5
    v_mul_f32 v189, v189, v5
    v_mul_f32 v190, v190, v5
    v_mul_f32 v191, v191, v5
    v_mul_f32 v192, v192, v5
    v_mul_f32 v193, v193, v5
    v_mul_f32 v194, v194, v5
    v_mul_f32 v195, v195, v5
    v_mul_f32 v196, v196, v5
    v_mul_f32 v197, v197, v5
    v_mul_f32 v198, v198, v5
    v_mul_f32 v199, v199, v5
    v_mov_b32 v4, v39
    v_mov_b32 v5, v39
    s_nop 1
    v_permlane32_swap_b32 v4, v5
    v_max_f32 v4, v4, v5
    v_max_f32 v4, s31, v4
    v_max_f32 v5, 0, v4
    v_sub_f32 v5, 0, v5
    v_exp_f32 v5, v5
    v_sub_f32 v152, v152, v4
    v_sub_f32 v153, v153, v4
    v_sub_f32 v154, v154, v4
    v_sub_f32 v155, v155, v4
    v_sub_f32 v156, v156, v4
    v_sub_f32 v157, v157, v4
    v_sub_f32 v158, v158, v4
    v_sub_f32 v159, v159, v4
    v_sub_f32 v160, v160, v4
    v_sub_f32 v161, v161, v4
    v_sub_f32 v162, v162, v4
    v_sub_f32 v163, v163, v4
    v_sub_f32 v164, v164, v4
    v_sub_f32 v165, v165, v4
    v_sub_f32 v166, v166, v4
    v_sub_f32 v167, v167, v4
    v_sub_f32 v88, v88, v4
    v_sub_f32 v89, v89, v4
    v_sub_f32 v90, v90, v4
    v_sub_f32 v91, v91, v4
    v_sub_f32 v92, v92, v4
    v_sub_f32 v93, v93, v4
    v_sub_f32 v94, v94, v4
    v_sub_f32 v95, v95, v4
    v_sub_f32 v96, v96, v4
    v_sub_f32 v97, v97, v4
    v_sub_f32 v98, v98, v4
    v_sub_f32 v99, v99, v4
    v_sub_f32 v100, v100, v4
    v_sub_f32 v101, v101, v4
    v_sub_f32 v102, v102, v4
    v_sub_f32 v103, v103, v4
    v_mul_f32 v200, v200, v5
    v_mul_f32 v201, v201, v5
    v_mul_f32 v202, v202, v5
    v_mul_f32 v203, v203, v5
    v_mul_f32 v204, v204, v5
    v_mul_f32 v205, v205, v5
    v_mul_f32 v206, v206, v5
    v_mul_f32 v207, v207, v5
    v_mul_f32 v208, v208, v5
    v_mul_f32 v209, v209, v5
    v_mul_f32 v210, v210, v5
    v_mul_f32 v211, v211, v5
    v_mul_f32 v212, v212, v5
    v_mul_f32 v213, v213, v5
    v_mul_f32 v214, v214, v5
    v_mul_f32 v215, v215, v5
    s_mov_b32 s30, 8.0
    s_mov_b32 s31, 0
    s_branch ret_64
slow_65:
    s_nop 7
    s_nop 7
    v_mov_b32 v4, v38
    v_mov_b32 v5, v38
    s_nop 1
    v_permlane32_swap_b32 v4, v5
    v_max_f32 v4, v4, v5
    v_max_f32 v4, s31, v4
    v_max_f32 v5, 0, v4
    v_sub_f32 v5, 0, v5
    v_exp_f32 v5, v5
    v_sub_f32 v136, v136, v4
    v_sub_f32 v137, v137, v4
    v_sub_f32 v138, v138, v4
    v_sub_f32 v139, v139, v4
    v_sub_f32 v140, v140, v4
    v_sub_f32 v141, v141, v4
    v_sub_f32 v142, v142, v4
    v_sub_f32 v143, v143, v4
    v_sub_f32 v144, v144, v4
    v_sub_f32 v145, v145, v4
    v_sub_f32 v146, v146, v4
    v_sub_f32 v147, v147, v4
    v_sub_f32 v148, v148, v4
    v_sub_f32 v149, v149, v4
    v_sub_f32 v150, v150, v4
    v_sub_f32 v151, v151, v4
    v_sub_f32 v104, v104, v4
    v_sub_f32 v105, v105, v4
    v_sub_f32 v106, v106, v4
    v_sub_f32 v107, v107, v4
    v_sub_f32 v108, v108, v4
    v_sub_f32 v109, v109, v4
    v_sub_f32 v110, v110, v4
    v_sub_f32 v111, v111, v4
    v_sub_f32 v112, v112, v4
    v_sub_f32 v113, v113, v4
    v_sub_f32 v114, v114, v4
    v_sub_f32 v115, v115, v4
    v_sub_f32 v116, v116, v4
    v_sub_f32 v117, v117, v4
    v_sub_f32 v118, v118, v4
    v_sub_f32 v119, v119, v4
    v_mul_f32 v184, v184, v5
    v_mul_f32 v185, v185, v5
    v_mul_f32 v186, v186, v5
    v_mul_f32 v187, v187, v5
    v_mul_f32 v188, v188, v5
    v_mul_f32 v189, v189, v5
    v_mul_f32 v190, v190, v5
    v_mul_f32 v191, v191, v5
    v_mul_f32 v192, v192, v5
    v_mul_f32 v193, v193, v5
    v_mul_f32 v194, v194, v5
    v_mul_f32 v195, v195, v5
    v_mul_f32 v196, v196, v5
    v_mul_f32 v197, v197, v5
    v_mul_f32 v198, v198, v5
    v_mul_f32 v199, v199, v5
    v_mov_b32 v4, v39
    v_mov_b32 v5, v39
    s_nop 1
    v_permlane32_swap_b32 v4, v5
    v_max_f32 v4, v4, v5
    v_max_f32 v4, s31, v4
    v_max_f32 v5, 0, v4
    v_sub_f32 v5, 0, v5
    v_exp_f32 v5, v5
    v_sub_f32 v152, v152, v4
    v_sub_f32 v153, v153, v4
    v_sub_f32 v154, v154, v4
    v_sub_f32 v155, v155, v4
    v_sub_f32 v156, v156, v4
    v_sub_f32 v157, v157, v4
    v_sub_f32 v158, v158, v4
    v_sub_f32 v159, v159, v4
    v_sub_f32 v160, v160, v4
    v_sub_f32 v161, v161, v4
    v_sub_f32 v162, v162, v4
    v_sub_f32 v163, v163, v4
    v_sub_f32 v164, v164, v4
    v_sub_f32 v165, v165, v4
    v_sub_f32 v166, v166, v4
    v_sub_f32 v167, v167, v4
    v_sub_f32 v120, v120, v4
    v_sub_f32 v121, v121, v4
    v_sub_f32 v122, v122, v4
    v_sub_f32 v123, v123, v4
    v_sub_f32 v124, v124, v4
    v_sub_f32 v125, v125, v4
    v_sub_f32 v126, v126, v4
    v_sub_f32 v127, v127, v4
    v_sub_f32 v128, v128, v4
    v_sub_f32 v129, v129, v4
    v_sub_f32 v130, v130, v4
    v_sub_f32 v131, v131, v4
    v_sub_f32 v132, v132, v4
    v_sub_f32 v133, v133, v4
    v_sub_f32 v134, v134, v4
    v_sub_f32 v135, v135, v4
    v_mul_f32 v200, v200, v5
    v_mul_f32 v201, v201, v5
    v_mul_f32 v202, v202, v5
    v_mul_f32 v203, v203, v5
    v_mul_f32 v204, v204, v5
    v_mul_f32 v205, v205, v5
    v_mul_f32 v206, v206, v5
    v_mul_f32 v207, v207, v5
    v_mul_f32 v208, v208, v5
    v_mul_f32 v209, v209, v5
    v_mul_f32 v210, v210, v5
    v_mul_f32 v211, v211, v5
    v_mul_f32 v212, v212, v5
    v_mul_f32 v213, v213, v5
    v_mul_f32 v214, v214, v5
    v_mul_f32 v215, v215, v5
    s_mov_b32 s30, 8.0
    s_mov_b32 s31, 0
    s_branch ret_66
slow_67:
    s_nop 7
    s_nop 7
    v_mov_b32 v4, v38
    v_mov_b32 v5, v38
    s_nop 1
    v_permlane32_swap_b32 v4, v5
    v_max_f32 v4, v4, v5
    v_max_f32 v4, s31, v4
    v_max_f32 v5, 0, v4
    v_sub_f32 v5, 0, v5
    v_exp_f32 v5, v5
    v_sub_f32 v136, v136, v4
    v_sub_f32 v137, v137, v4
    v_sub_f32 v138, v138, v4
    v_sub_f32 v139, v139, v4
    v_sub_f32 v140, v140, v4
    v_sub_f32 v141, v141, v4
    v_sub_f32 v142, v142, v4
    v_sub_f32 v143, v143, v4
    v_sub_f32 v144, v144, v4
    v_sub_f32 v145, v145, v4
    v_sub_f32 v146, v146, v4
    v_sub_f32 v147, v147, v4
    v_sub_f32 v148, v148, v4
    v_sub_f32 v149, v149, v4
    v_sub_f32 v150, v150, v4
    v_sub_f32 v151, v151, v4
    v_sub_f32 v72, v72, v4
    v_sub_f32 v73, v73, v4
    v_sub_f32 v74, v74, v4
    v_sub_f32 v75, v75, v4
    v_sub_f32 v76, v76, v4
    v_sub_f32 v77, v77, v4
    v_sub_f32 v78, v78, v4
    v_sub_f32 v79, v79, v4
    v_sub_f32 v80, v80, v4
    v_sub_f32 v81, v81, v4
    v_sub_f32 v82, v82, v4
    v_sub_f32 v83, v83, v4
    v_sub_f32 v84, v84, v4
    v_sub_f32 v85, v85, v4
    v_sub_f32 v86, v86, v4
    v_sub_f32 v87, v87, v4
    v_mul_f32 v184, v184, v5
    v_mul_f32 v185, v185, v5
    v_mul_f32 v186, v186, v5
    v_mul_f32 v187, v187, v5
    v_mul_f32 v188, v188, v5
    v_mul_f32 v189, v189, v5
    v_mul_f32 v190, v190, v5
    v_mul_f32 v191, v191, v5
    v_mul_f32 v192, v192, v5
    v_mul_f32 v193, v193, v5
    v_mul_f32 v194, v194, v5
    v_mul_f32 v195, v195, v5
    v_mul_f32 v196, v196, v5
    v_mul_f32 v197, v197, v5
    v_mul_f32 v198, v198, v5
    v_mul_f32 v199, v199, v5
    v_mov_b32 v4, v39
    v_mov_b32 v5, v39
    s_nop 1
    v_permlane32_swap_b32 v4, v5
    v_max_f32 v4, v4, v5
    v_max_f32 v4, s31, v4
    v_max_f32 v5, 0, v4
    v_sub_f32 v5, 0, v5
    v_exp_f32 v5, v5
    v_sub_f32 v152, v152, v4
    v_sub_f32 v153, v153, v4
    v_sub_f32 v154, v154, v4
    v_sub_f32 v155, v155, v4
    v_sub_f32 v156, v156, v4
    v_sub_f32 v157, v157, v4
    v_sub_f32 v158, v158, v4
    v_sub_f32 v159, v159, v4
    v_sub_f32 v160, v160, v4
    v_sub_f32 v161, v161, v4
    v_sub_f32 v162, v162, v4
    v_sub_f32 v163, v163, v4
    v_sub_f32 v164, v164, v4
    v_sub_f32 v165, v165, v4
    v_sub_f32 v166, v166, v4
    v_sub_f32 v167, v167, v4
    v_sub_f32 v88, v88, v4
    v_sub_f32 v89, v89, v4
    v_sub_f32 v90, v90, v4
    v_sub_f32 v91, v91, v4
    v_sub_f32 v92, v92, v4
    v_sub_f32 v93, v93, v4
    v_sub_f32 v94, v94, v4
    v_sub_f32 v95, v95, v4
    v_sub_f32 v96, v96, v4
    v_sub_f32 v97, v97, v4
    v_sub_f32 v98, v98, v4
    v_sub_f32 v99, v99, v4
    v_sub_f32 v100, v100, v4
    v_sub_f32 v101, v101, v4
    v_sub_f32 v102, v102, v4
    v_sub_f32 v103, v103, v4
    v_mul_f32 v200, v200, v5
    v_mul_f32 v201, v201, v5
    v_mul_f32 v202, v202, v5
    v_mul_f32 v203, v203, v5
    v_mul_f32 v204, v204, v5
    v_mul_f32 v205, v205, v5
    v_mul_f32 v206, v206, v5
    v_mul_f32 v207, v207, v5
    v_mul_f32 v208, v208, v5
    v_mul_f32 v209, v209, v5
    v_mul_f32 v210, v210, v5
    v_mul_f32 v211, v211, v5
    v_mul_f32 v212, v212, v5
    v_mul_f32 v213, v213, v5
    v_mul_f32 v214, v214, v5
    v_mul_f32 v215, v215, v5
    s_mov_b32 s30, 8.0
    s_mov_b32 s31, 0
    s_branch ret_68
slow_69:
    s_nop 7
    s_nop 7
    v_mov_b32 v4, v38
    v_mov_b32 v5, v38
    s_nop 1
    v_permlane32_swap_b32 v4, v5
    v_max_f32 v4, v4, v5
    v_max_f32 v4, s31, v4
    v_max_f32 v5, 0, v4
    v_sub_f32 v5, 0, v5
    v_exp_f32 v5, v5
    v_sub_f32 v136, v136, v4
    v_sub_f32 v137, v137, v4
    v_sub_f32 v138, v138, v4
    v_sub_f32 v139, v139, v4
    v_sub_f32 v140, v140, v4
    v_sub_f32 v141, v141, v4
    v_sub_f32 v142, v142, v4
    v_sub_f32 v143, v143, v4
    v_sub_f32 v144, v144, v4
    v_sub_f32 v145, v145, v4
    v_sub_f32 v146, v146, v4
    v_sub_f32 v147, v147, v4
    v_sub_f32 v148, v148, v4
    v_sub_f32 v149, v149, v4
    v_sub_f32 v150, v150, v4
    v_sub_f32 v151, v151, v4
    v_sub_f32 v104, v104, v4
    v_sub_f32 v105, v105, v4
    v_sub_f32 v106, v106, v4
    v_sub_f32 v107, v107, v4
    v_sub_f32 v108, v108, v4
    v_sub_f32 v109, v109, v4
    v_sub_f32 v110, v110, v4
    v_sub_f32 v111, v111, v4
    v_sub_f32 v112, v112, v4
    v_sub_f32 v113, v113, v4
    v_sub_f32 v114, v114, v4
    v_sub_f32 v115, v115, v4
    v_sub_f32 v116, v116, v4
    v_sub_f32 v117, v117, v4
    v_sub_f32 v118, v118, v4
    v_sub_f32 v119, v119, v4
    v_mul_f32 v184, v184, v5
    v_mul_f32 v185, v185, v5
    v_mul_f32 v186, v186, v5
    v_mul_f32 v187, v187, v5
    v_mul_f32 v188, v188, v5
    v_mul_f32 v189, v189, v5
    v_mul_f32 v190, v190, v5
    v_mul_f32 v191, v191, v5
    v_mul_f32 v192, v192, v5
    v_mul_f32 v193, v193, v5
    v_mul_f32 v194, v194, v5
    v_mul_f32 v195, v195, v5
    v_mul_f32 v196, v196, v5
    v_mul_f32 v197, v197, v5
    v_mul_f32 v198, v198, v5
    v_mul_f32 v199, v199, v5
    v_mov_b32 v4, v39
    v_mov_b32 v5, v39
    s_nop 1
    v_permlane32_swap_b32 v4, v5
    v_max_f32 v4, v4, v5
    v_max_f32 v4, s31, v4
    v_max_f32 v5, 0, v4
    v_sub_f32 v5, 0, v5
    v_exp_f32 v5, v5
    v_sub_f32 v152, v152, v4
    v_sub_f32 v153, v153, v4
    v_sub_f32 v154, v154, v4
    v_sub_f32 v155, v155, v4
    v_sub_f32 v156, v156, v4
    v_sub_f32 v157, v157, v4
    v_sub_f32 v158, v158, v4
    v_sub_f32 v159, v159, v4
    v_sub_f32 v160, v160, v4
    v_sub_f32 v161, v161, v4
    v_sub_f32 v162, v162, v4
    v_sub_f32 v163, v163, v4
    v_sub_f32 v164, v164, v4
    v_sub_f32 v165, v165, v4
    v_sub_f32 v166, v166, v4
    v_sub_f32 v167, v167, v4
    v_sub_f32 v120, v120, v4
    v_sub_f32 v121, v121, v4
    v_sub_f32 v122, v122, v4
    v_sub_f32 v123, v123, v4
    v_sub_f32 v124, v124, v4
    v_sub_f32 v125, v125, v4
    v_sub_f32 v126, v126, v4
    v_sub_f32 v127, v127, v4
    v_sub_f32 v128, v128, v4
    v_sub_f32 v129, v129, v4
    v_sub_f32 v130, v130, v4
    v_sub_f32 v131, v131, v4
    v_sub_f32 v132, v132, v4
    v_sub_f32 v133, v133, v4
    v_sub_f32 v134, v134, v4
    v_sub_f32 v135, v135, v4
    v_mul_f32 v200, v200, v5
    v_mul_f32 v201, v201, v5
    v_mul_f32 v202, v202, v5
    v_mul_f32 v203, v203, v5
    v_mul_f32 v204, v204, v5
    v_mul_f32 v205, v205, v5
    v_mul_f32 v206, v206, v5
    v_mul_f32 v207, v207, v5
    v_mul_f32 v208, v208, v5
    v_mul_f32 v209, v209, v5
    v_mul_f32 v210, v210, v5
    v_mul_f32 v211, v211, v5
    v_mul_f32 v212, v212, v5
    v_mul_f32 v213, v213, v5
    v_mul_f32 v214, v214, v5
    v_mul_f32 v215, v215, v5
    s_mov_b32 s30, 8.0
    s_mov_b32 s31, 0
    s_branch ret_70
at_end:
    s_endpgm
.globl oproj_kernel
.p2align 8
.type oproj_kernel,@function
oproj_kernel:
    s_cmp_ge_u32 s2, 200
    s_cbranch_scc1 k3_end
    s_load_dwordx2 s[42:43], s[0:1], 88
    s_mov_b32 s21, 1280
    s_mov_b32 s25, 81920
    s_mov_b32 s23, 0
    s_cmp_ge_u32 s2, 160
    s_cbranch_scc1 k3_p1
    s_load_dwordx2 s[6:7], s[0:1], 64
    s_bfe_u32 s44, s2, 0x20001
    s_and_b32 s36, s2, 1
    s_lshl_b32 s36, s36, 2
    s_bfe_u32 s37, s2, 0x20003
    s_add_u32 s30, s36, s37
    s_lshl_b32 s30, s30, 8
    s_lshr_b32 s31, s2, 5
    s_lshl_b32 s31, s31, 7
    s_mov_b32 s20, 8192
    s_mov_b32 s22, 16
    s_lshl_b32 s41, s44, 16
    s_add_u32 s41, s41, 50331648
    s_mul_i32 s24, s44, 1310720
    s_mul_i32 s33, s44, 5242880
    s_add_u32 s33, s33, 83886080
    s_lshl_b32 s45, s31, 7
    s_add_u32 s33, s33, s45
    s_waitcnt lgkmcnt(0)
    s_mov_b32 s8, s42
    s_and_b32 s9, s43, 0xffff
    s_mov_b32 s10, 268435456
    s_mov_b32 s11, 0x00020000
    s_mov_b32 s12, s6
    s_and_b32 s13, s7, 0xffff
    s_mov_b32 s14, 5242880
    s_mov_b32 s15, 0x00020000
    s_mov_b32 s16, s42
    s_and_b32 s17, s43, 0xffff
    s_mov_b32 s18, 268435456
    s_mov_b32 s19, 0x00020000
    v_and_b32 v1, 63, v0
    v_lshrrev_b32 v2, 6, v0
    s_nop 0
    v_readfirstlane_b32 s27, v2
    s_lshl_b32 s26, s27, 12
    s_lshr_b32 s28, s27, 1
    s_and_b32 s29, s27, 1
    s_lshl_b32 s34, s27, 11
    v_lshrrev_b32 v2, 3, v1
    v_and_b32 v3, 7, v1
    v_lshrrev_b32 v4, 4, v1
    v_and_b32 v5, 15, v1
    s_lshl_b32 s36, s27, 5
    s_add_u32 s36, s36, 0
    s_add_u32 s36, s36, s30
    v_add_u32 v6, s36, v2
    v_add_u32 v7, 0, v4
    v_xor_b32 v7, v7, v3
    v_lshrrev_b32 v9, 5, v6
    v_lshlrev_b32 v9, 18, v9
    v_and_b32 v6, 31, v6
    v_lshl_add_u32 v9, v6, 5, v9
    v_lshrrev_b32 v6, 1, v7
    v_lshl_add_u32 v9, v6, 10, v9
    v_and_b32 v7, 1, v7
    v_lshl_add_u32 v9, v7, 4, v9
    v_add_u32 v10, s41, v9
    s_lshl_b32 s36, s27, 5
    s_add_u32 s36, s36, 8
    s_add_u32 s36, s36, s30
    v_add_u32 v6, s36, v2
    v_add_u32 v7, 4, v4
    v_xor_b32 v7, v7, v3
    v_lshrrev_b32 v9, 5, v6
    v_lshlrev_b32 v9, 18, v9
    v_and_b32 v6, 31, v6
    v_lshl_add_u32 v9, v6, 5, v9
    v_lshrrev_b32 v6, 1, v7
    v_lshl_add_u32 v9, v6, 10, v9
    v_and_b32 v7, 1, v7
    v_lshl_add_u32 v9, v7, 4, v9
    v_add_u32 v11, s41, v9
    s_lshl_b32 s36, s27, 5
    s_add_u32 s36, s36, 16
    s_add_u32 s36, s36, s30
    v_add_u32 v6, s36, v2
    v_add_u32 v7, 0, v4
    v_xor_b32 v7, v7, v3
    v_lshrrev_b32 v9, 5, v6
    v_lshlrev_b32 v9, 18, v9
    v_and_b32 v6, 31, v6
    v_lshl_add_u32 v9, v6, 5, v9
    v_lshrrev_b32 v6, 1, v7
    v_lshl_add_u32 v9, v6, 10, v9
    v_and_b32 v7, 1, v7
    v_lshl_add_u32 v9, v7, 4, v9
    v_add_u32 v12, s41, v9
    s_lshl_b32 s36, s27, 5
    s_add_u32 s36, s36, 24
    s_add_u32 s36, s36, s30
    v_add_u32 v6, s36, v2
    v_add_u32 v7, 4, v4
    v_xor_b32 v7, v7, v3
    v_lshrrev_b32 v9, 5, v6
    v_lshlrev_b32 v9, 18, v9
    v_and_b32 v6, 31, v6
    v_lshl_add_u32 v9, v6, 5, v9
    v_lshrrev_b32 v6, 1, v7
    v_lshl_add_u32 v9, v6, 10, v9
    v_and_b32 v7, 1, v7
    v_lshl_add_u32 v9, v7, 4, v9
    v_add_u32 v13, s41, v9
    v_lshlrev_b32 v7, 2, v4
    v_xor_b32 v7, v7, v5
    v_lshlrev_b32 v7, 4, v7
    s_lshl_b32 s37, s31, 1
    s_lshl_b32 s36, s27, 3
    s_add_u32 s36, s36, 0
    v_add_u32 v6, s36, v4
    v_mul_lo_u32 v6, v6, s21
    v_add3_u32 v14, v6, v7, s37
    s_lshl_b32 s36, s27, 3
    s_add_u32 s36, s36, 4
    v_add_u32 v6, s36, v4
    v_mul_lo_u32 v6, v6, s21
    v_add3_u32 v15, v6, v7, s37
    s_add_u32 m0, s26, 0
    s_nop 0
    buffer_load_dwordx4 v10, s[8:11], s23 offen lds
    s_add_u32 m0, s26, 1024
    s_nop 0
    buffer_load_dwordx4 v11, s[8:11], s23 offen lds
    s_add_u32 m0, s26, 2048
    s_nop 0
    buffer_load_dwordx4 v12, s[8:11], s23 offen lds
    s_add_u32 m0, s26, 3072
    s_nop 0
    buffer_load_dwordx4 v13, s[8:11], s23 offen lds
    s_add_u32 m0, s34, 32768
    s_nop 0
    buffer_load_dwordx4 v14, s[12:15], s24 offen lds
    s_add_u32 m0, s34, 33792
    s_nop 0
    buffer_load_dwordx4 v15, s[12:15], s24 offen lds
    s_add_u32 s23, s23, 4096
    s_add_u32 s24, s24, s25
    s_add_u32 m0, s26, 49152
    s_nop 0
    buffer_load_dwordx4 v10, s[8:11], s23 offen lds
    s_add_u32 m0, s26, 50176
    s_nop 0
    buffer_load_dwordx4 v11, s[8:11], s23 offen lds
    s_add_u32 m0, s26, 51200
    s_nop 0
    buffer_load_dwordx4 v12, s[8:11], s23 offen lds
    s_add_u32 m0, s26, 52224
    s_nop 0
    buffer_load_dwordx4 v13, s[8:11], s23 offen lds
    s_add_u32 m0, s34, 81920
    s_nop 0
    buffer_load_dwordx4 v14, s[12:15], s24 offen lds
    s_add_u32 m0, s34, 82944
    s_nop 0
    buffer_load_dwordx4 v15, s[12:15], s24 offen lds
    s_add_u32 s23, s23, 4096
    s_add_u32 s24, s24, s25
    s_add_u32 m0, s26, 98304
    s_nop 0
    buffer_load_dwordx4 v10, s[8:11], s23 offen lds
    s_add_u32 m0, s26, 99328
    s_nop 0
    buffer_load_dwordx4 v11, s[8:11], s23 offen lds
    s_add_u32 m0, s26, 100352
    s_nop 0
    buffer_load_dwordx4 v12, s[8:11], s23 offen lds
    s_add_u32 m0, s26, 101376
    s_nop 0
    buffer_load_dwordx4 v13, s[8:11], s23 offen lds
    s_add_u32 m0, s34, 131072
    s_nop 0
    buffer_load_dwordx4 v14, s[12:15], s24 offen lds
    s_add_u32 m0, s34, 132096
    s_nop 0
    buffer_load_dwordx4 v15, s[12:15], s24 offen lds
    s_add_u32 s23, s23, 4096
    s_add_u32 s24, s24, s25
    v_and_b32 v6, 31, v1
    v_lshrrev_b32 v8, 5, v1
    v_bfe_u32 v7, v6, 1, 3
    v_xor_b32 v7, v7, v8
    v_lshlrev_b32 v6, 7, v6
    s_lshl_b32 s36, s28, 13
    v_add_u32 v6, s36, v6
    v_xor_b32 v9, 0, v7
    v_lshl_add_u32 v18, v9, 4, v6
    v_add_u32 v22, 49152, v18
    v_add_u32 v26, 98304, v18
    v_xor_b32 v9, 2, v7
    v_lshl_add_u32 v19, v9, 4, v6
    v_add_u32 v23, 49152, v19
    v_add_u32 v27, 98304, v19
    v_xor_b32 v9, 4, v7
    v_lshl_add_u32 v20, v9, 4, v6
    v_add_u32 v24, 49152, v20
    v_add_u32 v28, 98304, v20
    v_xor_b32 v9, 6, v7
    v_lshl_add_u32 v21, v9, 4, v6
    v_add_u32 v25, 49152, v21
    v_add_u32 v29, 98304, v21
    v_bfe_u32 v6, v1, 2, 2
    v_and_b32 v7, 3, v1
    v_bfe_u32 v9, v1, 4, 1
    v_lshlrev_b32 v40, 2, v8
    v_add_u32 v40, v40, v6
    v_lshlrev_b32 v40, 8, v40
    v_lshrrev_b32 v41, 1, v7
    v_lshl_add_u32 v41, v9, 1, v41
    s_and_b32 s36, s29, 1
    s_lshl_b32 s36, s36, 3
    v_add_u32 v41, s36, v41
    v_lshlrev_b32 v42, 2, v6
    v_xor_b32 v41, v41, v42
    v_and_b32 v7, 1, v7
    v_lshl_add_u32 v40, v7, 3, v40
    s_lshr_b32 s36, s29, 1
    s_lshl_b32 s36, s36, 14
    s_add_u32 s36, s36, 32768
    v_add_u32 v40, s36, v40
    v_xor_b32 v42, 0, v41
    v_lshl_add_u32 v30, v42, 4, v40
    v_add_u32 v32, 49152, v30
    v_add_u32 v34, 98304, v30
    v_xor_b32 v42, 4, v41
    v_lshl_add_u32 v31, v42, 4, v40
    v_add_u32 v33, 49152, v31
    v_add_u32 v35, 98304, v31
    v_mov_b32 v128, 0
    v_mov_b32 v129, 0
    v_mov_b32 v130, 0
    v_mov_b32 v131, 0
    v_mov_b32 v132, 0
    v_mov_b32 v133, 0
    v_mov_b32 v134, 0
    v_mov_b32 v135, 0
    v_mov_b32 v136, 0
    v_mov_b32 v137, 0
    v_mov_b32 v138, 0
    v_mov_b32 v139, 0
    v_mov_b32 v140, 0
    v_mov_b32 v141, 0
    v_mov_b32 v142, 0
    v_mov_b32 v143, 0
    v_mov_b32 v144, 0
    v_mov_b32 v145, 0
    v_mov_b32 v146, 0
    v_mov_b32 v147, 0
    v_mov_b32 v148, 0
    v_mov_b32 v149, 0
    v_mov_b32 v150, 0
    v_mov_b32 v151, 0
    v_mov_b32 v152, 0
    v_mov_b32 v153, 0
    v_mov_b32 v154, 0
    v_mov_b32 v155, 0
    v_mov_b32 v156, 0
    v_mov_b32 v157, 0
    v_mov_b32 v158, 0
    v_mov_b32 v159, 0
    v_mov_b32 v192, 0
    v_mov_b32 v193, 0
    v_mov_b32 v194, 0
    v_mov_b32 v195, 0
    v_mov_b32 v196, 0
    v_mov_b32 v197, 0
    v_mov_b32 v198, 0
    v_mov_b32 v199, 0
    v_mov_b32 v200, 0
    v_mov_b32 v201, 0
    v_mov_b32 v202, 0
    v_mov_b32 v203, 0
    v_mov_b32 v204, 0
    v_mov_b32 v205, 0
    v_mov_b32 v206, 0
    v_mov_b32 v207, 0
    v_mov_b32 v208, 0
    v_mov_b32 v209, 0
    v_mov_b32 v210, 0
    v_mov_b32 v211, 0
    v_mov_b32 v212, 0
    v_mov_b32 v213, 0
    v_mov_b32 v214, 0
    v_mov_b32 v215, 0
    v_mov_b32 v216, 0
    v_mov_b32 v217, 0
    v_mov_b32 v218, 0
    v_mov_b32 v219, 0
    v_mov_b32 v220, 0
    v_mov_b32 v221, 0
    v_mov_b32 v222, 0
    v_mov_b32 v223, 0
    s_mov_b64 vcc, 0
    s_waitcnt vmcnt(12)
    s_barrier
    ds_read_b64_tr_b16 v[80:81], v30 offset:0
    ds_read_b64_tr_b16 v[82:83], v30 offset:2048
    ds_read_b64_tr_b16 v[84:85], v31 offset:0
    ds_read_b64_tr_b16 v[86:87], v31 offset:2048
    ds_read_b128 v[64:67], v18 offset:0
    ds_read_b128 v[68:71], v18 offset:4096
gl_71:
    ds_read_b64_tr_b16 v[104:105], v30 offset:4096
    ds_read_b64_tr_b16 v[106:107], v30 offset:6144
    ds_read_b64_tr_b16 v[108:109], v31 offset:4096
    ds_read_b64_tr_b16 v[110:111], v31 offset:6144
    ds_read_b128 v[88:91], v19 offset:0
    ds_read_b128 v[92:95], v19 offset:4096
    s_waitcnt lgkmcnt(7)
    v_mfma_f32_32x32x16_bf16 v[128:143], v[80:83], v[64:67], v[128:143]
    v_mfma_f32_32x32x16_bf16 v[192:207], v[84:87], v[64:67], v[192:207]
    s_cbranch_vccz gn_73
    s_add_u32 m0, s26, 99328
    s_nop 0
    buffer_load_dwordx4 v11, s[8:11], s23 offen lds
gn_73:
    s_waitcnt lgkmcnt(6)
    v_mfma_f32_32x32x16_bf16 v[144:159], v[80:83], v[68:71], v[144:159]
    v_mfma_f32_32x32x16_bf16 v[208:223], v[84:87], v[68:71], v[208:223]
    s_cbranch_vccz gn_74
    s_add_u32 m0, s26, 100352
    s_nop 0
    buffer_load_dwordx4 v12, s[8:11], s23 offen lds
gn_74:
    ds_read_b64_tr_b16 v[80:81], v30 offset:8192
    ds_read_b64_tr_b16 v[82:83], v30 offset:10240
    ds_read_b64_tr_b16 v[84:85], v31 offset:8192
    ds_read_b64_tr_b16 v[86:87], v31 offset:10240
    ds_read_b128 v[64:67], v20 offset:0
    ds_read_b128 v[68:71], v20 offset:4096
    s_waitcnt lgkmcnt(7)
    v_mfma_f32_32x32x16_bf16 v[128:143], v[104:107], v[88:91], v[128:143]
    v_mfma_f32_32x32x16_bf16 v[192:207], v[108:111], v[88:91], v[192:207]
    s_cbranch_vccz gn_75
    s_add_u32 m0, s26, 101376
    s_nop 0
    buffer_load_dwordx4 v13, s[8:11], s23 offen lds
gn_75:
    s_waitcnt lgkmcnt(6)
    v_mfma_f32_32x32x16_bf16 v[144:159], v[104:107], v[92:95], v[144:159]
    v_mfma_f32_32x32x16_bf16 v[208:223], v[108:111], v[92:95], v[208:223]
    s_cbranch_vccz gn_76
    s_add_u32 m0, s34, 131072
    s_nop 0
    buffer_load_dwordx4 v14, s[12:15], s24 offen lds
gn_76:
    ds_read_b64_tr_b16 v[104:105], v30 offset:12288
    ds_read_b64_tr_b16 v[106:107], v30 offset:14336
    ds_read_b64_tr_b16 v[108:109], v31 offset:12288
    ds_read_b64_tr_b16 v[110:111], v31 offset:14336
    ds_read_b128 v[88:91], v21 offset:0
    ds_read_b128 v[92:95], v21 offset:4096
    s_waitcnt lgkmcnt(7)
    v_mfma_f32_32x32x16_bf16 v[128:143], v[80:83], v[64:67], v[128:143]
    v_mfma_f32_32x32x16_bf16 v[192:207], v[84:87], v[64:67], v[192:207]
    s_cbranch_vccz gn_77
    s_add_u32 m0, s34, 132096
    s_nop 0
    buffer_load_dwordx4 v15, s[12:15], s24 offen lds
    s_add_u32 s23, s23, 4096
    s_add_u32 s24, s24, s25
gn_77:
    s_waitcnt lgkmcnt(6)
    v_mfma_f32_32x32x16_bf16 v[144:159], v[80:83], v[68:71], v[144:159]
    v_mfma_f32_32x32x16_bf16 v[208:223], v[84:87], v[68:71], v[208:223]
    s_waitcnt lgkmcnt(1)
    v_mfma_f32_32x32x16_bf16 v[128:143], v[104:107], v[88:91], v[128:143]
    v_mfma_f32_32x32x16_bf16 v[192:207], v[108:111], v[88:91], v[192:207]
    s_cmp_le_u32 s22, 1
    s_waitcnt lgkmcnt(0)
    s_cbranch_scc1 ge_72
    s_cmp_gt_u32 s22, 2
    s_cbranch_scc1 gw_78
    s_waitcnt vmcnt(0)
gw_78:
    s_waitcnt vmcnt(6)
    s_cmp_gt_u32 s22, 3
    s_cselect_b64 vcc, -1, 0
    s_barrier
    ds_read_b64_tr_b16 v[80:81], v32 offset:0
    ds_read_b64_tr_b16 v[82:83], v32 offset:2048
    ds_read_b64_tr_b16 v[84:85], v33 offset:0
    ds_read_b64_tr_b16 v[86:87], v33 offset:2048
    ds_read_b128 v[64:67], v22 offset:0
    ds_read_b128 v[68:71], v22 offset:4096
    v_mfma_f32_32x32x16_bf16 v[144:159], v[104:107], v[92:95], v[144:159]
    v_mfma_f32_32x32x16_bf16 v[208:223], v[108:111], v[92:95], v[208:223]
    s_cbranch_vccz gn_79
    s_add_u32 m0, s26, 0
    s_nop 0
    buffer_load_dwordx4 v10, s[8:11], s23 offen lds
gn_79:
    s_sub_u32 s22, s22, 1
    ds_read_b64_tr_b16 v[104:105], v32 offset:4096
    ds_read_b64_tr_b16 v[106:107], v32 offset:6144
    ds_read_b64_tr_b16 v[108:109], v33 offset:4096
    ds_read_b64_tr_b16 v[110:111], v33 offset:6144
    ds_read_b128 v[88:91], v23 offset:0
    ds_read_b128 v[92:95], v23 offset:4096
    s_waitcnt lgkmcnt(7)
    v_mfma_f32_32x32x16_bf16 v[128:143], v[80:83], v[64:67], v[128:143]
    v_mfma_f32_32x32x16_bf16 v[192:207], v[84:87], v[64:67], v[192:207]
    s_cbranch_vccz gn_80
    s_add_u32 m0, s26, 1024
    s_nop 0
    buffer_load_dwordx4 v11, s[8:11], s23 offen lds
gn_80:
    s_waitcnt lgkmcnt(6)
    v_mfma_f32_32x32x16_bf16 v[144:159], v[80:83], v[68:71], v[144:159]
    v_mfma_f32_32x32x16_bf16 v[208:223], v[84:87], v[68:71], v[208:223]
    s_cbranch_vccz gn_81
    s_add_u32 m0, s26, 2048
    s_nop 0
    buffer_load_dwordx4 v12, s[8:11], s23 offen lds
gn_81:
    ds_read_b64_tr_b16 v[80:81], v32 offset:8192
    ds_read_b64_tr_b16 v[82:83], v32 offset:10240
    ds_read_b64_tr_b16 v[84:85], v33 offset:8192
    ds_read_b64_tr_b16 v[86:87], v33 offset:10240
    ds_read_b128 v[64:67], v24 offset:0
    ds_read_b128 v[68:71], v24 offset:4096
    s_waitcnt lgkmcnt(7)
    v_mfma_f32_32x32x16_bf16 v[128:143], v[104:107], v[88:91], v[128:143]
    v_mfma_f32_32x32x16_bf16 v[192:207], v[108:111], v[88:91], v[192:207]
    s_cbranch_vccz gn_82
    s_add_u32 m0, s26, 3072
    s_nop 0
    buffer_load_dwordx4 v13, s[8:11], s23 offen lds
gn_82:
    s_waitcnt lgkmcnt(6)
    v_mfma_f32_32x32x16_bf16 v[144:159], v[104:107], v[92:95], v[144:159]
    v_mfma_f32_32x32x16_bf16 v[208:223], v[108:111], v[92:95], v[208:223]
    s_cbranch_vccz gn_83
    s_add_u32 m0, s34, 32768
    s_nop 0
    buffer_load_dwordx4 v14, s[12:15], s24 offen lds
gn_83:
    ds_read_b64_tr_b16 v[104:105], v32 offset:12288
    ds_read_b64_tr_b16 v[106:107], v32 offset:14336
    ds_read_b64_tr_b16 v[108:109], v33 offset:12288
    ds_read_b64_tr_b16 v[110:111], v33 offset:14336
    ds_read_b128 v[88:91], v25 offset:0
    ds_read_b128 v[92:95], v25 offset:4096
    s_waitcnt lgkmcnt(7)
    v_mfma_f32_32x32x16_bf16 v[128:143], v[80:83], v[64:67], v[128:143]
    v_mfma_f32_32x32x16_bf16 v[192:207], v[84:87], v[64:67], v[192:207]
    s_cbranch_vccz gn_84
    s_add_u32 m0, s34, 33792
    s_nop 0
    buffer_load_dwordx4 v15, s[12:15], s24 offen lds
    s_add_u32 s23, s23, 4096
    s_add_u32 s24, s24, s25
gn_84:
    s_waitcnt lgkmcnt(6)
    v_mfma_f32_32x32x16_bf16 v[144:159], v[80:83], v[68:71], v[144:159]
    v_mfma_f32_32x32x16_bf16 v[208:223], v[84:87], v[68:71], v[208:223]
    s_waitcnt lgkmcnt(1)
    v_mfma_f32_32x32x16_bf16 v[128:143], v[104:107], v[88:91], v[128:143]
    v_mfma_f32_32x32x16_bf16 v[192:207], v[108:111], v[88:91], v[192:207]
    s_cmp_le_u32 s22, 1
    s_waitcnt lgkmcnt(0)
    s_cbranch_scc1 ge_72
    s_cmp_gt_u32 s22, 2
    s_cbranch_scc1 gw_85
    s_waitcnt vmcnt(0)
gw_85:
    s_waitcnt vmcnt(6)
    s_cmp_gt_u32 s22, 3
    s_cselect_b64 vcc, -1, 0
    s_barrier
    ds_read_b64_tr_b16 v[80:81], v34 offset:0
    ds_read_b64_tr_b16 v[82:83], v34 offset:2048
    ds_read_b64_tr_b16 v[84:85], v35 offset:0
    ds_read_b64_tr_b16 v[86:87], v35 offset:2048
    ds_read_b128 v[64:67], v26 offset:0
    ds_read_b128 v[68:71], v26 offset:4096
    v_mfma_f32_32x32x16_bf16 v[144:159], v[104:107], v[92:95], v[144:159]
    v_mfma_f32_32x32x16_bf16 v[208:223], v[108:111], v[92:95], v[208:223]
    s_cbranch_vccz gn_86
    s_add_u32 m0, s26, 49152
    s_nop 0
    buffer_load_dwordx4 v10, s[8:11], s23 offen lds
gn_86:
    s_sub_u32 s22, s22, 1
    ds_read_b64_tr_b16 v[104:105], v34 offset:4096
    ds_read_b64_tr_b16 v[106:107], v34 offset:6144
    ds_read_b64_tr_b16 v[108:109], v35 offset:4096
    ds_read_b64_tr_b16 v[110:111], v35 offset:6144
    ds_read_b128 v[88:91], v27 offset:0
    ds_read_b128 v[92:95], v27 offset:4096
    s_waitcnt lgkmcnt(7)
    v_mfma_f32_32x32x16_bf16 v[128:143], v[80:83], v[64:67], v[128:143]
    v_mfma_f32_32x32x16_bf16 v[192:207], v[84:87], v[64:67], v[192:207]
    s_cbranch_vccz gn_87
    s_add_u32 m0, s26, 50176
    s_nop 0
    buffer_load_dwordx4 v11, s[8:11], s23 offen lds
gn_87:
    s_waitcnt lgkmcnt(6)
    v_mfma_f32_32x32x16_bf16 v[144:159], v[80:83], v[68:71], v[144:159]
    v_mfma_f32_32x32x16_bf16 v[208:223], v[84:87], v[68:71], v[208:223]
    s_cbranch_vccz gn_88
    s_add_u32 m0, s26, 51200
    s_nop 0
    buffer_load_dwordx4 v12, s[8:11], s23 offen lds
gn_88:
    ds_read_b64_tr_b16 v[80:81], v34 offset:8192
    ds_read_b64_tr_b16 v[82:83], v34 offset:10240
    ds_read_b64_tr_b16 v[84:85], v35 offset:8192
    ds_read_b64_tr_b16 v[86:87], v35 offset:10240
    ds_read_b128 v[64:67], v28 offset:0
    ds_read_b128 v[68:71], v28 offset:4096
    s_waitcnt lgkmcnt(7)
    v_mfma_f32_32x32x16_bf16 v[128:143], v[104:107], v[88:91], v[128:143]
    v_mfma_f32_32x32x16_bf16 v[192:207], v[108:111], v[88:91], v[192:207]
    s_cbranch_vccz gn_89
    s_add_u32 m0, s26, 52224
    s_nop 0
    buffer_load_dwordx4 v13, s[8:11], s23 offen lds
gn_89:
    s_waitcnt lgkmcnt(6)
    v_mfma_f32_32x32x16_bf16 v[144:159], v[104:107], v[92:95], v[144:159]
    v_mfma_f32_32x32x16_bf16 v[208:223], v[108:111], v[92:95], v[208:223]
    s_cbranch_vccz gn_90
    s_add_u32 m0, s34, 81920
    s_nop 0
    buffer_load_dwordx4 v14, s[12:15], s24 offen lds
gn_90:
    ds_read_b64_tr_b16 v[104:105], v34 offset:12288
    ds_read_b64_tr_b16 v[106:107], v34 offset:14336
    ds_read_b64_tr_b16 v[108:109], v35 offset:12288
    ds_read_b64_tr_b16 v[110:111], v35 offset:14336
    ds_read_b128 v[88:91], v29 offset:0
    ds_read_b128 v[92:95], v29 offset:4096
    s_waitcnt lgkmcnt(7)
    v_mfma_f32_32x32x16_bf16 v[128:143], v[80:83], v[64:67], v[128:143]
    v_mfma_f32_32x32x16_bf16 v[192:207], v[84:87], v[64:67], v[192:207]
    s_cbranch_vccz gn_91
    s_add_u32 m0, s34, 82944
    s_nop 0
    buffer_load_dwordx4 v15, s[12:15], s24 offen lds
    s_add_u32 s23, s23, 4096
    s_add_u32 s24, s24, s25
gn_91:
    s_waitcnt lgkmcnt(6)
    v_mfma_f32_32x32x16_bf16 v[144:159], v[80:83], v[68:71], v[144:159]
    v_mfma_f32_32x32x16_bf16 v[208:223], v[84:87], v[68:71], v[208:223]
    s_waitcnt lgkmcnt(1)
    v_mfma_f32_32x32x16_bf16 v[128:143], v[104:107], v[88:91], v[128:143]
    v_mfma_f32_32x32x16_bf16 v[192:207], v[108:111], v[88:91], v[192:207]
    s_cmp_le_u32 s22, 1
    s_waitcnt lgkmcnt(0)
    s_cbranch_scc1 ge_72
    s_cmp_gt_u32 s22, 2
    s_cbranch_scc1 gw_92
    s_waitcnt vmcnt(0)
gw_92:
    s_waitcnt vmcnt(6)
    s_cmp_gt_u32 s22, 3
    s_cselect_b64 vcc, -1, 0
    s_barrier
    ds_read_b64_tr_b16 v[80:81], v30 offset:0
    ds_read_b64_tr_b16 v[82:83], v30 offset:2048
    ds_read_b64_tr_b16 v[84:85], v31 offset:0
    ds_read_b64_tr_b16 v[86:87], v31 offset:2048
    ds_read_b128 v[64:67], v18 offset:0
    ds_read_b128 v[68:71], v18 offset:4096
    v_mfma_f32_32x32x16_bf16 v[144:159], v[104:107], v[92:95], v[144:159]
    v_mfma_f32_32x32x16_bf16 v[208:223], v[108:111], v[92:95], v[208:223]
    s_cbranch_vccz gn_93
    s_add_u32 m0, s26, 98304
    s_nop 0
    buffer_load_dwordx4 v10, s[8:11], s23 offen lds
gn_93:
    s_sub_u32 s22, s22, 1
    s_branch gl_71
ge_72:
    v_mfma_f32_32x32x16_bf16 v[144:159], v[104:107], v[92:95], v[144:159]
    v_mfma_f32_32x32x16_bf16 v[208:223], v[108:111], v[92:95], v[208:223]
    s_nop 15
    v_and_b32 v2, 31, v1
    v_lshlrev_b32 v2, 5, v2
    v_lshl_add_u32 v2, v8, 4, v2
    s_lshl_b32 s36, s28, 6
    s_add_u32 s36, s36, s30
    s_mul_i32 s36, s36, 2560
    s_add_u32 s36, s36, s33
    s_lshl_b32 s37, s29, 13
    s_add_u32 s36, s36, s37
    v_add_u32 v2, s36, v2
    v_add_u32 v3, 4096, v2
    v_add_u32 v4, 81920, v2
    v_add_u32 v5, 86016, v2
    buffer_store_dwordx4 v[128:131], v2, s[16:19], 0 offen offset:0
    buffer_store_dwordx4 v[132:135], v2, s[16:19], 0 offen offset:1024
    buffer_store_dwordx4 v[136:139], v2, s[16:19], 0 offen offset:2048
    buffer_store_dwordx4 v[140:143], v2, s[16:19], 0 offen offset:3072
    buffer_store_dwordx4 v[192:195], v3, s[16:19], 0 offen offset:0
    buffer_store_dwordx4 v[196:199], v3, s[16:19], 0 offen offset:1024
    buffer_store_dwordx4 v[200:203], v3, s[16:19], 0 offen offset:2048
    buffer_store_dwordx4 v[204:207], v3, s[16:19], 0 offen offset:3072
    buffer_store_dwordx4 v[144:147], v4, s[16:19], 0 offen offset:0
    buffer_store_dwordx4 v[148:151], v4, s[16:19], 0 offen offset:1024
    buffer_store_dwordx4 v[152:155], v4, s[16:19], 0 offen offset:2048
    buffer_store_dwordx4 v[156:159], v4, s[16:19], 0 offen offset:3072
    buffer_store_dwordx4 v[208:211], v5, s[16:19], 0 offen offset:0
    buffer_store_dwordx4 v[212:215], v5, s[16:19], 0 offen offset:1024
    buffer_store_dwordx4 v[216:219], v5, s[16:19], 0 offen offset:2048
    buffer_store_dwordx4 v[220:223], v5, s[16:19], 0 offen offset:3072
    s_endpgm
k3_p1:
    s_load_dwordx2 s[6:7], s[0:1], 16
    s_load_dwordx2 s[4:5], s[0:1], 72
    s_sub_u32 s35, s2, 160
    s_and_b32 s30, s35, 7
    s_lshl_b32 s30, s30, 8
    s_lshr_b32 s31, s35, 3
    s_lshl_b32 s31, s31, 7
    s_mov_b32 s20, 1280
    s_mov_b32 s22, 10
    s_mov_b32 s41, 76546048
    s_mov_b32 s24, 0
    s_lshl_b32 s33, s31, 1
    s_waitcnt lgkmcnt(0)
    s_mov_b32 s8, s42
    s_and_b32 s9, s43, 0xffff
    s_mov_b32 s10, 268435456
    s_mov_b32 s11, 0x00020000
    s_mov_b32 s12, s6
    s_and_b32 s13, s7, 0xffff
    s_mov_b32 s14, 819200
    s_mov_b32 s15, 0x00020000
    s_mov_b32 s16, s4
    s_and_b32 s17, s5, 0xffff
    s_mov_b32 s18, 5242880
    s_mov_b32 s19, 0x00020000
    v_and_b32 v1, 63, v0
    v_lshrrev_b32 v2, 6, v0
    s_nop 0
    v_readfirstlane_b32 s27, v2
    s_lshl_b32 s26, s27, 12
    s_lshr_b32 s28, s27, 1
    s_and_b32 s29, s27, 1
    s_lshl_b32 s34, s27, 11
    v_lshrrev_b32 v2, 3, v1
    v_and_b32 v3, 7, v1
    v_lshrrev_b32 v4, 4, v1
    v_and_b32 v5, 15, v1
    s_lshl_b32 s36, s27, 5
    s_add_u32 s36, s36, 0
    s_add_u32 s36, s36, s30
    v_add_u32 v6, s36, v2
    v_add_u32 v7, 0, v4
    v_xor_b32 v7, v7, v3
    v_mul_lo_u32 v6, v6, s20
    v_lshlrev_b32 v7, 4, v7
    v_add3_u32 v10, v6, v7, s41
    s_lshl_b32 s36, s27, 5
    s_add_u32 s36, s36, 8
    s_add_u32 s36, s36, s30
    v_add_u32 v6, s36, v2
    v_add_u32 v7, 4, v4
    v_xor_b32 v7, v7, v3
    v_mul_lo_u32 v6, v6, s20
    v_lshlrev_b32 v7, 4, v7
    v_add3_u32 v11, v6, v7, s41
    s_lshl_b32 s36, s27, 5
    s_add_u32 s36, s36, 16
    s_add_u32 s36, s36, s30
    v_add_u32 v6, s36, v2
    v_add_u32 v7, 0, v4
    v_xor_b32 v7, v7, v3
    v_mul_lo_u32 v6, v6, s20
    v_lshlrev_b32 v7, 4, v7
    v_add3_u32 v12, v6, v7, s41
    s_lshl_b32 s36, s27, 5
    s_add_u32 s36, s36, 24
    s_add_u32 s36, s36, s30
    v_add_u32 v6, s36, v2
    v_add_u32 v7, 4, v4
    v_xor_b32 v7, v7, v3
    v_mul_lo_u32 v6, v6, s20
    v_lshlrev_b32 v7, 4, v7
    v_add3_u32 v13, v6, v7, s41
    v_lshlrev_b32 v7, 2, v4
    v_xor_b32 v7, v7, v5
    v_lshlrev_b32 v7, 4, v7
    s_lshl_b32 s37, s31, 1
    s_lshl_b32 s36, s27, 3
    s_add_u32 s36, s36, 0
    v_add_u32 v6, s36, v4
    v_mul_lo_u32 v6, v6, s21
    v_add3_u32 v14, v6, v7, s37
    s_lshl_b32 s36, s27, 3
    s_add_u32 s36, s36, 4
    v_add_u32 v6, s36, v4
    v_mul_lo_u32 v6, v6, s21
    v_add3_u32 v15, v6, v7, s37
    s_add_u32 m0, s26, 0
    s_nop 0
    buffer_load_dwordx4 v10, s[8:11], s23 offen lds
    s_add_u32 m0, s26, 1024
    s_nop 0
    buffer_load_dwordx4 v11, s[8:11], s23 offen lds
    s_add_u32 m0, s26, 2048
    s_nop 0
    buffer_load_dwordx4 v12, s[8:11], s23 offen lds
    s_add_u32 m0, s26, 3072
    s_nop 0
    buffer_load_dwordx4 v13, s[8:11], s23 offen lds
    s_add_u32 m0, s34, 32768
    s_nop 0
    buffer_load_dwordx4 v14, s[12:15], s24 offen lds
    s_add_u32 m0, s34, 33792
    s_nop 0
    buffer_load_dwordx4 v15, s[12:15], s24 offen lds
    s_add_u32 s23, s23, 128
    s_add_u32 s24, s24, s25
    s_add_u32 m0, s26, 49152
    s_nop 0
    buffer_load_dwordx4 v10, s[8:11], s23 offen lds
    s_add_u32 m0, s26, 50176
    s_nop 0
    buffer_load_dwordx4 v11, s[8:11], s23 offen lds
    s_add_u32 m0, s26, 51200
    s_nop 0
    buffer_load_dwordx4 v12, s[8:11], s23 offen lds
    s_add_u32 m0, s26, 52224
    s_nop 0
    buffer_load_dwordx4 v13, s[8:11], s23 offen lds
    s_add_u32 m0, s34, 81920
    s_nop 0
    buffer_load_dwordx4 v14, s[12:15], s24 offen lds
    s_add_u32 m0, s34, 82944
    s_nop 0
    buffer_load_dwordx4 v15, s[12:15], s24 offen lds
    s_add_u32 s23, s23, 128
    s_add_u32 s24, s24, s25
    s_add_u32 m0, s26, 98304
    s_nop 0
    buffer_load_dwordx4 v10, s[8:11], s23 offen lds
    s_add_u32 m0, s26, 99328
    s_nop 0
    buffer_load_dwordx4 v11, s[8:11], s23 offen lds
    s_add_u32 m0, s26, 100352
    s_nop 0
    buffer_load_dwordx4 v12, s[8:11], s23 offen lds
    s_add_u32 m0, s26, 101376
    s_nop 0
    buffer_load_dwordx4 v13, s[8:11], s23 offen lds
    s_add_u32 m0, s34, 131072
    s_nop 0
    buffer_load_dwordx4 v14, s[12:15], s24 offen lds
    s_add_u32 m0, s34, 132096
    s_nop 0
    buffer_load_dwordx4 v15, s[12:15], s24 offen lds
    s_add_u32 s23, s23, 128
    s_add_u32 s24, s24, s25
    v_and_b32 v6, 31, v1
    v_lshrrev_b32 v8, 5, v1
    v_bfe_u32 v7, v6, 1, 3
    v_xor_b32 v7, v7, v8
    v_lshlrev_b32 v6, 7, v6
    s_lshl_b32 s36, s28, 13
    v_add_u32 v6, s36, v6
    v_xor_b32 v9, 0, v7
    v_lshl_add_u32 v18, v9, 4, v6
    v_add_u32 v22, 49152, v18
    v_add_u32 v26, 98304, v18
    v_xor_b32 v9, 2, v7
    v_lshl_add_u32 v19, v9, 4, v6
    v_add_u32 v23, 49152, v19
    v_add_u32 v27, 98304, v19
    v_xor_b32 v9, 4, v7
    v_lshl_add_u32 v20, v9, 4, v6
    v_add_u32 v24, 49152, v20
    v_add_u32 v28, 98304, v20
    v_xor_b32 v9, 6, v7
    v_lshl_add_u32 v21, v9, 4, v6
    v_add_u32 v25, 49152, v21
    v_add_u32 v29, 98304, v21
    v_bfe_u32 v6, v1, 2, 2
    v_and_b32 v7, 3, v1
    v_bfe_u32 v9, v1, 4, 1
    v_lshlrev_b32 v40, 3, v8
    v_add_u32 v40, v40, v6
    v_lshlrev_b32 v40, 8, v40
    v_lshrrev_b32 v41, 1, v7
    v_lshl_add_u32 v41, v9, 1, v41
    s_and_b32 s36, s29, 1
    s_lshl_b32 s36, s36, 3
    v_add_u32 v41, s36, v41
    v_lshlrev_b32 v42, 2, v6
    v_xor_b32 v41, v41, v42
    v_and_b32 v7, 1, v7
    v_lshl_add_u32 v40, v7, 3, v40
    s_lshr_b32 s36, s29, 1
    s_lshl_b32 s36, s36, 14
    s_add_u32 s36, s36, 32768
    v_add_u32 v40, s36, v40
    v_xor_b32 v42, 0, v41
    v_lshl_add_u32 v30, v42, 4, v40
    v_add_u32 v32, 49152, v30
    v_add_u32 v34, 98304, v30
    v_xor_b32 v42, 4, v41
    v_lshl_add_u32 v31, v42, 4, v40
    v_add_u32 v33, 49152, v31
    v_add_u32 v35, 98304, v31
    v_mov_b32 v128, 0
    v_mov_b32 v129, 0
    v_mov_b32 v130, 0
    v_mov_b32 v131, 0
    v_mov_b32 v132, 0
    v_mov_b32 v133, 0
    v_mov_b32 v134, 0
    v_mov_b32 v135, 0
    v_mov_b32 v136, 0
    v_mov_b32 v137, 0
    v_mov_b32 v138, 0
    v_mov_b32 v139, 0
    v_mov_b32 v140, 0
    v_mov_b32 v141, 0
    v_mov_b32 v142, 0
    v_mov_b32 v143, 0
    v_mov_b32 v144, 0
    v_mov_b32 v145, 0
    v_mov_b32 v146, 0
    v_mov_b32 v147, 0
    v_mov_b32 v148, 0
    v_mov_b32 v149, 0
    v_mov_b32 v150, 0
    v_mov_b32 v151, 0
    v_mov_b32 v152, 0
    v_mov_b32 v153, 0
    v_mov_b32 v154, 0
    v_mov_b32 v155, 0
    v_mov_b32 v156, 0
    v_mov_b32 v157, 0
    v_mov_b32 v158, 0
    v_mov_b32 v159, 0
    v_mov_b32 v192, 0
    v_mov_b32 v193, 0
    v_mov_b32 v194, 0
    v_mov_b32 v195, 0
    v_mov_b32 v196, 0
    v_mov_b32 v197, 0
    v_mov_b32 v198, 0
    v_mov_b32 v199, 0
    v_mov_b32 v200, 0
    v_mov_b32 v201, 0
    v_mov_b32 v202, 0
    v_mov_b32 v203, 0
    v_mov_b32 v204, 0
    v_mov_b32 v205, 0
    v_mov_b32 v206, 0
    v_mov_b32 v207, 0
    v_mov_b32 v208, 0
    v_mov_b32 v209, 0
    v_mov_b32 v210, 0
    v_mov_b32 v211, 0
    v_mov_b32 v212, 0
    v_mov_b32 v213, 0
    v_mov_b32 v214, 0
    v_mov_b32 v215, 0
    v_mov_b32 v216, 0
    v_mov_b32 v217, 0
    v_mov_b32 v218, 0
    v_mov_b32 v219, 0
    v_mov_b32 v220, 0
    v_mov_b32 v221, 0
    v_mov_b32 v222, 0
    v_mov_b32 v223, 0
    s_mov_b64 vcc, 0
    s_waitcnt vmcnt(12)
    s_barrier
    ds_read_b64_tr_b16 v[80:81], v30 offset:0
    ds_read_b64_tr_b16 v[82:83], v30 offset:1024
    ds_read_b64_tr_b16 v[84:85], v31 offset:0
    ds_read_b64_tr_b16 v[86:87], v31 offset:1024
    ds_read_b128 v[64:67], v18 offset:0
    ds_read_b128 v[68:71], v18 offset:4096
gl_94:
    ds_read_b64_tr_b16 v[104:105], v30 offset:4096
    ds_read_b64_tr_b16 v[106:107], v30 offset:5120
    ds_read_b64_tr_b16 v[108:109], v31 offset:4096
    ds_read_b64_tr_b16 v[110:111], v31 offset:5120
    ds_read_b128 v[88:91], v19 offset:0
    ds_read_b128 v[92:95], v19 offset:4096
    s_waitcnt lgkmcnt(7)
    v_mfma_f32_32x32x16_bf16 v[128:143], v[80:83], v[64:67], v[128:143]
    v_mfma_f32_32x32x16_bf16 v[192:207], v[84:87], v[64:67], v[192:207]
    s_cbranch_vccz gn_96
    s_add_u32 m0, s26, 99328
    s_nop 0
    buffer_load_dwordx4 v11, s[8:11], s23 offen lds
gn_96:
    s_waitcnt lgkmcnt(6)
    v_mfma_f32_32x32x16_bf16 v[144:159], v[80:83], v[68:71], v[144:159]
    v_mfma_f32_32x32x16_bf16 v[208:223], v[84:87], v[68:71], v[208:223]
    s_cbranch_vccz gn_97
    s_add_u32 m0, s26, 100352
    s_nop 0
    buffer_load_dwordx4 v12, s[8:11], s23 offen lds
gn_97:
    ds_read_b64_tr_b16 v[80:81], v30 offset:8192
    ds_read_b64_tr_b16 v[82:83], v30 offset:9216
    ds_read_b64_tr_b16 v[84:85], v31 offset:8192
    ds_read_b64_tr_b16 v[86:87], v31 offset:9216
    ds_read_b128 v[64:67], v20 offset:0
    ds_read_b128 v[68:71], v20 offset:4096
    s_waitcnt lgkmcnt(7)
    v_mfma_f32_32x32x16_bf16 v[128:143], v[104:107], v[88:91], v[128:143]
    v_mfma_f32_32x32x16_bf16 v[192:207], v[108:111], v[88:91], v[192:207]
    s_cbranch_vccz gn_98
    s_add_u32 m0, s26, 101376
    s_nop 0
    buffer_load_dwordx4 v13, s[8:11], s23 offen lds
gn_98:
    s_waitcnt lgkmcnt(6)
    v_mfma_f32_32x32x16_bf16 v[144:159], v[104:107], v[92:95], v[144:159]
    v_mfma_f32_32x32x16_bf16 v[208:223], v[108:111], v[92:95], v[208:223]
    s_cbranch_vccz gn_99
    s_add_u32 m0, s34, 131072
    s_nop 0
    buffer_load_dwordx4 v14, s[12:15], s24 offen lds
gn_99:
    ds_read_b64_tr_b16 v[104:105], v30 offset:12288
    ds_read_b64_tr_b16 v[106:107], v30 offset:13312
    ds_read_b64_tr_b16 v[108:109], v31 offset:12288
    ds_read_b64_tr_b16 v[110:111], v31 offset:13312
    ds_read_b128 v[88:91], v21 offset:0
    ds_read_b128 v[92:95], v21 offset:4096
    s_waitcnt lgkmcnt(7)
    v_mfma_f32_32x32x16_bf16 v[128:143], v[80:83], v[64:67], v[128:143]
    v_mfma_f32_32x32x16_bf16 v[192:207], v[84:87], v[64:67], v[192:207]
    s_cbranch_vccz gn_100
    s_add_u32 m0, s34, 132096
    s_nop 0
    buffer_load_dwordx4 v15, s[12:15], s24 offen lds
    s_add_u32 s23, s23, 128
    s_add_u32 s24, s24, s25
gn_100:
    s_waitcnt lgkmcnt(6)
    v_mfma_f32_32x32x16_bf16 v[144:159], v[80:83], v[68:71], v[144:159]
    v_mfma_f32_32x32x16_bf16 v[208:223], v[84:87], v[68:71], v[208:223]
    s_waitcnt lgkmcnt(1)
    v_mfma_f32_32x32x16_bf16 v[128:143], v[104:107], v[88:91], v[128:143]
    v_mfma_f32_32x32x16_bf16 v[192:207], v[108:111], v[88:91], v[192:207]
    s_cmp_le_u32 s22, 1
    s_waitcnt lgkmcnt(0)
    s_cbranch_scc1 ge_95
    s_cmp_gt_u32 s22, 2
    s_cbranch_scc1 gw_101
    s_waitcnt vmcnt(0)
gw_101:
    s_waitcnt vmcnt(6)
    s_cmp_gt_u32 s22, 3
    s_cselect_b64 vcc, -1, 0
    s_barrier
    ds_read_b64_tr_b16 v[80:81], v32 offset:0
    ds_read_b64_tr_b16 v[82:83], v32 offset:1024
    ds_read_b64_tr_b16 v[84:85], v33 offset:0
    ds_read_b64_tr_b16 v[86:87], v33 offset:1024
    ds_read_b128 v[64:67], v22 offset:0
    ds_read_b128 v[68:71], v22 offset:4096
    v_mfma_f32_32x32x16_bf16 v[144:159], v[104:107], v[92:95], v[144:159]
    v_mfma_f32_32x32x16_bf16 v[208:223], v[108:111], v[92:95], v[208:223]
    s_cbranch_vccz gn_102
    s_add_u32 m0, s26, 0
    s_nop 0
    buffer_load_dwordx4 v10, s[8:11], s23 offen lds
gn_102:
    s_sub_u32 s22, s22, 1
    ds_read_b64_tr_b16 v[104:105], v32 offset:4096
    ds_read_b64_tr_b16 v[106:107], v32 offset:5120
    ds_read_b64_tr_b16 v[108:109], v33 offset:4096
    ds_read_b64_tr_b16 v[110:111], v33 offset:5120
    ds_read_b128 v[88:91], v23 offset:0
    ds_read_b128 v[92:95], v23 offset:4096
    s_waitcnt lgkmcnt(7)
    v_mfma_f32_32x32x16_bf16 v[128:143], v[80:83], v[64:67], v[128:143]
    v_mfma_f32_32x32x16_bf16 v[192:207], v[84:87], v[64:67], v[192:207]
    s_cbranch_vccz gn_103
    s_add_u32 m0, s26, 1024
    s_nop 0
    buffer_load_dwordx4 v11, s[8:11], s23 offen lds
gn_103:
    s_waitcnt lgkmcnt(6)
    v_mfma_f32_32x32x16_bf16 v[144:159], v[80:83], v[68:71], v[144:159]
    v_mfma_f32_32x32x16_bf16 v[208:223], v[84:87], v[68:71], v[208:223]
    s_cbranch_vccz gn_104
    s_add_u32 m0, s26, 2048
    s_nop 0
    buffer_load_dwordx4 v12, s[8:11], s23 offen lds
gn_104:
    ds_read_b64_tr_b16 v[80:81], v32 offset:8192
    ds_read_b64_tr_b16 v[82:83], v32 offset:9216
    ds_read_b64_tr_b16 v[84:85], v33 offset:8192
    ds_read_b64_tr_b16 v[86:87], v33 offset:9216
    ds_read_b128 v[64:67], v24 offset:0
    ds_read_b128 v[68:71], v24 offset:4096
    s_waitcnt lgkmcnt(7)
    v_mfma_f32_32x32x16_bf16 v[128:143], v[104:107], v[88:91], v[128:143]
    v_mfma_f32_32x32x16_bf16 v[192:207], v[108:111], v[88:91], v[192:207]
    s_cbranch_vccz gn_105
    s_add_u32 m0, s26, 3072
    s_nop 0
    buffer_load_dwordx4 v13, s[8:11], s23 offen lds
gn_105:
    s_waitcnt lgkmcnt(6)
    v_mfma_f32_32x32x16_bf16 v[144:159], v[104:107], v[92:95], v[144:159]
    v_mfma_f32_32x32x16_bf16 v[208:223], v[108:111], v[92:95], v[208:223]
    s_cbranch_vccz gn_106
    s_add_u32 m0, s34, 32768
    s_nop 0
    buffer_load_dwordx4 v14, s[12:15], s24 offen lds
gn_106:
    ds_read_b64_tr_b16 v[104:105], v32 offset:12288
    ds_read_b64_tr_b16 v[106:107], v32 offset:13312
    ds_read_b64_tr_b16 v[108:109], v33 offset:12288
    ds_read_b64_tr_b16 v[110:111], v33 offset:13312
    ds_read_b128 v[88:91], v25 offset:0
    ds_read_b128 v[92:95], v25 offset:4096
    s_waitcnt lgkmcnt(7)
    v_mfma_f32_32x32x16_bf16 v[128:143], v[80:83], v[64:67], v[128:143]
    v_mfma_f32_32x32x16_bf16 v[192:207], v[84:87], v[64:67], v[192:207]
    s_cbranch_vccz gn_107
    s_add_u32 m0, s34, 33792
    s_nop 0
    buffer_load_dwordx4 v15, s[12:15], s24 offen lds
    s_add_u32 s23, s23, 128
    s_add_u32 s24, s24, s25
gn_107:
    s_waitcnt lgkmcnt(6)
    v_mfma_f32_32x32x16_bf16 v[144:159], v[80:83], v[68:71], v[144:159]
    v_mfma_f32_32x32x16_bf16 v[208:223], v[84:87], v[68:71], v[208:223]
    s_waitcnt lgkmcnt(1)
    v_mfma_f32_32x32x16_bf16 v[128:143], v[104:107], v[88:91], v[128:143]
    v_mfma_f32_32x32x16_bf16 v[192:207], v[108:111], v[88:91], v[192:207]
    s_cmp_le_u32 s22, 1
    s_waitcnt lgkmcnt(0)
    s_cbranch_scc1 ge_95
    s_cmp_gt_u32 s22, 2
    s_cbranch_scc1 gw_108
    s_waitcnt vmcnt(0)
gw_108:
    s_waitcnt vmcnt(6)
    s_cmp_gt_u32 s22, 3
    s_cselect_b64 vcc, -1, 0
    s_barrier
    ds_read_b64_tr_b16 v[80:81], v34 offset:0
    ds_read_b64_tr_b16 v[82:83], v34 offset:1024
    ds_read_b64_tr_b16 v[84:85], v35 offset:0
    ds_read_b64_tr_b16 v[86:87], v35 offset:1024
    ds_read_b128 v[64:67], v26 offset:0
    ds_read_b128 v[68:71], v26 offset:4096
    v_mfma_f32_32x32x16_bf16 v[144:159], v[104:107], v[92:95], v[144:159]
    v_mfma_f32_32x32x16_bf16 v[208:223], v[108:111], v[92:95], v[208:223]
    s_cbranch_vccz gn_109
    s_add_u32 m0, s26, 49152
    s_nop 0
    buffer_load_dwordx4 v10, s[8:11], s23 offen lds
gn_109:
    s_sub_u32 s22, s22, 1
    ds_read_b64_tr_b16 v[104:105], v34 offset:4096
    ds_read_b64_tr_b16 v[106:107], v34 offset:5120
    ds_read_b64_tr_b16 v[108:109], v35 offset:4096
    ds_read_b64_tr_b16 v[110:111], v35 offset:5120
    ds_read_b128 v[88:91], v27 offset:0
    ds_read_b128 v[92:95], v27 offset:4096
    s_waitcnt lgkmcnt(7)
    v_mfma_f32_32x32x16_bf16 v[128:143], v[80:83], v[64:67], v[128:143]
    v_mfma_f32_32x32x16_bf16 v[192:207], v[84:87], v[64:67], v[192:207]
    s_cbranch_vccz gn_110
    s_add_u32 m0, s26, 50176
    s_nop 0
    buffer_load_dwordx4 v11, s[8:11], s23 offen lds
gn_110:
    s_waitcnt lgkmcnt(6)
    v_mfma_f32_32x32x16_bf16 v[144:159], v[80:83], v[68:71], v[144:159]
    v_mfma_f32_32x32x16_bf16 v[208:223], v[84:87], v[68:71], v[208:223]
    s_cbranch_vccz gn_111
    s_add_u32 m0, s26, 51200
    s_nop 0
    buffer_load_dwordx4 v12, s[8:11], s23 offen lds
gn_111:
    ds_read_b64_tr_b16 v[80:81], v34 offset:8192
    ds_read_b64_tr_b16 v[82:83], v34 offset:9216
    ds_read_b64_tr_b16 v[84:85], v35 offset:8192
    ds_read_b64_tr_b16 v[86:87], v35 offset:9216
    ds_read_b128 v[64:67], v28 offset:0
    ds_read_b128 v[68:71], v28 offset:4096
    s_waitcnt lgkmcnt(7)
    v_mfma_f32_32x32x16_bf16 v[128:143], v[104:107], v[88:91], v[128:143]
    v_mfma_f32_32x32x16_bf16 v[192:207], v[108:111], v[88:91], v[192:207]
    s_cbranch_vccz gn_112
    s_add_u32 m0, s26, 52224
    s_nop 0
    buffer_load_dwordx4 v13, s[8:11], s23 offen lds
gn_112:
    s_waitcnt lgkmcnt(6)
    v_mfma_f32_32x32x16_bf16 v[144:159], v[104:107], v[92:95], v[144:159]
    v_mfma_f32_32x32x16_bf16 v[208:223], v[108:111], v[92:95], v[208:223]
    s_cbranch_vccz gn_113
    s_add_u32 m0, s34, 81920
    s_nop 0
    buffer_load_dwordx4 v14, s[12:15], s24 offen lds
gn_113:
    ds_read_b64_tr_b16 v[104:105], v34 offset:12288
    ds_read_b64_tr_b16 v[106:107], v34 offset:13312
    ds_read_b64_tr_b16 v[108:109], v35 offset:12288
    ds_read_b64_tr_b16 v[110:111], v35 offset:13312
    ds_read_b128 v[88:91], v29 offset:0
    ds_read_b128 v[92:95], v29 offset:4096
    s_waitcnt lgkmcnt(7)
    v_mfma_f32_32x32x16_bf16 v[128:143], v[80:83], v[64:67], v[128:143]
    v_mfma_f32_32x32x16_bf16 v[192:207], v[84:87], v[64:67], v[192:207]
    s_cbranch_vccz gn_114
    s_add_u32 m0, s34, 82944
    s_nop 0
    buffer_load_dwordx4 v15, s[12:15], s24 offen lds
    s_add_u32 s23, s23, 128
    s_add_u32 s24, s24, s25
gn_114:
    s_waitcnt lgkmcnt(6)
    v_mfma_f32_32x32x16_bf16 v[144:159], v[80:83], v[68:71], v[144:159]
    v_mfma_f32_32x32x16_bf16 v[208:223], v[84:87], v[68:71], v[208:223]
    s_waitcnt lgkmcnt(1)
    v_mfma_f32_32x32x16_bf16 v[128:143], v[104:107], v[88:91], v[128:143]
    v_mfma_f32_32x32x16_bf16 v[192:207], v[108:111], v[88:91], v[192:207]
    s_cmp_le_u32 s22, 1
    s_waitcnt lgkmcnt(0)
    s_cbranch_scc1 ge_95
    s_cmp_gt_u32 s22, 2
    s_cbranch_scc1 gw_115
    s_waitcnt vmcnt(0)
gw_115:
    s_waitcnt vmcnt(6)
    s_cmp_gt_u32 s22, 3
    s_cselect_b64 vcc, -1, 0
    s_barrier
    ds_read_b64_tr_b16 v[80:81], v30 offset:0
    ds_read_b64_tr_b16 v[82:83], v30 offset:1024
    ds_read_b64_tr_b16 v[84:85], v31 offset:0
    ds_read_b64_tr_b16 v[86:87], v31 offset:1024
    ds_read_b128 v[64:67], v18 offset:0
    ds_read_b128 v[68:71], v18 offset:4096
    v_mfma_f32_32x32x16_bf16 v[144:159], v[104:107], v[92:95], v[144:159]
    v_mfma_f32_32x32x16_bf16 v[208:223], v[108:111], v[92:95], v[208:223]
    s_cbranch_vccz gn_116
    s_add_u32 m0, s26, 98304
    s_nop 0
    buffer_load_dwordx4 v10, s[8:11], s23 offen lds
gn_116:
    s_sub_u32 s22, s22, 1
    s_branch gl_94
ge_95:
    v_mfma_f32_32x32x16_bf16 v[144:159], v[104:107], v[92:95], v[144:159]
    v_mfma_f32_32x32x16_bf16 v[208:223], v[108:111], v[92:95], v[208:223]
    s_nop 15
    v_and_b32 v2, 31, v1
    s_lshl_b32 s36, s28, 6
    s_add_u32 s36, s36, s30
    v_add_u32 v2, s36, v2
    v_mul_u32_u24 v2, 2560, v2
    s_mul_i32 s36, s29, 128
    s_add_u32 s36, s36, s33
    v_mul_u32_u24 v3, 8, v8
    v_add3_u32 v2, v2, v3, s36
    v_add_u32 v3, 81920, v2
    v_cvt_pk_bf16_f32 v32, v128, v129
    v_cvt_pk_bf16_f32 v33, v130, v131
    buffer_store_dwordx2 v[32:33], v2, s[16:19], 0 offen offset:0
    v_cvt_pk_bf16_f32 v34, v132, v133
    v_cvt_pk_bf16_f32 v35, v134, v135
    buffer_store_dwordx2 v[34:35], v2, s[16:19], 0 offen offset:16
    v_cvt_pk_bf16_f32 v36, v136, v137
    v_cvt_pk_bf16_f32 v37, v138, v139
    buffer_store_dwordx2 v[36:37], v2, s[16:19], 0 offen offset:32
    v_cvt_pk_bf16_f32 v38, v140, v141
    v_cvt_pk_bf16_f32 v39, v142, v143
    buffer_store_dwordx2 v[38:39], v2, s[16:19], 0 offen offset:48
    v_cvt_pk_bf16_f32 v40, v144, v145
    v_cvt_pk_bf16_f32 v41, v146, v147
    buffer_store_dwordx2 v[40:41], v3, s[16:19], 0 offen offset:0
    v_cvt_pk_bf16_f32 v42, v148, v149
    v_cvt_pk_bf16_f32 v43, v150, v151
    buffer_store_dwordx2 v[42:43], v3, s[16:19], 0 offen offset:16
    v_cvt_pk_bf16_f32 v44, v152, v153
    v_cvt_pk_bf16_f32 v45, v154, v155
    buffer_store_dwordx2 v[44:45], v3, s[16:19], 0 offen offset:32
    v_cvt_pk_bf16_f32 v46, v156, v157
    v_cvt_pk_bf16_f32 v47, v158, v159
    buffer_store_dwordx2 v[46:47], v3, s[16:19], 0 offen offset:48
    v_cvt_pk_bf16_f32 v32, v192, v193
    v_cvt_pk_bf16_f32 v33, v194, v195
    buffer_store_dwordx2 v[32:33], v2, s[16:19], 0 offen offset:64
    v_cvt_pk_bf16_f32 v34, v196, v197
    v_cvt_pk_bf16_f32 v35, v198, v199
    buffer_store_dwordx2 v[34:35], v2, s[16:19], 0 offen offset:80
    v_cvt_pk_bf16_f32 v36, v200, v201
    v_cvt_pk_bf16_f32 v37, v202, v203
    buffer_store_dwordx2 v[36:37], v2, s[16:19], 0 offen offset:96
    v_cvt_pk_bf16_f32 v38, v204, v205
    v_cvt_pk_bf16_f32 v39, v206, v207
    buffer_store_dwordx2 v[38:39], v2, s[16:19], 0 offen offset:112
    v_cvt_pk_bf16_f32 v40, v208, v209
    v_cvt_pk_bf16_f32 v41, v210, v211
    buffer_store_dwordx2 v[40:41], v3, s[16:19], 0 offen offset:64
    v_cvt_pk_bf16_f32 v42, v212, v213
    v_cvt_pk_bf16_f32 v43, v214, v215
    buffer_store_dwordx2 v[42:43], v3, s[16:19], 0 offen offset:80
    v_cvt_pk_bf16_f32 v44, v216, v217
    v_cvt_pk_bf16_f32 v45, v218, v219
    buffer_store_dwordx2 v[44:45], v3, s[16:19], 0 offen offset:96
    v_cvt_pk_bf16_f32 v46, v220, v221
    v_cvt_pk_bf16_f32 v47, v222, v223
    buffer_store_dwordx2 v[46:47], v3, s[16:19], 0 offen offset:112
k3_end:
    s_endpgm
.globl reduce_kernel
.p2align 8
.type reduce_kernel,@function
reduce_kernel:
    s_cmp_ge_u32 s2, 640
    s_cbranch_scc1 k4_end
    s_load_dwordx2 s[4:5], s[0:1], 72
    s_load_dwordx2 s[6:7], s[0:1], 88
    s_mul_hi_u32 s3, s2, 429496730
    s_mul_i32 s20, s3, 10
    s_sub_u32 s20, s2, s20
    v_and_b32 v1, 7, v0
    v_lshrrev_b32 v4, 3, v0
    s_mul_i32 s21, s3, 81920
    s_lshl_b32 s22, s20, 13
    s_add_u32 s22, s22, s21
    v_lshlrev_b32 v2, 10, v1
    v_lshl_add_u32 v2, v4, 5, v2
    v_add_u32 v2, s22, v2
    s_lshl_b32 s22, s20, 7
    s_add_u32 s22, s22, s21
    v_mul_u32_u24 v3, 2560, v4
    v_lshl_add_u32 v3, v1, 4, v3
    v_add_u32 v3, s22, v3
    s_waitcnt lgkmcnt(0)
    s_mov_b32 s8, s4
    s_and_b32 s9, s5, 0xffff
    s_mov_b32 s10, 5242880
    s_mov_b32 s11, 0x00020000
    s_mov_b32 s12, s6
    s_and_b32 s13, s7, 0xffff
    s_mov_b32 s14, 268435456
    s_mov_b32 s15, 0x00020000
    s_mov_b32 s20, 83886080
    buffer_load_dwordx4 v[8:11], v2, s[12:15], s20 offen
    buffer_load_dwordx4 v[12:15], v2, s[12:15], s20 offen offset:16
    s_mov_b32 s21, 89128960
    buffer_load_dwordx4 v[16:19], v2, s[12:15], s21 offen
    buffer_load_dwordx4 v[20:23], v2, s[12:15], s21 offen offset:16
    s_mov_b32 s22, 94371840
    buffer_load_dwordx4 v[24:27], v2, s[12:15], s22 offen
    buffer_load_dwordx4 v[28:31], v2, s[12:15], s22 offen offset:16
    s_mov_b32 s23, 99614720
    buffer_load_dwordx4 v[32:35], v2, s[12:15], s23 offen
    buffer_load_dwordx4 v[36:39], v2, s[12:15], s23 offen offset:16
    s_waitcnt vmcnt(0)
    v_add_f32 v8, v8, v16
    v_add_f32 v24, v24, v32
    v_add_f32 v9, v9, v17
    v_add_f32 v25, v25, v33
    v_add_f32 v10, v10, v18
    v_add_f32 v26, v26, v34
    v_add_f32 v11, v11, v19
    v_add_f32 v27, v27, v35
    v_add_f32 v12, v12, v20
    v_add_f32 v28, v28, v36
    v_add_f32 v13, v13, v21
    v_add_f32 v29, v29, v37
    v_add_f32 v14, v14, v22
    v_add_f32 v30, v30, v38
    v_add_f32 v15, v15, v23
    v_add_f32 v31, v31, v39
    v_add_f32 v8, v8, v24
    v_add_f32 v9, v9, v25
    v_add_f32 v10, v10, v26
    v_add_f32 v11, v11, v27
    v_add_f32 v12, v12, v28
    v_add_f32 v13, v13, v29
    v_add_f32 v14, v14, v30
    v_add_f32 v15, v15, v31
    v_cvt_pk_bf16_f32 v40, v8, v9
    v_cvt_pk_bf16_f32 v41, v10, v11
    v_cvt_pk_bf16_f32 v42, v12, v13
    v_cvt_pk_bf16_f32 v43, v14, v15
    buffer_store_dwordx4 v[40:43], v3, s[8:11], 0 offen offset:1280
k4_end:
    s_endpgm
.section .rodata,"a"
.p2align 6
.p2align 6
.amdhsa_kernel proj_kernel
  .amdhsa_next_free_vgpr 256
  .amdhsa_next_free_sgpr 102
  .amdhsa_accum_offset 256
  .amdhsa_group_segment_fixed_size 0
  .amdhsa_kernarg_size 96
  .amdhsa_user_sgpr_count 2
  .amdhsa_user_sgpr_kernarg_segment_ptr 1
  .amdhsa_system_sgpr_workgroup_id_x 1
.end_amdhsa_kernel
.p2align 6
.amdhsa_kernel attn_kernel
  .amdhsa_next_free_vgpr 256
  .amdhsa_next_free_sgpr 102
  .amdhsa_accum_offset 256
  .amdhsa_group_segment_fixed_size 0
  .amdhsa_kernarg_size 96
  .amdhsa_user_sgpr_count 2
  .amdhsa_user_sgpr_kernarg_segment_ptr 1
  .amdhsa_system_sgpr_workgroup_id_x 1
.end_amdhsa_kernel
.p2align 6
.amdhsa_kernel oproj_kernel
  .amdhsa_next_free_vgpr 256
  .amdhsa_next_free_sgpr 102
  .amdhsa_accum_offset 256
  .amdhsa_group_segment_fixed_size 0
  .amdhsa_kernarg_size 96
  .amdhsa_user_sgpr_count 2
  .amdhsa_user_sgpr_kernarg_segment_ptr 1
  .amdhsa_system_sgpr_workgroup_id_x 1
.end_amdhsa_kernel
.p2align 6
.amdhsa_kernel reduce_kernel
  .amdhsa_next_free_vgpr 48
  .amdhsa_next_free_sgpr 102
  .amdhsa_accum_offset 48
  .amdhsa_group_segment_fixed_size 0
  .amdhsa_kernarg_size 96
  .amdhsa_user_sgpr_count 2
  .amdhsa_user_sgpr_kernarg_segment_ptr 1
  .amdhsa_system_sgpr_workgroup_id_x 1
.end_amdhsa_kernel
```
